```python
import torch

def _softmax(x, axis=-1):
    return torch.softmax(x, dim=axis)
def _gelu(x):
    return torch.nn.functional.gelu(x, approximate="tanh")
def _silu(x):
    return torch.nn.functional.silu(x)
def _sigmoid(x):
    return torch.sigmoid(x)
def _layernorm(x, axis=-1, eps=1e-5):
    m = x.mean(dim=axis, keepdim=True)
    v = x.var(dim=axis, keepdim=True, unbiased=False)
    return (x - m) / torch.sqrt(v + eps)
def _scatter_add(tgt, idx, src, axis=0):
    return tgt.clone().index_add_(axis, idx, src)
def _segment_sum(src, seg, n):
    out = torch.zeros((n,) + src.shape[1:], dtype=src.dtype)
    return out.index_add_(0, seg, src)
def _pad(x, pw):
    flat = tuple(v for pair in reversed(pw) for v in pair)
    return torch.nn.functional.pad(x, flat)

kernel_name = 'interleave_layers__sliding_block__geglu_ffn__prompt'

def setup_inputs():

    _w = (lambda a: (lambda t: t.to(torch.bfloat16) if t.is_floating_point() else t)(torch.as_tensor(a)))
    def _A_setup():
        B, S, D = 1, 2048, 512
        return {
            "x": _w((lambda *s: torch.randn(*s, dtype=torch.bfloat16) * 0.05)(B, S, D)),
            "wqkv": _w((lambda *s: torch.randn(*s, dtype=torch.bfloat16) * 0.05)(D, 3 * D)),
            "wo": _w((lambda *s: torch.randn(*s, dtype=torch.bfloat16) * 0.05)(D, D)),
        }
    _A_in = _A_setup()

    def _B_setup():
        B, S, D, F = 1, 2048, 512, 1792
        return {
            "x": _w((lambda *s: torch.randn(*s, dtype=torch.bfloat16) * 0.05)(B, S, D)),
            "w_gate": _w((lambda *s: torch.randn(*s, dtype=torch.bfloat16) * 0.05)(D, F)),
            "w_up": _w((lambda *s: torch.randn(*s, dtype=torch.bfloat16) * 0.05)(D, F)),
            "w_down": _w((lambda *s: torch.randn(*s, dtype=torch.bfloat16) * 0.05)(F, D)),
        }
    _B_in = _B_setup()

    return {
        "A_x": _A_in["x"],
        "A_wqkv": _A_in["wqkv"],
        "A_wo": _A_in["wo"],
        "B_x": _B_in["x"],
        "B_w_gate": _B_in["w_gate"],
        "B_w_up": _B_in["w_up"],
        "B_w_down": _B_in["w_down"],
    }

def reference(A_x, A_wqkv, A_wo, B_x, B_w_gate, B_w_up, B_w_down):
    def _A_ref(x, wqkv, wo):
        B, S, D = x.shape
        H = 32; Dh = D // H; W = 256
        qkv = (lambda x, *d: x.permute(*d))((x @ wqkv).reshape(B, S, 3, H, Dh), 2, 0, 3, 1, 4)
        q, k, v = qkv[0], qkv[1], qkv[2]
        scores = torch.einsum("bhqd,bhkd->bhqk", q, k) * (Dh ** -0.5)
        idx = torch.arange(S)
        mask = (idx[:, None] - idx[None, :] >= 0) & (idx[:, None] - idx[None, :] < W)
        scores = torch.where(mask[None, None], scores, -1e9)
        p = _softmax(scores, axis=-1)
        o = torch.einsum("bhqk,bhkd->bhqd", p, v)
        return (lambda x, *d: x.permute(*d))(o, 0, 2, 1, 3).reshape(B, S, D) @ wo

    def _B_ref(x, w_gate, w_up, w_down):
        return (_gelu(x @ w_gate) * (x @ w_up)) @ w_down

    x = A_x
    x = x + _A_ref(_layernorm(x, axis=-1), A_wqkv, A_wo)
    x = x + _B_ref(_layernorm(x, axis=-1), B_w_gate, B_w_up, B_w_down)
    x = x + _A_ref(_layernorm(x, axis=-1), A_wqkv, A_wo)
    x = x + _B_ref(_layernorm(x, axis=-1), B_w_gate, B_w_up, B_w_down)
    return x
```

```asm
; @launch kernel=mega_kernel grid=(256,1,1) block=(512,1,1) lds=163840
.amdgcn_target "amdgcn-amd-amdhsa--gfx950"
.text
.globl mega_kernel
.p2align 8
.type mega_kernel,@function
mega_kernel:
  s_load_dwordx16 s[36:51], s[0:1], 0
  s_load_dwordx4 s[52:55], s[0:1], 64
  s_mov_b32 s3, 0
  s_mov_b32 s4, 0
B_mega:
  s_cmp_ge_u32 s2, 256
  s_cbranch_scc1 L_mega_end
  v_and_b32 v1, 63, v0
  v_lshrrev_b32 v2, 6, v0
  s_nop 0
  v_readfirstlane_b32 s5, v2
  s_and_b32 s6, s2, 7
  s_lshr_b32 s7, s2, 3
  s_mov_b32 s75, 0
  s_getpc_b64 s[96:97]
  s_and_b32 s97, s97, 0xffff
  s_mov_b32 s98, 4096
  s_mov_b32 s99, 0x20000
  v_lshlrev_b32 v2, 6, v1
  buffer_load_dword v255, v2, s[96:99], 0 offen
  s_cmp_ge_u32 s7, 24
  s_cbranch_scc1 L_helper
  s_mul_i32 s24, s7, 43
  s_lshr_b32 s24, s24, 8
  s_mul_i32 s25, s24, 6
  s_sub_u32 s25, s7, s25
  s_mul_i32 s86, s24, 1
  s_mul_i32 s87, s25, 0
  s_add_u32 s86, s86, s87
  s_lshr_b32 s87, s6, 1
  s_mul_i32 s87, s87, 2
  s_add_u32 s86, s86, s87
  s_and_b32 s87, s6, 1
  s_mul_i32 s87, s87, 4
  s_add_u32 s86, s86, s87
  s_lshr_b32 s26, s6, 1
  s_lshl_b32 s26, s26, 2
  s_add_u32 s24, s24, s26
  s_and_b32 s26, s6, 1
  s_mul_i32 s26, s26, 6
  s_add_u32 s25, s25, s26
  s_and_b32 s26, s5, 3
  s_lshl_b32 s27, s24, 2
  s_add_u32 s27, s27, s26
  s_cmp_lt_u32 s5, 4
  s_cbranch_scc1 L_qkv_a_A
  s_setprio 3
  v_lshrrev_b32 v3, 4, v1
  v_and_b32 v4, 15, v1
  v_lshrrev_b32 v5, 2, v4
  v_xor_b32 v5, v5, v3
  v_and_b32 v4, 3, v4
  v_lshl_add_u32 v4, v5, 2, v4
  v_lshlrev_b32 v4, 4, v4
  v_mul_u32_u24 v3, 3072, v3
  s_lshl_b32 s28, s25, 8
  v_add3_u32 v16, v3, v4, s28
  s_mul_i32 s32, s26, 12288
  s_lshl_b32 s31, s26, 10
  v_lshrrev_b32 v3, 3, v1
  v_and_b32 v4, 7, v1
  v_lshrrev_b32 v5, 1, v3
  v_xor_b32 v5, v5, v4
  v_lshlrev_b32 v5, 4, v5
  v_lshl_add_u32 v20, v3, 10, v5
  v_xor_b32 v21, 64, v20
  s_lshl_b32 s30, s26, 12
  s_add_u32 s30, s30, 81920
  s_lshl_b32 s29, s27, 15
  s_add_u32 s57, s29, 8192
  s_add_u32 s58, s29, 16384
  s_add_u32 s59, s29, 24576
  s_mov_b32 s56, s29
  s_waitcnt lgkmcnt(0)
  s_mov_b32 s20, s36
  s_and_b32 s21, s37, 0xffff
  s_mov_b32 s22, 2097152
  s_mov_b32 s23, 0x20000
  s_mov_b32 s12, s38
  s_and_b32 s13, s39, 0xffff
  s_mov_b32 s14, 1572864
  s_mov_b32 s15, 0x20000
  s_add_u32 s81, s86, 0
  s_and_b32 s81, s81, 7
  s_mul_i32 s82, s81, 196608
  s_add_u32 s82, s82, s32
  s_lshl_b32 s81, s81, 7
  s_add_u32 m0, s30, 0
  s_add_u32 s83, s56, s81
  buffer_load_dwordx4 v20, s[20:23], s83 offen lds
  s_add_u32 m0, s30, 1024
  s_add_u32 s83, s57, s81
  buffer_load_dwordx4 v21, s[20:23], s83 offen lds
  s_add_u32 m0, s30, 2048
  s_add_u32 s83, s58, s81
  buffer_load_dwordx4 v20, s[20:23], s83 offen lds
  s_add_u32 m0, s30, 3072
  s_add_u32 s83, s59, s81
  buffer_load_dwordx4 v21, s[20:23], s83 offen lds
  s_add_u32 m0, s31, 0
  s_add_u32 s33, s82, 0
  buffer_load_dwordx4 v16, s[12:15], s33 offen lds
  s_add_u32 m0, s31, 4096
  s_add_u32 s33, s82, 49152
  buffer_load_dwordx4 v16, s[12:15], s33 offen lds
  s_add_u32 m0, s31, 8192
  s_add_u32 s33, s82, 98304
  buffer_load_dwordx4 v16, s[12:15], s33 offen lds
  s_add_u32 m0, s31, 12288
  s_add_u32 s33, s82, 147456
  buffer_load_dwordx4 v16, s[12:15], s33 offen lds
  s_add_u32 s81, s86, 1
  s_and_b32 s81, s81, 7
  s_mul_i32 s82, s81, 196608
  s_add_u32 s82, s82, s32
  s_lshl_b32 s81, s81, 7
  s_add_u32 m0, s30, 16384
  s_add_u32 s83, s56, s81
  buffer_load_dwordx4 v20, s[20:23], s83 offen lds
  s_add_u32 m0, s30, 17408
  s_add_u32 s83, s57, s81
  buffer_load_dwordx4 v21, s[20:23], s83 offen lds
  s_add_u32 m0, s30, 18432
  s_add_u32 s83, s58, s81
  buffer_load_dwordx4 v20, s[20:23], s83 offen lds
  s_add_u32 m0, s30, 19456
  s_add_u32 s83, s59, s81
  buffer_load_dwordx4 v21, s[20:23], s83 offen lds
  s_add_u32 m0, s31, 16384
  s_add_u32 s33, s82, 0
  buffer_load_dwordx4 v16, s[12:15], s33 offen lds
  s_add_u32 m0, s31, 20480
  s_add_u32 s33, s82, 49152
  buffer_load_dwordx4 v16, s[12:15], s33 offen lds
  s_add_u32 m0, s31, 24576
  s_add_u32 s33, s82, 98304
  buffer_load_dwordx4 v16, s[12:15], s33 offen lds
  s_add_u32 m0, s31, 28672
  s_add_u32 s33, s82, 147456
  buffer_load_dwordx4 v16, s[12:15], s33 offen lds
  s_mov_b32 s95, 27262976
  s_lshr_b32 s78, s24, 1
  s_lshl_b32 s78, s78, 5
  s_and_b32 s28, s24, 1
  s_mul_i32 s28, s28, 12
  s_add_u32 s78, s78, s28
  s_add_u32 s78, s78, s25
  v_and_b32 v3, 15, v1
  v_lshrrev_b32 v4, 2, v3
  v_and_b32 v5, 3, v3
  v_bfe_u32 v6, v1, 4, 1
  v_lshrrev_b32 v7, 5, v1
  v_lshl_add_u32 v8, v7, 3, v4
  v_mul_u32_u24 v8, 256, v8
  v_lshlrev_b32 v9, 5, v6
  v_lshl_add_u32 v9, v5, 3, v9
  v_add_u32 v8, v8, v9
  v_and_b32 v11, 31, v1
  v_xor_b32 v9, s26, v4
  v_lshl_add_u32 v18, v9, 6, v8
  s_mov_b32 s88, 0xffff0000
  v_mov_b32 v48, 0
  v_mov_b32 v49, 0
  v_mov_b32 v50, 0
  v_mov_b32 v51, 0
  v_mov_b32 v52, 0
  v_mov_b32 v53, 0
  v_mov_b32 v54, 0
  v_mov_b32 v55, 0
  v_lshrrev_b32 v24, 2, v1
  v_xor_b32 v24, v24, v1
  v_bfe_u32 v24, v24, 2, 1
  v_sub_u32 v24, 1, v24
  v_mul_u32_u24 v24, 0x3f80, v24
  v_lshl_or_b32 v24, v24, 16, v24
  v_mov_b32 v25, v24
  v_mov_b32 v26, v24
  v_mov_b32 v27, v24
  v_mov_b32 v64, 0
  v_mov_b32 v65, 0
  v_mov_b32 v66, 0
  v_mov_b32 v67, 0
  v_mov_b32 v68, 0
  v_mov_b32 v69, 0
  v_mov_b32 v70, 0
  v_mov_b32 v71, 0
  v_mov_b32 v72, 0
  v_mov_b32 v73, 0
  v_mov_b32 v74, 0
  v_mov_b32 v75, 0
  v_mov_b32 v76, 0
  v_mov_b32 v77, 0
  v_mov_b32 v78, 0
  v_mov_b32 v79, 0
  s_mov_b32 s60, 0x3f803f80
  s_waitcnt vmcnt(8)
  s_barrier
  ds_read_b64_tr_b16 v[128:129], v18 offset:0
  ds_read_b64_tr_b16 v[130:131], v18 offset:1024
  ds_read_b64_tr_b16 v[132:133], v18 offset:4096
  ds_read_b64_tr_b16 v[134:135], v18 offset:5120
  ds_read_b64_tr_b16 v[136:137], v18 offset:8192
  ds_read_b64_tr_b16 v[138:139], v18 offset:9216
  ds_read_b64_tr_b16 v[140:141], v18 offset:12288
  ds_read_b64_tr_b16 v[142:143], v18 offset:13312
  s_add_u32 s81, s86, 2
  s_and_b32 s81, s81, 7
  s_mul_i32 s82, s81, 196608
  s_add_u32 s82, s82, s32
  s_lshl_b32 s81, s81, 7
  s_add_u32 m0, s30, 32768
  s_add_u32 s83, s56, s81
  buffer_load_dwordx4 v20, s[20:23], s83 offen lds
  s_add_u32 m0, s30, 33792
  s_add_u32 s83, s57, s81
  buffer_load_dwordx4 v21, s[20:23], s83 offen lds
  s_add_u32 m0, s30, 34816
  s_add_u32 s83, s58, s81
  buffer_load_dwordx4 v20, s[20:23], s83 offen lds
  s_add_u32 m0, s30, 35840
  s_add_u32 s83, s59, s81
  buffer_load_dwordx4 v21, s[20:23], s83 offen lds
  s_add_u32 m0, s31, 32768
  s_add_u32 s33, s82, 0
  buffer_load_dwordx4 v16, s[12:15], s33 offen lds
  s_add_u32 m0, s31, 36864
  s_add_u32 s33, s82, 49152
  buffer_load_dwordx4 v16, s[12:15], s33 offen lds
  s_add_u32 m0, s31, 40960
  s_add_u32 s33, s82, 98304
  buffer_load_dwordx4 v16, s[12:15], s33 offen lds
  s_add_u32 m0, s31, 45056
  s_add_u32 s33, s82, 147456
  buffer_load_dwordx4 v16, s[12:15], s33 offen lds
  s_waitcnt lgkmcnt(6)
  v_mfma_f32_16x16x32_bf16 v[64:67], v[24:27], v[128:131], 0
  s_waitcnt lgkmcnt(4)
  v_mfma_f32_16x16x32_bf16 v[80:83], v[24:27], v[132:135], 0
  s_waitcnt lgkmcnt(2)
  v_mfma_f32_16x16x32_bf16 v[96:99], v[24:27], v[136:139], 0
  s_waitcnt lgkmcnt(0)
  v_mfma_f32_16x16x32_bf16 v[112:115], v[24:27], v[140:143], 0
  s_waitcnt vmcnt(8)
  s_barrier
  ds_read_b64_tr_b16 v[144:145], v18 offset:16384
  ds_read_b64_tr_b16 v[146:147], v18 offset:17408
  ds_read_b64_tr_b16 v[148:149], v18 offset:20480
  ds_read_b64_tr_b16 v[150:151], v18 offset:21504
  ds_read_b64_tr_b16 v[152:153], v18 offset:24576
  ds_read_b64_tr_b16 v[154:155], v18 offset:25600
  ds_read_b64_tr_b16 v[156:157], v18 offset:28672
  ds_read_b64_tr_b16 v[158:159], v18 offset:29696
  s_add_u32 s81, s86, 3
  s_and_b32 s81, s81, 7
  s_mul_i32 s82, s81, 196608
  s_add_u32 s82, s82, s32
  s_lshl_b32 s81, s81, 7
  s_add_u32 m0, s30, 49152
  s_add_u32 s83, s56, s81
  buffer_load_dwordx4 v20, s[20:23], s83 offen lds
  s_add_u32 m0, s30, 50176
  s_add_u32 s83, s57, s81
  buffer_load_dwordx4 v21, s[20:23], s83 offen lds
  s_add_u32 m0, s30, 51200
  s_add_u32 s83, s58, s81
  buffer_load_dwordx4 v20, s[20:23], s83 offen lds
  s_add_u32 m0, s30, 52224
  s_add_u32 s83, s59, s81
  buffer_load_dwordx4 v21, s[20:23], s83 offen lds
  s_add_u32 m0, s31, 49152
  s_add_u32 s33, s82, 0
  buffer_load_dwordx4 v16, s[12:15], s33 offen lds
  s_add_u32 m0, s31, 53248
  s_add_u32 s33, s82, 49152
  buffer_load_dwordx4 v16, s[12:15], s33 offen lds
  s_add_u32 m0, s31, 57344
  s_add_u32 s33, s82, 98304
  buffer_load_dwordx4 v16, s[12:15], s33 offen lds
  s_add_u32 m0, s31, 61440
  s_add_u32 s33, s82, 147456
  buffer_load_dwordx4 v16, s[12:15], s33 offen lds
  s_waitcnt lgkmcnt(6)
  v_mfma_f32_16x16x32_bf16 v[64:67], v[24:27], v[144:147], v[64:67]
  s_waitcnt lgkmcnt(4)
  v_mfma_f32_16x16x32_bf16 v[80:83], v[24:27], v[148:151], v[80:83]
  s_waitcnt lgkmcnt(2)
  v_mfma_f32_16x16x32_bf16 v[96:99], v[24:27], v[152:155], v[96:99]
  s_waitcnt lgkmcnt(0)
  v_mfma_f32_16x16x32_bf16 v[112:115], v[24:27], v[156:159], v[112:115]
  s_waitcnt vmcnt(8)
  s_barrier
  ds_read_b64_tr_b16 v[128:129], v18 offset:32768
  ds_read_b64_tr_b16 v[130:131], v18 offset:33792
  ds_read_b64_tr_b16 v[132:133], v18 offset:36864
  ds_read_b64_tr_b16 v[134:135], v18 offset:37888
  ds_read_b64_tr_b16 v[136:137], v18 offset:40960
  ds_read_b64_tr_b16 v[138:139], v18 offset:41984
  ds_read_b64_tr_b16 v[140:141], v18 offset:45056
  ds_read_b64_tr_b16 v[142:143], v18 offset:46080
  s_add_u32 s81, s86, 4
  s_and_b32 s81, s81, 7
  s_mul_i32 s82, s81, 196608
  s_add_u32 s82, s82, s32
  s_lshl_b32 s81, s81, 7
  s_add_u32 m0, s30, 65536
  s_add_u32 s83, s56, s81
  buffer_load_dwordx4 v20, s[20:23], s83 offen lds
  s_add_u32 m0, s30, 66560
  s_add_u32 s83, s57, s81
  buffer_load_dwordx4 v21, s[20:23], s83 offen lds
  s_add_u32 m0, s30, 67584
  s_add_u32 s83, s58, s81
  buffer_load_dwordx4 v20, s[20:23], s83 offen lds
  s_add_u32 m0, s30, 68608
  s_add_u32 s83, s59, s81
  buffer_load_dwordx4 v21, s[20:23], s83 offen lds
  s_add_u32 m0, s31, 65536
  s_add_u32 s33, s82, 0
  buffer_load_dwordx4 v16, s[12:15], s33 offen lds
  s_add_u32 m0, s31, 69632
  s_add_u32 s33, s82, 49152
  buffer_load_dwordx4 v16, s[12:15], s33 offen lds
  s_add_u32 m0, s31, 73728
  s_add_u32 s33, s82, 98304
  buffer_load_dwordx4 v16, s[12:15], s33 offen lds
  s_add_u32 m0, s31, 77824
  s_add_u32 s33, s82, 147456
  buffer_load_dwordx4 v16, s[12:15], s33 offen lds
  s_waitcnt lgkmcnt(6)
  v_mfma_f32_16x16x32_bf16 v[64:67], v[24:27], v[128:131], v[64:67]
  s_waitcnt lgkmcnt(4)
  v_mfma_f32_16x16x32_bf16 v[80:83], v[24:27], v[132:135], v[80:83]
  s_waitcnt lgkmcnt(2)
  v_mfma_f32_16x16x32_bf16 v[96:99], v[24:27], v[136:139], v[96:99]
  s_waitcnt lgkmcnt(0)
  v_mfma_f32_16x16x32_bf16 v[112:115], v[24:27], v[140:143], v[112:115]
  s_waitcnt vmcnt(8)
  s_barrier
  ds_read_b64_tr_b16 v[144:145], v18 offset:49152
  ds_read_b64_tr_b16 v[146:147], v18 offset:50176
  ds_read_b64_tr_b16 v[148:149], v18 offset:53248
  ds_read_b64_tr_b16 v[150:151], v18 offset:54272
  ds_read_b64_tr_b16 v[152:153], v18 offset:57344
  ds_read_b64_tr_b16 v[154:155], v18 offset:58368
  ds_read_b64_tr_b16 v[156:157], v18 offset:61440
  ds_read_b64_tr_b16 v[158:159], v18 offset:62464
  s_add_u32 s81, s86, 5
  s_and_b32 s81, s81, 7
  s_mul_i32 s82, s81, 196608
  s_add_u32 s82, s82, s32
  s_lshl_b32 s81, s81, 7
  s_add_u32 m0, s30, 0
  s_add_u32 s83, s56, s81
  buffer_load_dwordx4 v20, s[20:23], s83 offen lds
  s_add_u32 m0, s30, 1024
  s_add_u32 s83, s57, s81
  buffer_load_dwordx4 v21, s[20:23], s83 offen lds
  s_add_u32 m0, s30, 2048
  s_add_u32 s83, s58, s81
  buffer_load_dwordx4 v20, s[20:23], s83 offen lds
  s_add_u32 m0, s30, 3072
  s_add_u32 s83, s59, s81
  buffer_load_dwordx4 v21, s[20:23], s83 offen lds
  s_add_u32 m0, s31, 0
  s_add_u32 s33, s82, 0
  buffer_load_dwordx4 v16, s[12:15], s33 offen lds
  s_add_u32 m0, s31, 4096
  s_add_u32 s33, s82, 49152
  buffer_load_dwordx4 v16, s[12:15], s33 offen lds
  s_add_u32 m0, s31, 8192
  s_add_u32 s33, s82, 98304
  buffer_load_dwordx4 v16, s[12:15], s33 offen lds
  s_add_u32 m0, s31, 12288
  s_add_u32 s33, s82, 147456
  buffer_load_dwordx4 v16, s[12:15], s33 offen lds
  s_waitcnt lgkmcnt(6)
  v_mfma_f32_16x16x32_bf16 v[64:67], v[24:27], v[144:147], v[64:67]
  s_waitcnt lgkmcnt(4)
  v_mfma_f32_16x16x32_bf16 v[80:83], v[24:27], v[148:151], v[80:83]
  s_waitcnt lgkmcnt(2)
  v_mfma_f32_16x16x32_bf16 v[96:99], v[24:27], v[152:155], v[96:99]
  s_waitcnt lgkmcnt(0)
  v_mfma_f32_16x16x32_bf16 v[112:115], v[24:27], v[156:159], v[112:115]
  s_waitcnt vmcnt(8)
  s_barrier
  v_add_u32 v18, 65536, v18
  ds_read_b64_tr_b16 v[128:129], v18 offset:0
  ds_read_b64_tr_b16 v[130:131], v18 offset:1024
  ds_read_b64_tr_b16 v[132:133], v18 offset:4096
  ds_read_b64_tr_b16 v[134:135], v18 offset:5120
  ds_read_b64_tr_b16 v[136:137], v18 offset:8192
  ds_read_b64_tr_b16 v[138:139], v18 offset:9216
  ds_read_b64_tr_b16 v[140:141], v18 offset:12288
  ds_read_b64_tr_b16 v[142:143], v18 offset:13312
  s_add_u32 s81, s86, 6
  s_and_b32 s81, s81, 7
  s_mul_i32 s82, s81, 196608
  s_add_u32 s82, s82, s32
  s_lshl_b32 s81, s81, 7
  s_add_u32 m0, s30, 16384
  s_add_u32 s83, s56, s81
  buffer_load_dwordx4 v20, s[20:23], s83 offen lds
  s_add_u32 m0, s30, 17408
  s_add_u32 s83, s57, s81
  buffer_load_dwordx4 v21, s[20:23], s83 offen lds
  s_add_u32 m0, s30, 18432
  s_add_u32 s83, s58, s81
  buffer_load_dwordx4 v20, s[20:23], s83 offen lds
  s_add_u32 m0, s30, 19456
  s_add_u32 s83, s59, s81
  buffer_load_dwordx4 v21, s[20:23], s83 offen lds
  s_add_u32 m0, s31, 16384
  s_add_u32 s33, s82, 0
  buffer_load_dwordx4 v16, s[12:15], s33 offen lds
  s_add_u32 m0, s31, 20480
  s_add_u32 s33, s82, 49152
  buffer_load_dwordx4 v16, s[12:15], s33 offen lds
  s_add_u32 m0, s31, 24576
  s_add_u32 s33, s82, 98304
  buffer_load_dwordx4 v16, s[12:15], s33 offen lds
  s_add_u32 m0, s31, 28672
  s_add_u32 s33, s82, 147456
  buffer_load_dwordx4 v16, s[12:15], s33 offen lds
  s_waitcnt lgkmcnt(6)
  v_mfma_f32_16x16x32_bf16 v[64:67], v[24:27], v[128:131], v[64:67]
  s_waitcnt lgkmcnt(4)
  v_mfma_f32_16x16x32_bf16 v[80:83], v[24:27], v[132:135], v[80:83]
  s_waitcnt lgkmcnt(2)
  v_mfma_f32_16x16x32_bf16 v[96:99], v[24:27], v[136:139], v[96:99]
  s_waitcnt lgkmcnt(0)
  v_mfma_f32_16x16x32_bf16 v[112:115], v[24:27], v[140:143], v[112:115]
  s_waitcnt vmcnt(8)
  s_barrier
  v_subrev_u32 v18, 65536, v18
  ds_read_b64_tr_b16 v[144:145], v18 offset:0
  ds_read_b64_tr_b16 v[146:147], v18 offset:1024
  ds_read_b64_tr_b16 v[148:149], v18 offset:4096
  ds_read_b64_tr_b16 v[150:151], v18 offset:5120
  ds_read_b64_tr_b16 v[152:153], v18 offset:8192
  ds_read_b64_tr_b16 v[154:155], v18 offset:9216
  ds_read_b64_tr_b16 v[156:157], v18 offset:12288
  ds_read_b64_tr_b16 v[158:159], v18 offset:13312
  s_add_u32 s81, s86, 7
  s_and_b32 s81, s81, 7
  s_mul_i32 s82, s81, 196608
  s_add_u32 s82, s82, s32
  s_lshl_b32 s81, s81, 7
  s_add_u32 m0, s30, 32768
  s_add_u32 s83, s56, s81
  buffer_load_dwordx4 v20, s[20:23], s83 offen lds
  s_add_u32 m0, s30, 33792
  s_add_u32 s83, s57, s81
  buffer_load_dwordx4 v21, s[20:23], s83 offen lds
  s_add_u32 m0, s30, 34816
  s_add_u32 s83, s58, s81
  buffer_load_dwordx4 v20, s[20:23], s83 offen lds
  s_add_u32 m0, s30, 35840
  s_add_u32 s83, s59, s81
  buffer_load_dwordx4 v21, s[20:23], s83 offen lds
  s_add_u32 m0, s31, 32768
  s_add_u32 s33, s82, 0
  buffer_load_dwordx4 v16, s[12:15], s33 offen lds
  s_add_u32 m0, s31, 36864
  s_add_u32 s33, s82, 49152
  buffer_load_dwordx4 v16, s[12:15], s33 offen lds
  s_add_u32 m0, s31, 40960
  s_add_u32 s33, s82, 98304
  buffer_load_dwordx4 v16, s[12:15], s33 offen lds
  s_add_u32 m0, s31, 45056
  s_add_u32 s33, s82, 147456
  buffer_load_dwordx4 v16, s[12:15], s33 offen lds
  s_waitcnt lgkmcnt(6)
  v_mfma_f32_16x16x32_bf16 v[64:67], v[24:27], v[144:147], v[64:67]
  s_waitcnt lgkmcnt(4)
  v_mfma_f32_16x16x32_bf16 v[80:83], v[24:27], v[148:151], v[80:83]
  s_waitcnt lgkmcnt(2)
  v_mfma_f32_16x16x32_bf16 v[96:99], v[24:27], v[152:155], v[96:99]
  s_waitcnt lgkmcnt(0)
  v_mfma_f32_16x16x32_bf16 v[112:115], v[24:27], v[156:159], v[112:115]
  s_waitcnt vmcnt(8)
  s_barrier
  ds_read_b64_tr_b16 v[128:129], v18 offset:16384
  ds_read_b64_tr_b16 v[130:131], v18 offset:17408
  ds_read_b64_tr_b16 v[132:133], v18 offset:20480
  ds_read_b64_tr_b16 v[134:135], v18 offset:21504
  ds_read_b64_tr_b16 v[136:137], v18 offset:24576
  ds_read_b64_tr_b16 v[138:139], v18 offset:25600
  ds_read_b64_tr_b16 v[140:141], v18 offset:28672
  ds_read_b64_tr_b16 v[142:143], v18 offset:29696
  s_waitcnt lgkmcnt(6)
  v_mfma_f32_16x16x32_bf16 v[64:67], v[24:27], v[128:131], v[64:67]
  s_waitcnt lgkmcnt(4)
  v_mfma_f32_16x16x32_bf16 v[80:83], v[24:27], v[132:135], v[80:83]
  s_waitcnt lgkmcnt(2)
  v_mfma_f32_16x16x32_bf16 v[96:99], v[24:27], v[136:139], v[96:99]
  s_waitcnt lgkmcnt(0)
  v_mfma_f32_16x16x32_bf16 v[112:115], v[24:27], v[140:143], v[112:115]
  s_waitcnt vmcnt(0)
  s_barrier
  ds_read_b64_tr_b16 v[144:145], v18 offset:32768
  ds_read_b64_tr_b16 v[146:147], v18 offset:33792
  ds_read_b64_tr_b16 v[148:149], v18 offset:36864
  ds_read_b64_tr_b16 v[150:151], v18 offset:37888
  ds_read_b64_tr_b16 v[152:153], v18 offset:40960
  ds_read_b64_tr_b16 v[154:155], v18 offset:41984
  ds_read_b64_tr_b16 v[156:157], v18 offset:45056
  ds_read_b64_tr_b16 v[158:159], v18 offset:46080
  s_waitcnt lgkmcnt(6)
  v_mfma_f32_16x16x32_bf16 v[64:67], v[24:27], v[144:147], v[64:67]
  s_waitcnt lgkmcnt(4)
  v_mfma_f32_16x16x32_bf16 v[80:83], v[24:27], v[148:151], v[80:83]
  s_waitcnt lgkmcnt(2)
  v_mfma_f32_16x16x32_bf16 v[96:99], v[24:27], v[152:155], v[96:99]
  s_waitcnt lgkmcnt(0)
  v_mfma_f32_16x16x32_bf16 v[112:115], v[24:27], v[156:159], v[112:115]
  s_nop 15
  v_add_f32 v64, v64, v80
  v_add_f32 v96, v96, v112
  v_add_f32 v64, v64, v96
  v_cvt_pk_bf16_f32 v26, v64, v64
  v_and_b32 v25, s88, v26
  v_sub_f32 v25, v64, v25
  v_cvt_pk_bf16_f32 v27, v25, v25
  s_lshl_b32 s28, s26, 8
  s_add_u32 s28, s28, 49152
  v_lshl_add_u32 v4, v11, 3, s28
  ds_write_b64 v4, v[26:27]
  s_waitcnt lgkmcnt(0)
  s_barrier
  s_setprio 0
  s_mov_b32 s8, s54
  s_and_b32 s9, s55, 0xffff
  s_mov_b32 s10, 268435456
  s_mov_b32 s11, 0x20000
  v_mov_b32 v28, 0
  v_mov_b32 v29, 0
  v_lshlrev_b32 v4, 4, v11
  s_mul_i32 s28, s24, 12
  s_add_u32 s28, s28, s25
  s_lshl_b32 s28, s28, 2
  s_add_u32 s28, s28, s26
  s_lshl_b32 s28, s28, 9
  s_add_u32 s28, s28, 19988480
  buffer_store_dwordx4 v[26:29], v4, s[8:11], s28 offen sc1
  s_mov_b32 s20, s52
  s_and_b32 s21, s53, 0xffff
  s_mov_b32 s22, 256
  s_mov_b32 s23, 0x20000
  buffer_load_dwordx3 v[208:210], off, s[20:23], 0 sc1
  s_branch L_qkv_a_pub
L_qkv_a_A:
  s_mov_b32 s95, 27262976
  s_lshr_b32 s78, s24, 1
  s_lshl_b32 s78, s78, 5
  s_and_b32 s28, s24, 1
  s_mul_i32 s28, s28, 12
  s_add_u32 s78, s78, s28
  s_add_u32 s78, s78, s25
  v_and_b32 v3, 15, v1
  v_lshrrev_b32 v4, 2, v3
  v_and_b32 v5, 3, v3
  v_bfe_u32 v6, v1, 4, 1
  v_lshrrev_b32 v7, 5, v1
  v_lshl_add_u32 v8, v7, 3, v4
  v_mul_u32_u24 v8, 256, v8
  v_lshlrev_b32 v9, 5, v6
  v_lshl_add_u32 v9, v5, 3, v9
  v_add_u32 v8, v8, v9
  v_and_b32 v11, 31, v1
  v_xor_b32 v9, 0, v4
  v_lshl_add_u32 v18, v9, 6, v8
  v_xor_b32 v9, 1, v4
  v_lshl_add_u32 v19, v9, 6, v8
  v_xor_b32 v9, 2, v4
  v_lshl_add_u32 v20, v9, 6, v8
  v_xor_b32 v9, 3, v4
  v_lshl_add_u32 v21, v9, 6, v8
  v_lshlrev_b32 v17, 4, v1
  v_bfe_u32 v9, v1, 1, 3
  v_xor_b32 v9, v9, v7
  v_lshlrev_b32 v9, 4, v9
  v_lshl_add_u32 v9, v11, 7, v9
  s_lshl_b32 s28, s26, 12
  s_add_u32 s28, s28, 81920
  v_add_u32 v128, s28, v9
  v_xor_b32 v129, 32, v128
  v_xor_b32 v130, 64, v128
  v_xor_b32 v131, 96, v128
  s_lshr_b32 s84, s25, 2
  s_lshl_b32 s84, s84, 22
  s_and_b32 s85, s25, 3
  s_lshl_b32 s85, s85, 14
  s_add_u32 s84, s84, s85
  s_and_b32 s85, s27, 31
  s_lshl_b32 s85, s85, 16
  s_add_u32 s84, s84, s85
  s_add_u32 s84, s84, s3
  v_bfe_u32 v13, v1, 4, 1
  v_lshlrev_b32 v13, 10, v13
  v_lshl_add_u32 v13, v7, 8, v13
  v_and_b32 v4, 15, v1
  v_lshl_add_u32 v13, v4, 4, v13
  s_mov_b32 s92, 0x3eb8aa3b
  s_cmp_lt_u32 s25, 4
  s_cselect_b32 s92, s92, 1.0
  s_lshl_b32 s93, s26, 8
  s_add_u32 s93, s93, 51200
  v_lshl_add_u32 v12, v11, 2, s93
  v_lshl_add_u32 v14, v7, 4, s93
  s_mov_b32 s90, -1
  s_mov_b32 s91, 0
  s_mov_b32 s60, 0x3f803f80
  v_lshlrev_b32 v10, 3, v11
  v_add_u32 v10, 49152, v10
  v_mov_b32 v64, 0
  v_mov_b32 v65, 0
  v_mov_b32 v66, 0
  v_mov_b32 v67, 0
  v_mov_b32 v68, 0
  v_mov_b32 v69, 0
  v_mov_b32 v70, 0
  v_mov_b32 v71, 0
  v_mov_b32 v72, 0
  v_mov_b32 v73, 0
  v_mov_b32 v74, 0
  v_mov_b32 v75, 0
  v_mov_b32 v76, 0
  v_mov_b32 v77, 0
  v_mov_b32 v78, 0
  v_mov_b32 v79, 0
  v_mov_b32 v80, 0
  v_mov_b32 v81, 0
  v_mov_b32 v82, 0
  v_mov_b32 v83, 0
  v_mov_b32 v84, 0
  v_mov_b32 v85, 0
  v_mov_b32 v86, 0
  v_mov_b32 v87, 0
  v_mov_b32 v88, 0
  v_mov_b32 v89, 0
  v_mov_b32 v90, 0
  v_mov_b32 v91, 0
  v_mov_b32 v92, 0
  v_mov_b32 v93, 0
  v_mov_b32 v94, 0
  v_mov_b32 v95, 0
  v_mov_b32 v96, 0
  v_mov_b32 v97, 0
  v_mov_b32 v98, 0
  v_mov_b32 v99, 0
  v_mov_b32 v100, 0
  v_mov_b32 v101, 0
  v_mov_b32 v102, 0
  v_mov_b32 v103, 0
  v_mov_b32 v104, 0
  v_mov_b32 v105, 0
  v_mov_b32 v106, 0
  v_mov_b32 v107, 0
  v_mov_b32 v108, 0
  v_mov_b32 v109, 0
  v_mov_b32 v110, 0
  v_mov_b32 v111, 0
  v_mov_b32 v112, 0
  v_mov_b32 v113, 0
  v_mov_b32 v114, 0
  v_mov_b32 v115, 0
  v_mov_b32 v116, 0
  v_mov_b32 v117, 0
  v_mov_b32 v118, 0
  v_mov_b32 v119, 0
  v_mov_b32 v120, 0
  v_mov_b32 v121, 0
  v_mov_b32 v122, 0
  v_mov_b32 v123, 0
  v_mov_b32 v124, 0
  v_mov_b32 v125, 0
  v_mov_b32 v126, 0
  v_mov_b32 v127, 0
  v_mov_b32 v140, 0
  v_mov_b32 v141, 0
  v_mov_b32 v142, 0
  v_mov_b32 v143, 0
  v_mov_b32 v144, 0
  v_mov_b32 v145, 0
  v_mov_b32 v146, 0
  v_mov_b32 v147, 0
  v_mov_b32 v148, 0
  v_mov_b32 v149, 0
  v_mov_b32 v150, 0
  v_mov_b32 v151, 0
  v_mov_b32 v152, 0
  v_mov_b32 v153, 0
  v_mov_b32 v154, 0
  v_mov_b32 v155, 0
  v_mov_b32 v156, 0
  v_mov_b32 v157, 0
  v_mov_b32 v158, 0
  v_mov_b32 v159, 0
  v_mov_b32 v30, 0
  v_mov_b32 v31, 0
  s_waitcnt lgkmcnt(0)
  s_mov_b32 s8, s54
  s_and_b32 s9, s55, 0xffff
  s_mov_b32 s10, 268435456
  s_mov_b32 s11, 0x20000
  s_mov_b32 s20, s52
  s_and_b32 s21, s53, 0xffff
  s_mov_b32 s22, 256
  s_mov_b32 s23, 0x20000
  s_cmp_ge_u32 s25, 8
  s_cbranch_scc1 L_qkv_a_v
  s_barrier
  ds_read_b128 v[176:179], v128 offset:0
  ds_read_b64_tr_b16 v[32:33], v18 offset:0
  ds_read_b64_tr_b16 v[34:35], v18 offset:1024
  ds_read_b64_tr_b16 v[36:37], v19 offset:0
  ds_read_b64_tr_b16 v[38:39], v19 offset:1024
  ds_read_b64_tr_b16 v[40:41], v20 offset:0
  ds_read_b64_tr_b16 v[42:43], v20 offset:1024
  ds_read_b64_tr_b16 v[44:45], v21 offset:0
  ds_read_b64_tr_b16 v[46:47], v21 offset:1024
  s_waitcnt lgkmcnt(8)
  v_dot2_f32_bf16 v140, v176, s60, v140
  v_dot2_f32_bf16 v141, v176, v176, v141
  v_dot2_f32_bf16 v142, v177, s60, v142
  v_dot2_f32_bf16 v143, v177, v177, v143
  v_dot2_f32_bf16 v140, v178, s60, v140
  v_dot2_f32_bf16 v141, v178, v178, v141
  v_dot2_f32_bf16 v142, v179, s60, v142
  v_dot2_f32_bf16 v143, v179, v179, v143
  s_nop 7
  s_waitcnt lgkmcnt(6)
  v_mfma_f32_32x32x16_bf16 v[64:79], v[32:35], v[176:179], v[64:79]
  ds_read_b128 v[180:183], v129 offset:0
  ds_read_b64_tr_b16 v[48:49], v18 offset:4096
  ds_read_b64_tr_b16 v[50:51], v18 offset:5120
  s_waitcnt lgkmcnt(7)
  v_mfma_f32_32x32x16_bf16 v[80:95], v[36:39], v[176:179], v[80:95]
  ds_read_b64_tr_b16 v[52:53], v19 offset:4096
  ds_read_b64_tr_b16 v[54:55], v19 offset:5120
  s_waitcnt lgkmcnt(7)
  v_mfma_f32_32x32x16_bf16 v[96:111], v[40:43], v[176:179], v[96:111]
  ds_read_b64_tr_b16 v[56:57], v20 offset:4096
  ds_read_b64_tr_b16 v[58:59], v20 offset:5120
  s_waitcnt lgkmcnt(7)
  v_mfma_f32_32x32x16_bf16 v[112:127], v[44:47], v[176:179], v[112:127]
  ds_read_b64_tr_b16 v[60:61], v21 offset:4096
  ds_read_b64_tr_b16 v[62:63], v21 offset:5120
  s_waitcnt lgkmcnt(8)
  v_dot2_f32_bf16 v140, v180, s60, v140
  v_dot2_f32_bf16 v141, v180, v180, v141
  v_dot2_f32_bf16 v142, v181, s60, v142
  v_dot2_f32_bf16 v143, v181, v181, v143
  v_dot2_f32_bf16 v140, v182, s60, v140
  v_dot2_f32_bf16 v141, v182, v182, v141
  v_dot2_f32_bf16 v142, v183, s60, v142
  v_dot2_f32_bf16 v143, v183, v183, v143
  s_nop 7
  s_waitcnt lgkmcnt(6)
  v_mfma_f32_32x32x16_bf16 v[64:79], v[48:51], v[180:183], v[64:79]
  ds_read_b128 v[184:187], v130 offset:0
  ds_read_b64_tr_b16 v[32:33], v18 offset:8192
  ds_read_b64_tr_b16 v[34:35], v18 offset:9216
  s_waitcnt lgkmcnt(7)
  v_mfma_f32_32x32x16_bf16 v[80:95], v[52:55], v[180:183], v[80:95]
  ds_read_b64_tr_b16 v[36:37], v19 offset:8192
  ds_read_b64_tr_b16 v[38:39], v19 offset:9216
  s_waitcnt lgkmcnt(7)
  v_mfma_f32_32x32x16_bf16 v[96:111], v[56:59], v[180:183], v[96:111]
  ds_read_b64_tr_b16 v[40:41], v20 offset:8192
  ds_read_b64_tr_b16 v[42:43], v20 offset:9216
  s_waitcnt lgkmcnt(7)
  v_mfma_f32_32x32x16_bf16 v[112:127], v[60:63], v[180:183], v[112:127]
  ds_read_b64_tr_b16 v[44:45], v21 offset:8192
  ds_read_b64_tr_b16 v[46:47], v21 offset:9216
  s_waitcnt lgkmcnt(8)
  v_dot2_f32_bf16 v140, v184, s60, v140
  v_dot2_f32_bf16 v141, v184, v184, v141
  v_dot2_f32_bf16 v142, v185, s60, v142
  v_dot2_f32_bf16 v143, v185, v185, v143
  v_dot2_f32_bf16 v140, v186, s60, v140
  v_dot2_f32_bf16 v141, v186, v186, v141
  v_dot2_f32_bf16 v142, v187, s60, v142
  v_dot2_f32_bf16 v143, v187, v187, v143
  s_nop 7
  s_waitcnt lgkmcnt(6)
  v_mfma_f32_32x32x16_bf16 v[64:79], v[32:35], v[184:187], v[64:79]
  ds_read_b128 v[188:191], v131 offset:0
  ds_read_b64_tr_b16 v[48:49], v18 offset:12288
  ds_read_b64_tr_b16 v[50:51], v18 offset:13312
  s_waitcnt lgkmcnt(7)
  v_mfma_f32_32x32x16_bf16 v[80:95], v[36:39], v[184:187], v[80:95]
  ds_read_b64_tr_b16 v[52:53], v19 offset:12288
  ds_read_b64_tr_b16 v[54:55], v19 offset:13312
  s_waitcnt lgkmcnt(7)
  v_mfma_f32_32x32x16_bf16 v[96:111], v[40:43], v[184:187], v[96:111]
  ds_read_b64_tr_b16 v[56:57], v20 offset:12288
  ds_read_b64_tr_b16 v[58:59], v20 offset:13312
  s_waitcnt lgkmcnt(7)
  v_mfma_f32_32x32x16_bf16 v[112:127], v[44:47], v[184:187], v[112:127]
  ds_read_b64_tr_b16 v[60:61], v21 offset:12288
  ds_read_b64_tr_b16 v[62:63], v21 offset:13312
  s_waitcnt lgkmcnt(8)
  v_dot2_f32_bf16 v140, v188, s60, v140
  v_dot2_f32_bf16 v141, v188, v188, v141
  v_dot2_f32_bf16 v142, v189, s60, v142
  v_dot2_f32_bf16 v143, v189, v189, v143
  v_dot2_f32_bf16 v140, v190, s60, v140
  v_dot2_f32_bf16 v141, v190, v190, v141
  v_dot2_f32_bf16 v142, v191, s60, v142
  v_dot2_f32_bf16 v143, v191, v191, v143
  s_barrier
  s_nop 7
  s_waitcnt lgkmcnt(6)
  v_mfma_f32_32x32x16_bf16 v[64:79], v[48:51], v[188:191], v[64:79]
  ds_read_b128 v[192:195], v128 offset:16384
  ds_read_b64_tr_b16 v[32:33], v18 offset:16384
  ds_read_b64_tr_b16 v[34:35], v18 offset:17408
  s_waitcnt lgkmcnt(7)
  v_mfma_f32_32x32x16_bf16 v[80:95], v[52:55], v[188:191], v[80:95]
  ds_read_b64_tr_b16 v[36:37], v19 offset:16384
  ds_read_b64_tr_b16 v[38:39], v19 offset:17408
  s_waitcnt lgkmcnt(7)
  v_mfma_f32_32x32x16_bf16 v[96:111], v[56:59], v[188:191], v[96:111]
  ds_read_b64_tr_b16 v[40:41], v20 offset:16384
  ds_read_b64_tr_b16 v[42:43], v20 offset:17408
  s_waitcnt lgkmcnt(7)
  v_mfma_f32_32x32x16_bf16 v[112:127], v[60:63], v[188:191], v[112:127]
  ds_read_b64_tr_b16 v[44:45], v21 offset:16384
  ds_read_b64_tr_b16 v[46:47], v21 offset:17408
  s_waitcnt lgkmcnt(8)
  v_dot2_f32_bf16 v140, v192, s60, v140
  v_dot2_f32_bf16 v141, v192, v192, v141
  v_dot2_f32_bf16 v142, v193, s60, v142
  v_dot2_f32_bf16 v143, v193, v193, v143
  v_dot2_f32_bf16 v140, v194, s60, v140
  v_dot2_f32_bf16 v141, v194, v194, v141
  v_dot2_f32_bf16 v142, v195, s60, v142
  v_dot2_f32_bf16 v143, v195, v195, v143
  s_nop 7
  s_waitcnt lgkmcnt(6)
  v_mfma_f32_32x32x16_bf16 v[64:79], v[32:35], v[192:195], v[64:79]
  ds_read_b128 v[196:199], v129 offset:16384
  ds_read_b64_tr_b16 v[48:49], v18 offset:20480
  ds_read_b64_tr_b16 v[50:51], v18 offset:21504
  s_waitcnt lgkmcnt(7)
  v_mfma_f32_32x32x16_bf16 v[80:95], v[36:39], v[192:195], v[80:95]
  ds_read_b64_tr_b16 v[52:53], v19 offset:20480
  ds_read_b64_tr_b16 v[54:55], v19 offset:21504
  s_waitcnt lgkmcnt(7)
  v_mfma_f32_32x32x16_bf16 v[96:111], v[40:43], v[192:195], v[96:111]
  ds_read_b64_tr_b16 v[56:57], v20 offset:20480
  ds_read_b64_tr_b16 v[58:59], v20 offset:21504
  s_waitcnt lgkmcnt(7)
  v_mfma_f32_32x32x16_bf16 v[112:127], v[44:47], v[192:195], v[112:127]
  ds_read_b64_tr_b16 v[60:61], v21 offset:20480
  ds_read_b64_tr_b16 v[62:63], v21 offset:21504
  s_waitcnt lgkmcnt(8)
  v_dot2_f32_bf16 v140, v196, s60, v140
  v_dot2_f32_bf16 v141, v196, v196, v141
  v_dot2_f32_bf16 v142, v197, s60, v142
  v_dot2_f32_bf16 v143, v197, v197, v143
  v_dot2_f32_bf16 v140, v198, s60, v140
  v_dot2_f32_bf16 v141, v198, v198, v141
  v_dot2_f32_bf16 v142, v199, s60, v142
  v_dot2_f32_bf16 v143, v199, v199, v143
  s_nop 7
  s_waitcnt lgkmcnt(6)
  v_mfma_f32_32x32x16_bf16 v[64:79], v[48:51], v[196:199], v[64:79]
  ds_read_b128 v[200:203], v130 offset:16384
  ds_read_b64_tr_b16 v[32:33], v18 offset:24576
  ds_read_b64_tr_b16 v[34:35], v18 offset:25600
  s_waitcnt lgkmcnt(7)
  v_mfma_f32_32x32x16_bf16 v[80:95], v[52:55], v[196:199], v[80:95]
  ds_read_b64_tr_b16 v[36:37], v19 offset:24576
  ds_read_b64_tr_b16 v[38:39], v19 offset:25600
  s_waitcnt lgkmcnt(7)
  v_mfma_f32_32x32x16_bf16 v[96:111], v[56:59], v[196:199], v[96:111]
  ds_read_b64_tr_b16 v[40:41], v20 offset:24576
  ds_read_b64_tr_b16 v[42:43], v20 offset:25600
  s_waitcnt lgkmcnt(7)
  v_mfma_f32_32x32x16_bf16 v[112:127], v[60:63], v[196:199], v[112:127]
  ds_read_b64_tr_b16 v[44:45], v21 offset:24576
  ds_read_b64_tr_b16 v[46:47], v21 offset:25600
  s_waitcnt lgkmcnt(8)
  v_dot2_f32_bf16 v140, v200, s60, v140
  v_dot2_f32_bf16 v141, v200, v200, v141
  v_dot2_f32_bf16 v142, v201, s60, v142
  v_dot2_f32_bf16 v143, v201, v201, v143
  v_dot2_f32_bf16 v140, v202, s60, v140
  v_dot2_f32_bf16 v141, v202, v202, v141
  v_dot2_f32_bf16 v142, v203, s60, v142
  v_dot2_f32_bf16 v143, v203, v203, v143
  s_nop 7
  s_waitcnt lgkmcnt(6)
  v_mfma_f32_32x32x16_bf16 v[64:79], v[32:35], v[200:203], v[64:79]
  ds_read_b128 v[204:207], v131 offset:16384
  ds_read_b64_tr_b16 v[48:49], v18 offset:28672
  ds_read_b64_tr_b16 v[50:51], v18 offset:29696
  s_waitcnt lgkmcnt(7)
  v_mfma_f32_32x32x16_bf16 v[80:95], v[36:39], v[200:203], v[80:95]
  ds_read_b64_tr_b16 v[52:53], v19 offset:28672
  ds_read_b64_tr_b16 v[54:55], v19 offset:29696
  s_waitcnt lgkmcnt(7)
  v_mfma_f32_32x32x16_bf16 v[96:111], v[40:43], v[200:203], v[96:111]
  ds_read_b64_tr_b16 v[56:57], v20 offset:28672
  ds_read_b64_tr_b16 v[58:59], v20 offset:29696
  s_waitcnt lgkmcnt(7)
  v_mfma_f32_32x32x16_bf16 v[112:127], v[44:47], v[200:203], v[112:127]
  ds_read_b64_tr_b16 v[60:61], v21 offset:28672
  ds_read_b64_tr_b16 v[62:63], v21 offset:29696
  s_waitcnt lgkmcnt(8)
  v_dot2_f32_bf16 v140, v204, s60, v140
  v_dot2_f32_bf16 v141, v204, v204, v141
  v_dot2_f32_bf16 v142, v205, s60, v142
  v_dot2_f32_bf16 v143, v205, v205, v143
  v_dot2_f32_bf16 v140, v206, s60, v140
  v_dot2_f32_bf16 v141, v206, v206, v141
  v_dot2_f32_bf16 v142, v207, s60, v142
  v_dot2_f32_bf16 v143, v207, v207, v143
  s_barrier
  s_nop 7
  s_waitcnt lgkmcnt(6)
  v_mfma_f32_32x32x16_bf16 v[64:79], v[48:51], v[204:207], v[64:79]
  ds_read_b128 v[176:179], v128 offset:32768
  ds_read_b64_tr_b16 v[32:33], v18 offset:32768
  ds_read_b64_tr_b16 v[34:35], v18 offset:33792
  s_waitcnt lgkmcnt(7)
  v_mfma_f32_32x32x16_bf16 v[80:95], v[52:55], v[204:207], v[80:95]
  ds_read_b64_tr_b16 v[36:37], v19 offset:32768
  ds_read_b64_tr_b16 v[38:39], v19 offset:33792
  s_waitcnt lgkmcnt(7)
  v_mfma_f32_32x32x16_bf16 v[96:111], v[56:59], v[204:207], v[96:111]
  ds_read_b64_tr_b16 v[40:41], v20 offset:32768
  ds_read_b64_tr_b16 v[42:43], v20 offset:33792
  s_waitcnt lgkmcnt(7)
  v_mfma_f32_32x32x16_bf16 v[112:127], v[60:63], v[204:207], v[112:127]
  ds_read_b64_tr_b16 v[44:45], v21 offset:32768
  ds_read_b64_tr_b16 v[46:47], v21 offset:33792
  s_waitcnt lgkmcnt(8)
  v_dot2_f32_bf16 v140, v176, s60, v140
  v_dot2_f32_bf16 v141, v176, v176, v141
  v_dot2_f32_bf16 v142, v177, s60, v142
  v_dot2_f32_bf16 v143, v177, v177, v143
  v_dot2_f32_bf16 v140, v178, s60, v140
  v_dot2_f32_bf16 v141, v178, v178, v141
  v_dot2_f32_bf16 v142, v179, s60, v142
  v_dot2_f32_bf16 v143, v179, v179, v143
  s_nop 7
  s_waitcnt lgkmcnt(6)
  v_mfma_f32_32x32x16_bf16 v[64:79], v[32:35], v[176:179], v[64:79]
  ds_read_b128 v[180:183], v129 offset:32768
  ds_read_b64_tr_b16 v[48:49], v18 offset:36864
  ds_read_b64_tr_b16 v[50:51], v18 offset:37888
  s_waitcnt lgkmcnt(7)
  v_mfma_f32_32x32x16_bf16 v[80:95], v[36:39], v[176:179], v[80:95]
  ds_read_b64_tr_b16 v[52:53], v19 offset:36864
  ds_read_b64_tr_b16 v[54:55], v19 offset:37888
  s_waitcnt lgkmcnt(7)
  v_mfma_f32_32x32x16_bf16 v[96:111], v[40:43], v[176:179], v[96:111]
  ds_read_b64_tr_b16 v[56:57], v20 offset:36864
  ds_read_b64_tr_b16 v[58:59], v20 offset:37888
  s_waitcnt lgkmcnt(7)
  v_mfma_f32_32x32x16_bf16 v[112:127], v[44:47], v[176:179], v[112:127]
  ds_read_b64_tr_b16 v[60:61], v21 offset:36864
  ds_read_b64_tr_b16 v[62:63], v21 offset:37888
  s_waitcnt lgkmcnt(8)
  v_dot2_f32_bf16 v140, v180, s60, v140
  v_dot2_f32_bf16 v141, v180, v180, v141
  v_dot2_f32_bf16 v142, v181, s60, v142
  v_dot2_f32_bf16 v143, v181, v181, v143
  v_dot2_f32_bf16 v140, v182, s60, v140
  v_dot2_f32_bf16 v141, v182, v182, v141
  v_dot2_f32_bf16 v142, v183, s60, v142
  v_dot2_f32_bf16 v143, v183, v183, v143
  s_nop 7
  s_waitcnt lgkmcnt(6)
  v_mfma_f32_32x32x16_bf16 v[64:79], v[48:51], v[180:183], v[64:79]
  ds_read_b128 v[184:187], v130 offset:32768
  ds_read_b64_tr_b16 v[32:33], v18 offset:40960
  ds_read_b64_tr_b16 v[34:35], v18 offset:41984
  s_waitcnt lgkmcnt(7)
  v_mfma_f32_32x32x16_bf16 v[80:95], v[52:55], v[180:183], v[80:95]
  ds_read_b64_tr_b16 v[36:37], v19 offset:40960
  ds_read_b64_tr_b16 v[38:39], v19 offset:41984
  s_waitcnt lgkmcnt(7)
  v_mfma_f32_32x32x16_bf16 v[96:111], v[56:59], v[180:183], v[96:111]
  ds_read_b64_tr_b16 v[40:41], v20 offset:40960
  ds_read_b64_tr_b16 v[42:43], v20 offset:41984
  s_waitcnt lgkmcnt(7)
  v_mfma_f32_32x32x16_bf16 v[112:127], v[60:63], v[180:183], v[112:127]
  ds_read_b64_tr_b16 v[44:45], v21 offset:40960
  ds_read_b64_tr_b16 v[46:47], v21 offset:41984
  s_waitcnt lgkmcnt(8)
  v_dot2_f32_bf16 v140, v184, s60, v140
  v_dot2_f32_bf16 v141, v184, v184, v141
  v_dot2_f32_bf16 v142, v185, s60, v142
  v_dot2_f32_bf16 v143, v185, v185, v143
  v_dot2_f32_bf16 v140, v186, s60, v140
  v_dot2_f32_bf16 v141, v186, v186, v141
  v_dot2_f32_bf16 v142, v187, s60, v142
  v_dot2_f32_bf16 v143, v187, v187, v143
  s_nop 7
  s_waitcnt lgkmcnt(6)
  v_mfma_f32_32x32x16_bf16 v[64:79], v[32:35], v[184:187], v[64:79]
  ds_read_b128 v[188:191], v131 offset:32768
  ds_read_b64_tr_b16 v[48:49], v18 offset:45056
  ds_read_b64_tr_b16 v[50:51], v18 offset:46080
  s_waitcnt lgkmcnt(7)
  v_mfma_f32_32x32x16_bf16 v[80:95], v[36:39], v[184:187], v[80:95]
  ds_read_b64_tr_b16 v[52:53], v19 offset:45056
  ds_read_b64_tr_b16 v[54:55], v19 offset:46080
  s_waitcnt lgkmcnt(7)
  v_mfma_f32_32x32x16_bf16 v[96:111], v[40:43], v[184:187], v[96:111]
  ds_read_b64_tr_b16 v[56:57], v20 offset:45056
  ds_read_b64_tr_b16 v[58:59], v20 offset:46080
  s_waitcnt lgkmcnt(7)
  v_mfma_f32_32x32x16_bf16 v[112:127], v[44:47], v[184:187], v[112:127]
  ds_read_b64_tr_b16 v[60:61], v21 offset:45056
  ds_read_b64_tr_b16 v[62:63], v21 offset:46080
  s_waitcnt lgkmcnt(8)
  v_dot2_f32_bf16 v140, v188, s60, v140
  v_dot2_f32_bf16 v141, v188, v188, v141
  v_dot2_f32_bf16 v142, v189, s60, v142
  v_dot2_f32_bf16 v143, v189, v189, v143
  v_dot2_f32_bf16 v140, v190, s60, v140
  v_dot2_f32_bf16 v141, v190, v190, v141
  v_dot2_f32_bf16 v142, v191, s60, v142
  v_dot2_f32_bf16 v143, v191, v191, v143
  s_barrier
  s_nop 7
  s_waitcnt lgkmcnt(6)
  v_mfma_f32_32x32x16_bf16 v[64:79], v[48:51], v[188:191], v[64:79]
  ds_read_b128 v[192:195], v128 offset:49152
  ds_read_b64_tr_b16 v[32:33], v18 offset:49152
  ds_read_b64_tr_b16 v[34:35], v18 offset:50176
  s_waitcnt lgkmcnt(7)
  v_mfma_f32_32x32x16_bf16 v[80:95], v[52:55], v[188:191], v[80:95]
  ds_read_b64_tr_b16 v[36:37], v19 offset:49152
  ds_read_b64_tr_b16 v[38:39], v19 offset:50176
  s_waitcnt lgkmcnt(7)
  v_mfma_f32_32x32x16_bf16 v[96:111], v[56:59], v[188:191], v[96:111]
  ds_read_b64_tr_b16 v[40:41], v20 offset:49152
  ds_read_b64_tr_b16 v[42:43], v20 offset:50176
  s_waitcnt lgkmcnt(7)
  v_mfma_f32_32x32x16_bf16 v[112:127], v[60:63], v[188:191], v[112:127]
  ds_read_b64_tr_b16 v[44:45], v21 offset:49152
  ds_read_b64_tr_b16 v[46:47], v21 offset:50176
  s_waitcnt lgkmcnt(8)
  v_dot2_f32_bf16 v140, v192, s60, v140
  v_dot2_f32_bf16 v141, v192, v192, v141
  v_dot2_f32_bf16 v142, v193, s60, v142
  v_dot2_f32_bf16 v143, v193, v193, v143
  v_dot2_f32_bf16 v140, v194, s60, v140
  v_dot2_f32_bf16 v141, v194, v194, v141
  v_dot2_f32_bf16 v142, v195, s60, v142
  v_dot2_f32_bf16 v143, v195, v195, v143
  s_nop 7
  s_waitcnt lgkmcnt(6)
  v_mfma_f32_32x32x16_bf16 v[64:79], v[32:35], v[192:195], v[64:79]
  ds_read_b128 v[196:199], v129 offset:49152
  ds_read_b64_tr_b16 v[48:49], v18 offset:53248
  ds_read_b64_tr_b16 v[50:51], v18 offset:54272
  s_waitcnt lgkmcnt(7)
  v_mfma_f32_32x32x16_bf16 v[80:95], v[36:39], v[192:195], v[80:95]
  ds_read_b64_tr_b16 v[52:53], v19 offset:53248
  ds_read_b64_tr_b16 v[54:55], v19 offset:54272
  s_waitcnt lgkmcnt(7)
  v_mfma_f32_32x32x16_bf16 v[96:111], v[40:43], v[192:195], v[96:111]
  ds_read_b64_tr_b16 v[56:57], v20 offset:53248
  ds_read_b64_tr_b16 v[58:59], v20 offset:54272
  s_waitcnt lgkmcnt(7)
  v_mfma_f32_32x32x16_bf16 v[112:127], v[44:47], v[192:195], v[112:127]
  ds_read_b64_tr_b16 v[60:61], v21 offset:53248
  ds_read_b64_tr_b16 v[62:63], v21 offset:54272
  s_waitcnt lgkmcnt(8)
  v_dot2_f32_bf16 v140, v196, s60, v140
  v_dot2_f32_bf16 v141, v196, v196, v141
  v_dot2_f32_bf16 v142, v197, s60, v142
  v_dot2_f32_bf16 v143, v197, v197, v143
  v_dot2_f32_bf16 v140, v198, s60, v140
  v_dot2_f32_bf16 v141, v198, v198, v141
  v_dot2_f32_bf16 v142, v199, s60, v142
  v_dot2_f32_bf16 v143, v199, v199, v143
  s_nop 7
  s_waitcnt lgkmcnt(6)
  v_mfma_f32_32x32x16_bf16 v[64:79], v[48:51], v[196:199], v[64:79]
  ds_read_b128 v[200:203], v130 offset:49152
  ds_read_b64_tr_b16 v[32:33], v18 offset:57344
  ds_read_b64_tr_b16 v[34:35], v18 offset:58368
  s_waitcnt lgkmcnt(7)
  v_mfma_f32_32x32x16_bf16 v[80:95], v[52:55], v[196:199], v[80:95]
  ds_read_b64_tr_b16 v[36:37], v19 offset:57344
  ds_read_b64_tr_b16 v[38:39], v19 offset:58368
  s_waitcnt lgkmcnt(7)
  v_mfma_f32_32x32x16_bf16 v[96:111], v[56:59], v[196:199], v[96:111]
  ds_read_b64_tr_b16 v[40:41], v20 offset:57344
  ds_read_b64_tr_b16 v[42:43], v20 offset:58368
  s_waitcnt lgkmcnt(7)
  v_mfma_f32_32x32x16_bf16 v[112:127], v[60:63], v[196:199], v[112:127]
  ds_read_b64_tr_b16 v[44:45], v21 offset:57344
  ds_read_b64_tr_b16 v[46:47], v21 offset:58368
  s_waitcnt lgkmcnt(8)
  v_dot2_f32_bf16 v140, v200, s60, v140
  v_dot2_f32_bf16 v141, v200, v200, v141
  v_dot2_f32_bf16 v142, v201, s60, v142
  v_dot2_f32_bf16 v143, v201, v201, v143
  v_dot2_f32_bf16 v140, v202, s60, v140
  v_dot2_f32_bf16 v141, v202, v202, v141
  v_dot2_f32_bf16 v142, v203, s60, v142
  v_dot2_f32_bf16 v143, v203, v203, v143
  s_nop 7
  s_waitcnt lgkmcnt(6)
  v_mfma_f32_32x32x16_bf16 v[64:79], v[32:35], v[200:203], v[64:79]
  ds_read_b128 v[204:207], v131 offset:49152
  ds_read_b64_tr_b16 v[48:49], v18 offset:61440
  ds_read_b64_tr_b16 v[50:51], v18 offset:62464
  s_waitcnt lgkmcnt(7)
  v_mfma_f32_32x32x16_bf16 v[80:95], v[36:39], v[200:203], v[80:95]
  ds_read_b64_tr_b16 v[52:53], v19 offset:61440
  ds_read_b64_tr_b16 v[54:55], v19 offset:62464
  s_waitcnt lgkmcnt(7)
  v_mfma_f32_32x32x16_bf16 v[96:111], v[40:43], v[200:203], v[96:111]
  ds_read_b64_tr_b16 v[56:57], v20 offset:61440
  ds_read_b64_tr_b16 v[58:59], v20 offset:62464
  s_waitcnt lgkmcnt(7)
  v_mfma_f32_32x32x16_bf16 v[112:127], v[44:47], v[200:203], v[112:127]
  ds_read_b64_tr_b16 v[60:61], v21 offset:61440
  ds_read_b64_tr_b16 v[62:63], v21 offset:62464
  s_waitcnt lgkmcnt(8)
  v_dot2_f32_bf16 v140, v204, s60, v140
  v_dot2_f32_bf16 v141, v204, v204, v141
  v_dot2_f32_bf16 v142, v205, s60, v142
  v_dot2_f32_bf16 v143, v205, v205, v143
  v_dot2_f32_bf16 v140, v206, s60, v140
  v_dot2_f32_bf16 v141, v206, v206, v141
  v_dot2_f32_bf16 v142, v207, s60, v142
  v_dot2_f32_bf16 v143, v207, v207, v143
  s_barrier
  s_nop 7
  v_add_u32 v18, 65536, v18
  v_add_u32 v128, 65536, v128
  v_add_u32 v19, 65536, v19
  v_add_u32 v129, 65536, v129
  v_add_u32 v20, 65536, v20
  v_add_u32 v130, 65536, v130
  v_add_u32 v21, 65536, v21
  v_add_u32 v131, 65536, v131
  s_waitcnt lgkmcnt(6)
  v_mfma_f32_32x32x16_bf16 v[64:79], v[48:51], v[204:207], v[64:79]
  ds_read_b128 v[176:179], v128 offset:0
  ds_read_b64_tr_b16 v[32:33], v18 offset:0
  ds_read_b64_tr_b16 v[34:35], v18 offset:1024
  s_waitcnt lgkmcnt(7)
  v_mfma_f32_32x32x16_bf16 v[80:95], v[52:55], v[204:207], v[80:95]
  ds_read_b64_tr_b16 v[36:37], v19 offset:0
  ds_read_b64_tr_b16 v[38:39], v19 offset:1024
  s_waitcnt lgkmcnt(7)
  v_mfma_f32_32x32x16_bf16 v[96:111], v[56:59], v[204:207], v[96:111]
  ds_read_b64_tr_b16 v[40:41], v20 offset:0
  ds_read_b64_tr_b16 v[42:43], v20 offset:1024
  s_waitcnt lgkmcnt(7)
  v_mfma_f32_32x32x16_bf16 v[112:127], v[60:63], v[204:207], v[112:127]
  ds_read_b64_tr_b16 v[44:45], v21 offset:0
  ds_read_b64_tr_b16 v[46:47], v21 offset:1024
  s_waitcnt lgkmcnt(8)
  v_dot2_f32_bf16 v140, v176, s60, v140
  v_dot2_f32_bf16 v141, v176, v176, v141
  v_dot2_f32_bf16 v142, v177, s60, v142
  v_dot2_f32_bf16 v143, v177, v177, v143
  v_dot2_f32_bf16 v140, v178, s60, v140
  v_dot2_f32_bf16 v141, v178, v178, v141
  v_dot2_f32_bf16 v142, v179, s60, v142
  v_dot2_f32_bf16 v143, v179, v179, v143
  s_waitcnt lgkmcnt(6)
  v_mfma_f32_32x32x16_bf16 v[64:79], v[32:35], v[176:179], v[64:79]
  ds_read_b128 v[180:183], v129 offset:0
  ds_read_b64_tr_b16 v[48:49], v18 offset:4096
  ds_read_b64_tr_b16 v[50:51], v18 offset:5120
  s_waitcnt lgkmcnt(7)
  v_mfma_f32_32x32x16_bf16 v[80:95], v[36:39], v[176:179], v[80:95]
  ds_read_b64_tr_b16 v[52:53], v19 offset:4096
  ds_read_b64_tr_b16 v[54:55], v19 offset:5120
  s_waitcnt lgkmcnt(7)
  v_mfma_f32_32x32x16_bf16 v[96:111], v[40:43], v[176:179], v[96:111]
  ds_read_b64_tr_b16 v[56:57], v20 offset:4096
  ds_read_b64_tr_b16 v[58:59], v20 offset:5120
  s_waitcnt lgkmcnt(7)
  v_mfma_f32_32x32x16_bf16 v[112:127], v[44:47], v[176:179], v[112:127]
  ds_read_b64_tr_b16 v[60:61], v21 offset:4096
  ds_read_b64_tr_b16 v[62:63], v21 offset:5120
  s_waitcnt lgkmcnt(8)
  v_dot2_f32_bf16 v140, v180, s60, v140
  v_dot2_f32_bf16 v141, v180, v180, v141
  v_dot2_f32_bf16 v142, v181, s60, v142
  v_dot2_f32_bf16 v143, v181, v181, v143
  v_dot2_f32_bf16 v140, v182, s60, v140
  v_dot2_f32_bf16 v141, v182, v182, v141
  v_dot2_f32_bf16 v142, v183, s60, v142
  v_dot2_f32_bf16 v143, v183, v183, v143
  s_waitcnt lgkmcnt(6)
  v_mfma_f32_32x32x16_bf16 v[64:79], v[48:51], v[180:183], v[64:79]
  ds_read_b128 v[184:187], v130 offset:0
  ds_read_b64_tr_b16 v[32:33], v18 offset:8192
  ds_read_b64_tr_b16 v[34:35], v18 offset:9216
  s_waitcnt lgkmcnt(7)
  v_mfma_f32_32x32x16_bf16 v[80:95], v[52:55], v[180:183], v[80:95]
  ds_read_b64_tr_b16 v[36:37], v19 offset:8192
  ds_read_b64_tr_b16 v[38:39], v19 offset:9216
  s_waitcnt lgkmcnt(7)
  v_mfma_f32_32x32x16_bf16 v[96:111], v[56:59], v[180:183], v[96:111]
  ds_read_b64_tr_b16 v[40:41], v20 offset:8192
  ds_read_b64_tr_b16 v[42:43], v20 offset:9216
  s_waitcnt lgkmcnt(7)
  v_mfma_f32_32x32x16_bf16 v[112:127], v[60:63], v[180:183], v[112:127]
  ds_read_b64_tr_b16 v[44:45], v21 offset:8192
  ds_read_b64_tr_b16 v[46:47], v21 offset:9216
  s_waitcnt lgkmcnt(8)
  v_dot2_f32_bf16 v140, v184, s60, v140
  v_dot2_f32_bf16 v141, v184, v184, v141
  v_dot2_f32_bf16 v142, v185, s60, v142
  v_dot2_f32_bf16 v143, v185, v185, v143
  v_dot2_f32_bf16 v140, v186, s60, v140
  v_dot2_f32_bf16 v141, v186, v186, v141
  v_dot2_f32_bf16 v142, v187, s60, v142
  v_dot2_f32_bf16 v143, v187, v187, v143
  s_waitcnt lgkmcnt(6)
  v_mfma_f32_32x32x16_bf16 v[64:79], v[32:35], v[184:187], v[64:79]
  ds_read_b128 v[188:191], v131 offset:0
  ds_read_b64_tr_b16 v[48:49], v18 offset:12288
  ds_read_b64_tr_b16 v[50:51], v18 offset:13312
  s_waitcnt lgkmcnt(7)
  v_mfma_f32_32x32x16_bf16 v[80:95], v[36:39], v[184:187], v[80:95]
  ds_read_b64_tr_b16 v[52:53], v19 offset:12288
  ds_read_b64_tr_b16 v[54:55], v19 offset:13312
  s_waitcnt lgkmcnt(7)
  v_mfma_f32_32x32x16_bf16 v[96:111], v[40:43], v[184:187], v[96:111]
  ds_read_b64_tr_b16 v[56:57], v20 offset:12288
  ds_read_b64_tr_b16 v[58:59], v20 offset:13312
  s_waitcnt lgkmcnt(7)
  v_mfma_f32_32x32x16_bf16 v[112:127], v[44:47], v[184:187], v[112:127]
  ds_read_b64_tr_b16 v[60:61], v21 offset:12288
  ds_read_b64_tr_b16 v[62:63], v21 offset:13312
  s_waitcnt lgkmcnt(8)
  v_dot2_f32_bf16 v140, v188, s60, v140
  v_dot2_f32_bf16 v141, v188, v188, v141
  v_dot2_f32_bf16 v142, v189, s60, v142
  v_dot2_f32_bf16 v143, v189, v189, v143
  v_dot2_f32_bf16 v140, v190, s60, v140
  v_dot2_f32_bf16 v141, v190, v190, v141
  v_dot2_f32_bf16 v142, v191, s60, v142
  v_dot2_f32_bf16 v143, v191, v191, v143
  s_barrier
  v_subrev_u32 v18, 65536, v18
  v_subrev_u32 v128, 65536, v128
  v_subrev_u32 v19, 65536, v19
  v_subrev_u32 v129, 65536, v129
  v_subrev_u32 v20, 65536, v20
  v_subrev_u32 v130, 65536, v130
  v_subrev_u32 v21, 65536, v21
  v_subrev_u32 v131, 65536, v131
  s_waitcnt lgkmcnt(6)
  v_mfma_f32_32x32x16_bf16 v[64:79], v[48:51], v[188:191], v[64:79]
  ds_read_b128 v[192:195], v128 offset:0
  ds_read_b64_tr_b16 v[32:33], v18 offset:0
  ds_read_b64_tr_b16 v[34:35], v18 offset:1024
  s_waitcnt lgkmcnt(7)
  v_mfma_f32_32x32x16_bf16 v[80:95], v[52:55], v[188:191], v[80:95]
  ds_read_b64_tr_b16 v[36:37], v19 offset:0
  ds_read_b64_tr_b16 v[38:39], v19 offset:1024
  s_waitcnt lgkmcnt(7)
  v_mfma_f32_32x32x16_bf16 v[96:111], v[56:59], v[188:191], v[96:111]
  ds_read_b64_tr_b16 v[40:41], v20 offset:0
  ds_read_b64_tr_b16 v[42:43], v20 offset:1024
  s_waitcnt lgkmcnt(7)
  v_mfma_f32_32x32x16_bf16 v[112:127], v[60:63], v[188:191], v[112:127]
  ds_read_b64_tr_b16 v[44:45], v21 offset:0
  ds_read_b64_tr_b16 v[46:47], v21 offset:1024
  s_waitcnt lgkmcnt(8)
  v_dot2_f32_bf16 v140, v192, s60, v140
  v_dot2_f32_bf16 v141, v192, v192, v141
  v_dot2_f32_bf16 v142, v193, s60, v142
  v_dot2_f32_bf16 v143, v193, v193, v143
  v_dot2_f32_bf16 v140, v194, s60, v140
  v_dot2_f32_bf16 v141, v194, v194, v141
  v_dot2_f32_bf16 v142, v195, s60, v142
  v_dot2_f32_bf16 v143, v195, v195, v143
  s_waitcnt lgkmcnt(6)
  v_mfma_f32_32x32x16_bf16 v[64:79], v[32:35], v[192:195], v[64:79]
  ds_read_b128 v[196:199], v129 offset:0
  ds_read_b64_tr_b16 v[48:49], v18 offset:4096
  ds_read_b64_tr_b16 v[50:51], v18 offset:5120
  s_waitcnt lgkmcnt(7)
  v_mfma_f32_32x32x16_bf16 v[80:95], v[36:39], v[192:195], v[80:95]
  ds_read_b64_tr_b16 v[52:53], v19 offset:4096
  ds_read_b64_tr_b16 v[54:55], v19 offset:5120
  s_waitcnt lgkmcnt(7)
  v_mfma_f32_32x32x16_bf16 v[96:111], v[40:43], v[192:195], v[96:111]
  ds_read_b64_tr_b16 v[56:57], v20 offset:4096
  ds_read_b64_tr_b16 v[58:59], v20 offset:5120
  s_waitcnt lgkmcnt(7)
  v_mfma_f32_32x32x16_bf16 v[112:127], v[44:47], v[192:195], v[112:127]
  ds_read_b64_tr_b16 v[60:61], v21 offset:4096
  ds_read_b64_tr_b16 v[62:63], v21 offset:5120
  s_waitcnt lgkmcnt(8)
  v_dot2_f32_bf16 v140, v196, s60, v140
  v_dot2_f32_bf16 v141, v196, v196, v141
  v_dot2_f32_bf16 v142, v197, s60, v142
  v_dot2_f32_bf16 v143, v197, v197, v143
  v_dot2_f32_bf16 v140, v198, s60, v140
  v_dot2_f32_bf16 v141, v198, v198, v141
  v_dot2_f32_bf16 v142, v199, s60, v142
  v_dot2_f32_bf16 v143, v199, v199, v143
  s_waitcnt lgkmcnt(6)
  v_mfma_f32_32x32x16_bf16 v[64:79], v[48:51], v[196:199], v[64:79]
  ds_read_b128 v[200:203], v130 offset:0
  ds_read_b64_tr_b16 v[32:33], v18 offset:8192
  ds_read_b64_tr_b16 v[34:35], v18 offset:9216
  s_waitcnt lgkmcnt(7)
  v_mfma_f32_32x32x16_bf16 v[80:95], v[52:55], v[196:199], v[80:95]
  ds_read_b64_tr_b16 v[36:37], v19 offset:8192
  ds_read_b64_tr_b16 v[38:39], v19 offset:9216
  s_waitcnt lgkmcnt(7)
  v_mfma_f32_32x32x16_bf16 v[96:111], v[56:59], v[196:199], v[96:111]
  ds_read_b64_tr_b16 v[40:41], v20 offset:8192
  ds_read_b64_tr_b16 v[42:43], v20 offset:9216
  s_waitcnt lgkmcnt(7)
  v_mfma_f32_32x32x16_bf16 v[112:127], v[60:63], v[196:199], v[112:127]
  ds_read_b64_tr_b16 v[44:45], v21 offset:8192
  ds_read_b64_tr_b16 v[46:47], v21 offset:9216
  s_waitcnt lgkmcnt(8)
  v_dot2_f32_bf16 v140, v200, s60, v140
  v_dot2_f32_bf16 v141, v200, v200, v141
  v_dot2_f32_bf16 v142, v201, s60, v142
  v_dot2_f32_bf16 v143, v201, v201, v143
  v_dot2_f32_bf16 v140, v202, s60, v140
  v_dot2_f32_bf16 v141, v202, v202, v141
  v_dot2_f32_bf16 v142, v203, s60, v142
  v_dot2_f32_bf16 v143, v203, v203, v143
  s_waitcnt lgkmcnt(6)
  v_mfma_f32_32x32x16_bf16 v[64:79], v[32:35], v[200:203], v[64:79]
  ds_read_b128 v[204:207], v131 offset:0
  ds_read_b64_tr_b16 v[48:49], v18 offset:12288
  ds_read_b64_tr_b16 v[50:51], v18 offset:13312
  s_waitcnt lgkmcnt(7)
  v_mfma_f32_32x32x16_bf16 v[80:95], v[36:39], v[200:203], v[80:95]
  ds_read_b64_tr_b16 v[52:53], v19 offset:12288
  ds_read_b64_tr_b16 v[54:55], v19 offset:13312
  s_waitcnt lgkmcnt(7)
  v_mfma_f32_32x32x16_bf16 v[96:111], v[40:43], v[200:203], v[96:111]
  ds_read_b64_tr_b16 v[56:57], v20 offset:12288
  ds_read_b64_tr_b16 v[58:59], v20 offset:13312
  s_waitcnt lgkmcnt(7)
  v_mfma_f32_32x32x16_bf16 v[112:127], v[44:47], v[200:203], v[112:127]
  ds_read_b64_tr_b16 v[60:61], v21 offset:12288
  ds_read_b64_tr_b16 v[62:63], v21 offset:13312
  s_waitcnt lgkmcnt(8)
  v_dot2_f32_bf16 v140, v204, s60, v140
  v_dot2_f32_bf16 v141, v204, v204, v141
  v_dot2_f32_bf16 v142, v205, s60, v142
  v_dot2_f32_bf16 v143, v205, v205, v143
  v_dot2_f32_bf16 v140, v206, s60, v140
  v_dot2_f32_bf16 v141, v206, v206, v141
  v_dot2_f32_bf16 v142, v207, s60, v142
  v_dot2_f32_bf16 v143, v207, v207, v143
  s_barrier
  s_waitcnt lgkmcnt(6)
  v_mfma_f32_32x32x16_bf16 v[64:79], v[48:51], v[204:207], v[64:79]
  ds_read_b128 v[176:179], v128 offset:16384
  ds_read_b64_tr_b16 v[32:33], v18 offset:16384
  ds_read_b64_tr_b16 v[34:35], v18 offset:17408
  s_waitcnt lgkmcnt(7)
  v_mfma_f32_32x32x16_bf16 v[80:95], v[52:55], v[204:207], v[80:95]
  ds_read_b64_tr_b16 v[36:37], v19 offset:16384
  ds_read_b64_tr_b16 v[38:39], v19 offset:17408
  s_waitcnt lgkmcnt(7)
  v_mfma_f32_32x32x16_bf16 v[96:111], v[56:59], v[204:207], v[96:111]
  ds_read_b64_tr_b16 v[40:41], v20 offset:16384
  ds_read_b64_tr_b16 v[42:43], v20 offset:17408
  s_waitcnt lgkmcnt(7)
  v_mfma_f32_32x32x16_bf16 v[112:127], v[60:63], v[204:207], v[112:127]
  ds_read_b64_tr_b16 v[44:45], v21 offset:16384
  ds_read_b64_tr_b16 v[46:47], v21 offset:17408
  s_waitcnt lgkmcnt(8)
  v_dot2_f32_bf16 v140, v176, s60, v140
  v_dot2_f32_bf16 v141, v176, v176, v141
  v_dot2_f32_bf16 v142, v177, s60, v142
  v_dot2_f32_bf16 v143, v177, v177, v143
  v_dot2_f32_bf16 v140, v178, s60, v140
  v_dot2_f32_bf16 v141, v178, v178, v141
  v_dot2_f32_bf16 v142, v179, s60, v142
  v_dot2_f32_bf16 v143, v179, v179, v143
  buffer_load_dwordx3 v[208:210], off, s[20:23], 0 sc1
  s_waitcnt lgkmcnt(6)
  v_mfma_f32_32x32x16_bf16 v[64:79], v[32:35], v[176:179], v[64:79]
  ds_read_b128 v[180:183], v129 offset:16384
  ds_read_b64_tr_b16 v[48:49], v18 offset:20480
  ds_read_b64_tr_b16 v[50:51], v18 offset:21504
  s_waitcnt lgkmcnt(7)
  v_mfma_f32_32x32x16_bf16 v[80:95], v[36:39], v[176:179], v[80:95]
  ds_read_b64_tr_b16 v[52:53], v19 offset:20480
  ds_read_b64_tr_b16 v[54:55], v19 offset:21504
  s_waitcnt lgkmcnt(7)
  v_mfma_f32_32x32x16_bf16 v[96:111], v[40:43], v[176:179], v[96:111]
  ds_read_b64_tr_b16 v[56:57], v20 offset:20480
  ds_read_b64_tr_b16 v[58:59], v20 offset:21504
  s_waitcnt lgkmcnt(7)
  v_mfma_f32_32x32x16_bf16 v[112:127], v[44:47], v[176:179], v[112:127]
  ds_read_b64_tr_b16 v[60:61], v21 offset:20480
  ds_read_b64_tr_b16 v[62:63], v21 offset:21504
  s_waitcnt lgkmcnt(8)
  v_dot2_f32_bf16 v140, v180, s60, v140
  v_dot2_f32_bf16 v141, v180, v180, v141
  v_dot2_f32_bf16 v142, v181, s60, v142
  v_dot2_f32_bf16 v143, v181, v181, v143
  v_dot2_f32_bf16 v140, v182, s60, v140
  v_dot2_f32_bf16 v141, v182, v182, v141
  v_dot2_f32_bf16 v142, v183, s60, v142
  v_dot2_f32_bf16 v143, v183, v183, v143
  s_waitcnt lgkmcnt(6)
  v_mfma_f32_32x32x16_bf16 v[64:79], v[48:51], v[180:183], v[64:79]
  ds_read_b128 v[184:187], v130 offset:16384
  ds_read_b64_tr_b16 v[32:33], v18 offset:24576
  ds_read_b64_tr_b16 v[34:35], v18 offset:25600
  s_waitcnt lgkmcnt(7)
  v_mfma_f32_32x32x16_bf16 v[80:95], v[52:55], v[180:183], v[80:95]
  ds_read_b64_tr_b16 v[36:37], v19 offset:24576
  ds_read_b64_tr_b16 v[38:39], v19 offset:25600
  s_waitcnt lgkmcnt(7)
  v_mfma_f32_32x32x16_bf16 v[96:111], v[56:59], v[180:183], v[96:111]
  ds_read_b64_tr_b16 v[40:41], v20 offset:24576
  ds_read_b64_tr_b16 v[42:43], v20 offset:25600
  s_waitcnt lgkmcnt(7)
  v_mfma_f32_32x32x16_bf16 v[112:127], v[60:63], v[180:183], v[112:127]
  ds_read_b64_tr_b16 v[44:45], v21 offset:24576
  ds_read_b64_tr_b16 v[46:47], v21 offset:25600
  s_waitcnt lgkmcnt(8)
  v_dot2_f32_bf16 v140, v184, s60, v140
  v_dot2_f32_bf16 v141, v184, v184, v141
  v_dot2_f32_bf16 v142, v185, s60, v142
  v_dot2_f32_bf16 v143, v185, v185, v143
  v_dot2_f32_bf16 v140, v186, s60, v140
  v_dot2_f32_bf16 v141, v186, v186, v141
  v_dot2_f32_bf16 v142, v187, s60, v142
  v_dot2_f32_bf16 v143, v187, v187, v143
  s_waitcnt lgkmcnt(6)
  v_mfma_f32_32x32x16_bf16 v[64:79], v[32:35], v[184:187], v[64:79]
  ds_read_b128 v[188:191], v131 offset:16384
  ds_read_b64_tr_b16 v[48:49], v18 offset:28672
  ds_read_b64_tr_b16 v[50:51], v18 offset:29696
  s_waitcnt lgkmcnt(7)
  v_mfma_f32_32x32x16_bf16 v[80:95], v[36:39], v[184:187], v[80:95]
  ds_read_b64_tr_b16 v[52:53], v19 offset:28672
  ds_read_b64_tr_b16 v[54:55], v19 offset:29696
  s_waitcnt lgkmcnt(7)
  v_mfma_f32_32x32x16_bf16 v[96:111], v[40:43], v[184:187], v[96:111]
  ds_read_b64_tr_b16 v[56:57], v20 offset:28672
  ds_read_b64_tr_b16 v[58:59], v20 offset:29696
  s_waitcnt lgkmcnt(7)
  v_mfma_f32_32x32x16_bf16 v[112:127], v[44:47], v[184:187], v[112:127]
  ds_read_b64_tr_b16 v[60:61], v21 offset:28672
  ds_read_b64_tr_b16 v[62:63], v21 offset:29696
  s_waitcnt lgkmcnt(8)
  v_dot2_f32_bf16 v140, v188, s60, v140
  v_dot2_f32_bf16 v141, v188, v188, v141
  v_dot2_f32_bf16 v142, v189, s60, v142
  v_dot2_f32_bf16 v143, v189, v189, v143
  v_dot2_f32_bf16 v140, v190, s60, v140
  v_dot2_f32_bf16 v141, v190, v190, v141
  v_dot2_f32_bf16 v142, v191, s60, v142
  v_dot2_f32_bf16 v143, v191, v191, v143
  s_barrier
  s_waitcnt lgkmcnt(6)
  v_mfma_f32_32x32x16_bf16 v[64:79], v[48:51], v[188:191], v[64:79]
  ds_read_b128 v[192:195], v128 offset:32768
  ds_read_b64_tr_b16 v[32:33], v18 offset:32768
  ds_read_b64_tr_b16 v[34:35], v18 offset:33792
  s_waitcnt lgkmcnt(7)
  v_mfma_f32_32x32x16_bf16 v[80:95], v[52:55], v[188:191], v[80:95]
  ds_read_b64_tr_b16 v[36:37], v19 offset:32768
  ds_read_b64_tr_b16 v[38:39], v19 offset:33792
  s_waitcnt lgkmcnt(7)
  v_mfma_f32_32x32x16_bf16 v[96:111], v[56:59], v[188:191], v[96:111]
  ds_read_b64_tr_b16 v[40:41], v20 offset:32768
  ds_read_b64_tr_b16 v[42:43], v20 offset:33792
  s_waitcnt lgkmcnt(7)
  v_mfma_f32_32x32x16_bf16 v[112:127], v[60:63], v[188:191], v[112:127]
  ds_read_b64_tr_b16 v[44:45], v21 offset:32768
  ds_read_b64_tr_b16 v[46:47], v21 offset:33792
  s_waitcnt lgkmcnt(8)
  v_dot2_f32_bf16 v140, v192, s60, v140
  v_dot2_f32_bf16 v141, v192, v192, v141
  v_dot2_f32_bf16 v142, v193, s60, v142
  v_dot2_f32_bf16 v143, v193, v193, v143
  v_dot2_f32_bf16 v140, v194, s60, v140
  v_dot2_f32_bf16 v141, v194, v194, v141
  v_dot2_f32_bf16 v142, v195, s60, v142
  v_dot2_f32_bf16 v143, v195, v195, v143
  s_waitcnt lgkmcnt(6)
  v_mfma_f32_32x32x16_bf16 v[64:79], v[32:35], v[192:195], v[64:79]
  ds_read_b128 v[196:199], v129 offset:32768
  ds_read_b64_tr_b16 v[48:49], v18 offset:36864
  ds_read_b64_tr_b16 v[50:51], v18 offset:37888
  s_waitcnt lgkmcnt(7)
  v_mfma_f32_32x32x16_bf16 v[80:95], v[36:39], v[192:195], v[80:95]
  ds_read_b64_tr_b16 v[52:53], v19 offset:36864
  ds_read_b64_tr_b16 v[54:55], v19 offset:37888
  s_waitcnt lgkmcnt(7)
  v_mfma_f32_32x32x16_bf16 v[96:111], v[40:43], v[192:195], v[96:111]
  ds_read_b64_tr_b16 v[56:57], v20 offset:36864
  ds_read_b64_tr_b16 v[58:59], v20 offset:37888
  s_waitcnt lgkmcnt(7)
  v_mfma_f32_32x32x16_bf16 v[112:127], v[44:47], v[192:195], v[112:127]
  ds_read_b64_tr_b16 v[60:61], v21 offset:36864
  ds_read_b64_tr_b16 v[62:63], v21 offset:37888
  s_waitcnt lgkmcnt(8)
  v_dot2_f32_bf16 v140, v196, s60, v140
  v_dot2_f32_bf16 v141, v196, v196, v141
  v_dot2_f32_bf16 v142, v197, s60, v142
  v_dot2_f32_bf16 v143, v197, v197, v143
  v_dot2_f32_bf16 v140, v198, s60, v140
  v_dot2_f32_bf16 v141, v198, v198, v141
  v_dot2_f32_bf16 v142, v199, s60, v142
  v_dot2_f32_bf16 v143, v199, v199, v143
  s_waitcnt lgkmcnt(6)
  v_mfma_f32_32x32x16_bf16 v[64:79], v[48:51], v[196:199], v[64:79]
  ds_read_b128 v[200:203], v130 offset:32768
  ds_read_b64_tr_b16 v[32:33], v18 offset:40960
  ds_read_b64_tr_b16 v[34:35], v18 offset:41984
  s_waitcnt lgkmcnt(7)
  v_mfma_f32_32x32x16_bf16 v[80:95], v[52:55], v[196:199], v[80:95]
  ds_read_b64_tr_b16 v[36:37], v19 offset:40960
  ds_read_b64_tr_b16 v[38:39], v19 offset:41984
  s_waitcnt lgkmcnt(7)
  v_mfma_f32_32x32x16_bf16 v[96:111], v[56:59], v[196:199], v[96:111]
  ds_read_b64_tr_b16 v[40:41], v20 offset:40960
  ds_read_b64_tr_b16 v[42:43], v20 offset:41984
  s_waitcnt lgkmcnt(7)
  v_mfma_f32_32x32x16_bf16 v[112:127], v[60:63], v[196:199], v[112:127]
  ds_read_b64_tr_b16 v[44:45], v21 offset:40960
  ds_read_b64_tr_b16 v[46:47], v21 offset:41984
  s_waitcnt lgkmcnt(8)
  v_dot2_f32_bf16 v140, v200, s60, v140
  v_dot2_f32_bf16 v141, v200, v200, v141
  v_dot2_f32_bf16 v142, v201, s60, v142
  v_dot2_f32_bf16 v143, v201, v201, v143
  v_dot2_f32_bf16 v140, v202, s60, v140
  v_dot2_f32_bf16 v141, v202, v202, v141
  v_dot2_f32_bf16 v142, v203, s60, v142
  v_dot2_f32_bf16 v143, v203, v203, v143
  s_waitcnt lgkmcnt(6)
  v_mfma_f32_32x32x16_bf16 v[64:79], v[32:35], v[200:203], v[64:79]
  ds_read_b128 v[204:207], v131 offset:32768
  ds_read_b64_tr_b16 v[48:49], v18 offset:45056
  ds_read_b64_tr_b16 v[50:51], v18 offset:46080
  s_waitcnt lgkmcnt(7)
  v_mfma_f32_32x32x16_bf16 v[80:95], v[36:39], v[200:203], v[80:95]
  ds_read_b64_tr_b16 v[52:53], v19 offset:45056
  ds_read_b64_tr_b16 v[54:55], v19 offset:46080
  s_waitcnt lgkmcnt(7)
  v_mfma_f32_32x32x16_bf16 v[96:111], v[40:43], v[200:203], v[96:111]
  ds_read_b64_tr_b16 v[56:57], v20 offset:45056
  ds_read_b64_tr_b16 v[58:59], v20 offset:46080
  s_waitcnt lgkmcnt(7)
  v_mfma_f32_32x32x16_bf16 v[112:127], v[44:47], v[200:203], v[112:127]
  ds_read_b64_tr_b16 v[60:61], v21 offset:45056
  ds_read_b64_tr_b16 v[62:63], v21 offset:46080
  s_waitcnt lgkmcnt(8)
  v_dot2_f32_bf16 v140, v204, s60, v140
  v_dot2_f32_bf16 v141, v204, v204, v141
  v_dot2_f32_bf16 v142, v205, s60, v142
  v_dot2_f32_bf16 v143, v205, v205, v143
  v_dot2_f32_bf16 v140, v206, s60, v140
  v_dot2_f32_bf16 v141, v206, v206, v141
  v_dot2_f32_bf16 v142, v207, s60, v142
  v_dot2_f32_bf16 v143, v207, v207, v143
  s_barrier
  s_waitcnt lgkmcnt(6)
  v_mfma_f32_32x32x16_bf16 v[64:79], v[48:51], v[204:207], v[64:79]
  ds_read_b64 v[144:145], v10 offset:0
  ds_read_b64 v[148:149], v10 offset:256
  ds_read_b64 v[152:153], v10 offset:512
  s_waitcnt lgkmcnt(7)
  v_mfma_f32_32x32x16_bf16 v[80:95], v[52:55], v[204:207], v[80:95]
  ds_read_b64 v[156:157], v10 offset:768
  s_waitcnt lgkmcnt(6)
  v_mfma_f32_32x32x16_bf16 v[96:111], v[56:59], v[204:207], v[96:111]
  s_waitcnt lgkmcnt(4)
  v_mfma_f32_32x32x16_bf16 v[112:127], v[60:63], v[204:207], v[112:127]
  s_nop 2
  v_add_f32 v2, v140, v142
  v_add_f32 v3, v141, v143
  v_mov_b32 v4, v2
  v_mov_b32 v5, v3
  s_nop 1
  v_permlane32_swap_b32 v2, v4
  v_permlane32_swap_b32 v3, v5
  s_nop 1
  v_add_f32 v2, v2, v4
  v_add_f32 v3, v3, v5
  v_mul_f32 v2, 0xbb000000, v2
  v_mul_f32 v3, 0x3b000000, v3
  v_cvt_pk_bf16_f32 v4, v2, v2
  v_and_b32 v4, 0xffff0000, v4
  v_sub_f32 v4, v2, v4
  v_cvt_pk_bf16_f32 v4, v2, v4
  v_cndmask_b32_e64 v28, 0, v4, s[90:91]
  v_cndmask_b32_e64 v29, 0, v4, s[90:91]
  v_fma_f32 v3, -v2, v2, v3
  s_waitcnt lgkmcnt(0)
  v_mfma_f32_32x32x16_bf16 v[64:79], v[144:147], v[28:31], v[64:79]
  v_max_f32 v3, 0, v3
  v_add_f32 v3, 0x3727c5ac, v3
  v_rsq_f32 v6, v3
  s_nop 0
  v_mul_f32 v22, s92, v6
  v_mfma_f32_32x32x16_bf16 v[80:95], v[148:151], v[28:31], v[80:95]
  v_mfma_f32_32x32x16_bf16 v[96:111], v[152:155], v[28:31], v[96:111]
  v_mfma_f32_32x32x16_bf16 v[112:127], v[156:159], v[28:31], v[112:127]
  s_waitcnt vmcnt(0) lgkmcnt(0)
  s_mov_b32 s33, 0
L_tok_1:
  v_readfirstlane_b32 s76, v208
  v_readfirstlane_b32 s77, v209
  v_readfirstlane_b32 s101, v210
  s_and_b32 s62, s76, s101
  s_and_b32 s62, s62, 1
  s_cbranch_scc1 L_tokd_2
  s_add_u32 s33, s33, 1
  s_cmp_gt_u32 s33, 16384
  s_cbranch_scc1 L_tokd_2
  s_sleep 2
  buffer_load_dwordx3 v[208:210], off, s[20:23], 0 sc1
  s_waitcnt vmcnt(0)
  s_branch L_tok_1
L_tokd_2:
  s_xor_b32 s94, s101, s6
  s_and_b32 s94, s94, 4
  s_lshl_b32 s94, s94, 11
  s_add_u32 s84, s84, s94
  s_add_u32 s85, s84, 4096
  s_nop 7
  v_pk_mul_f32 v[64:65], v[64:65], v[22:23] op_sel_hi:[1,0]
  v_pk_mul_f32 v[66:67], v[66:67], v[22:23] op_sel_hi:[1,0]
  v_pk_mul_f32 v[68:69], v[68:69], v[22:23] op_sel_hi:[1,0]
  v_pk_mul_f32 v[70:71], v[70:71], v[22:23] op_sel_hi:[1,0]
  v_cvt_pk_bf16_f32 v32, v64, v65
  v_cvt_pk_bf16_f32 v33, v66, v67
  v_cvt_pk_bf16_f32 v34, v68, v69
  v_cvt_pk_bf16_f32 v35, v70, v71
  buffer_store_dwordx4 v[32:35], v17, s[8:11], s84 offen offset:0 sc1
  v_pk_mul_f32 v[72:73], v[72:73], v[22:23] op_sel_hi:[1,0]
  v_pk_mul_f32 v[74:75], v[74:75], v[22:23] op_sel_hi:[1,0]
  v_pk_mul_f32 v[76:77], v[76:77], v[22:23] op_sel_hi:[1,0]
  v_pk_mul_f32 v[78:79], v[78:79], v[22:23] op_sel_hi:[1,0]
  v_cvt_pk_bf16_f32 v36, v72, v73
  v_cvt_pk_bf16_f32 v37, v74, v75
  v_cvt_pk_bf16_f32 v38, v76, v77
  v_cvt_pk_bf16_f32 v39, v78, v79
  buffer_store_dwordx4 v[36:39], v17, s[8:11], s84 offen offset:1024 sc1
  v_pk_mul_f32 v[80:81], v[80:81], v[22:23] op_sel_hi:[1,0]
  v_pk_mul_f32 v[82:83], v[82:83], v[22:23] op_sel_hi:[1,0]
  v_pk_mul_f32 v[84:85], v[84:85], v[22:23] op_sel_hi:[1,0]
  v_pk_mul_f32 v[86:87], v[86:87], v[22:23] op_sel_hi:[1,0]
  v_cvt_pk_bf16_f32 v40, v80, v81
  v_cvt_pk_bf16_f32 v41, v82, v83
  v_cvt_pk_bf16_f32 v42, v84, v85
  v_cvt_pk_bf16_f32 v43, v86, v87
  buffer_store_dwordx4 v[40:43], v17, s[8:11], s84 offen offset:2048 sc1
  v_pk_mul_f32 v[88:89], v[88:89], v[22:23] op_sel_hi:[1,0]
  v_pk_mul_f32 v[90:91], v[90:91], v[22:23] op_sel_hi:[1,0]
  v_pk_mul_f32 v[92:93], v[92:93], v[22:23] op_sel_hi:[1,0]
  v_pk_mul_f32 v[94:95], v[94:95], v[22:23] op_sel_hi:[1,0]
  v_cvt_pk_bf16_f32 v44, v88, v89
  v_cvt_pk_bf16_f32 v45, v90, v91
  v_cvt_pk_bf16_f32 v46, v92, v93
  v_cvt_pk_bf16_f32 v47, v94, v95
  buffer_store_dwordx4 v[44:47], v17, s[8:11], s84 offen offset:3072 sc1
  v_pk_mul_f32 v[96:97], v[96:97], v[22:23] op_sel_hi:[1,0]
  v_pk_mul_f32 v[98:99], v[98:99], v[22:23] op_sel_hi:[1,0]
  v_pk_mul_f32 v[100:101], v[100:101], v[22:23] op_sel_hi:[1,0]
  v_pk_mul_f32 v[102:103], v[102:103], v[22:23] op_sel_hi:[1,0]
  v_cvt_pk_bf16_f32 v48, v96, v97
  v_cvt_pk_bf16_f32 v49, v98, v99
  v_cvt_pk_bf16_f32 v50, v100, v101
  v_cvt_pk_bf16_f32 v51, v102, v103
  buffer_store_dwordx4 v[48:51], v17, s[8:11], s85 offen offset:0 sc1
  v_pk_mul_f32 v[104:105], v[104:105], v[22:23] op_sel_hi:[1,0]
  v_pk_mul_f32 v[106:107], v[106:107], v[22:23] op_sel_hi:[1,0]
  v_pk_mul_f32 v[108:109], v[108:109], v[22:23] op_sel_hi:[1,0]
  v_pk_mul_f32 v[110:111], v[110:111], v[22:23] op_sel_hi:[1,0]
  v_cvt_pk_bf16_f32 v52, v104, v105
  v_cvt_pk_bf16_f32 v53, v106, v107
  v_cvt_pk_bf16_f32 v54, v108, v109
  v_cvt_pk_bf16_f32 v55, v110, v111
  buffer_store_dwordx4 v[52:55], v17, s[8:11], s85 offen offset:1024 sc1
  v_pk_mul_f32 v[112:113], v[112:113], v[22:23] op_sel_hi:[1,0]
  v_pk_mul_f32 v[114:115], v[114:115], v[22:23] op_sel_hi:[1,0]
  v_pk_mul_f32 v[116:117], v[116:117], v[22:23] op_sel_hi:[1,0]
  v_pk_mul_f32 v[118:119], v[118:119], v[22:23] op_sel_hi:[1,0]
  v_cvt_pk_bf16_f32 v56, v112, v113
  v_cvt_pk_bf16_f32 v57, v114, v115
  v_cvt_pk_bf16_f32 v58, v116, v117
  v_cvt_pk_bf16_f32 v59, v118, v119
  buffer_store_dwordx4 v[56:59], v17, s[8:11], s85 offen offset:2048 sc1
  v_pk_mul_f32 v[120:121], v[120:121], v[22:23] op_sel_hi:[1,0]
  v_pk_mul_f32 v[122:123], v[122:123], v[22:23] op_sel_hi:[1,0]
  v_pk_mul_f32 v[124:125], v[124:125], v[22:23] op_sel_hi:[1,0]
  v_pk_mul_f32 v[126:127], v[126:127], v[22:23] op_sel_hi:[1,0]
  v_cvt_pk_bf16_f32 v60, v120, v121
  v_cvt_pk_bf16_f32 v61, v122, v123
  v_cvt_pk_bf16_f32 v62, v124, v125
  v_cvt_pk_bf16_f32 v63, v126, v127
  buffer_store_dwordx4 v[60:63], v17, s[8:11], s85 offen offset:3072 sc1
  s_and_b32 s62, s78, 127
  s_and_b32 s78, s62, 63
  s_lshl_b32 s78, s78, 7
  s_lshr_b32 s63, s62, 6
  s_lshl_b32 s63, s63, 14
  s_add_u32 s78, s78, s63
  s_xor_b32 s63, s94, 0x2000
  s_add_u32 s78, s78, s63
  s_add_u32 s78, s78, s95
  s_branch L_mega_rot
L_qkv_a_v:
  s_barrier
  ds_read_b128 v[176:179], v128 offset:0
  ds_read_b64_tr_b16 v[32:33], v18 offset:0
  ds_read_b64_tr_b16 v[34:35], v18 offset:1024
  ds_read_b64_tr_b16 v[36:37], v19 offset:0
  ds_read_b64_tr_b16 v[38:39], v19 offset:1024
  ds_read_b64_tr_b16 v[40:41], v20 offset:0
  ds_read_b64_tr_b16 v[42:43], v20 offset:1024
  ds_read_b64_tr_b16 v[44:45], v21 offset:0
  ds_read_b64_tr_b16 v[46:47], v21 offset:1024
  s_waitcnt lgkmcnt(8)
  v_dot2_f32_bf16 v140, v176, s60, v140
  v_dot2_f32_bf16 v141, v176, v176, v141
  v_dot2_f32_bf16 v142, v177, s60, v142
  v_dot2_f32_bf16 v143, v177, v177, v143
  v_dot2_f32_bf16 v140, v178, s60, v140
  v_dot2_f32_bf16 v141, v178, v178, v141
  v_dot2_f32_bf16 v142, v179, s60, v142
  v_dot2_f32_bf16 v143, v179, v179, v143
  s_nop 7
  s_waitcnt lgkmcnt(6)
  v_mfma_f32_32x32x16_bf16 v[64:79], v[176:179], v[32:35], v[64:79]
  ds_read_b128 v[180:183], v129 offset:0
  ds_read_b64_tr_b16 v[48:49], v18 offset:4096
  ds_read_b64_tr_b16 v[50:51], v18 offset:5120
  s_waitcnt lgkmcnt(7)
  v_mfma_f32_32x32x16_bf16 v[80:95], v[176:179], v[36:39], v[80:95]
  ds_read_b64_tr_b16 v[52:53], v19 offset:4096
  ds_read_b64_tr_b16 v[54:55], v19 offset:5120
  s_waitcnt lgkmcnt(7)
  v_mfma_f32_32x32x16_bf16 v[96:111], v[176:179], v[40:43], v[96:111]
  ds_read_b64_tr_b16 v[56:57], v20 offset:4096
  ds_read_b64_tr_b16 v[58:59], v20 offset:5120
  s_waitcnt lgkmcnt(7)
  v_mfma_f32_32x32x16_bf16 v[112:127], v[176:179], v[44:47], v[112:127]
  ds_read_b64_tr_b16 v[60:61], v21 offset:4096
  ds_read_b64_tr_b16 v[62:63], v21 offset:5120
  s_waitcnt lgkmcnt(8)
  v_dot2_f32_bf16 v140, v180, s60, v140
  v_dot2_f32_bf16 v141, v180, v180, v141
  v_dot2_f32_bf16 v142, v181, s60, v142
  v_dot2_f32_bf16 v143, v181, v181, v143
  v_dot2_f32_bf16 v140, v182, s60, v140
  v_dot2_f32_bf16 v141, v182, v182, v141
  v_dot2_f32_bf16 v142, v183, s60, v142
  v_dot2_f32_bf16 v143, v183, v183, v143
  s_nop 7
  s_waitcnt lgkmcnt(6)
  v_mfma_f32_32x32x16_bf16 v[64:79], v[180:183], v[48:51], v[64:79]
  ds_read_b128 v[184:187], v130 offset:0
  ds_read_b64_tr_b16 v[32:33], v18 offset:8192
  ds_read_b64_tr_b16 v[34:35], v18 offset:9216
  s_waitcnt lgkmcnt(7)
  v_mfma_f32_32x32x16_bf16 v[80:95], v[180:183], v[52:55], v[80:95]
  ds_read_b64_tr_b16 v[36:37], v19 offset:8192
  ds_read_b64_tr_b16 v[38:39], v19 offset:9216
  s_waitcnt lgkmcnt(7)
  v_mfma_f32_32x32x16_bf16 v[96:111], v[180:183], v[56:59], v[96:111]
  ds_read_b64_tr_b16 v[40:41], v20 offset:8192
  ds_read_b64_tr_b16 v[42:43], v20 offset:9216
  s_waitcnt lgkmcnt(7)
  v_mfma_f32_32x32x16_bf16 v[112:127], v[180:183], v[60:63], v[112:127]
  ds_read_b64_tr_b16 v[44:45], v21 offset:8192
  ds_read_b64_tr_b16 v[46:47], v21 offset:9216
  s_waitcnt lgkmcnt(8)
  v_dot2_f32_bf16 v140, v184, s60, v140
  v_dot2_f32_bf16 v141, v184, v184, v141
  v_dot2_f32_bf16 v142, v185, s60, v142
  v_dot2_f32_bf16 v143, v185, v185, v143
  v_dot2_f32_bf16 v140, v186, s60, v140
  v_dot2_f32_bf16 v141, v186, v186, v141
  v_dot2_f32_bf16 v142, v187, s60, v142
  v_dot2_f32_bf16 v143, v187, v187, v143
  s_nop 7
  s_waitcnt lgkmcnt(6)
  v_mfma_f32_32x32x16_bf16 v[64:79], v[184:187], v[32:35], v[64:79]
  ds_read_b128 v[188:191], v131 offset:0
  ds_read_b64_tr_b16 v[48:49], v18 offset:12288
  ds_read_b64_tr_b16 v[50:51], v18 offset:13312
  s_waitcnt lgkmcnt(7)
  v_mfma_f32_32x32x16_bf16 v[80:95], v[184:187], v[36:39], v[80:95]
  ds_read_b64_tr_b16 v[52:53], v19 offset:12288
  ds_read_b64_tr_b16 v[54:55], v19 offset:13312
  s_waitcnt lgkmcnt(7)
  v_mfma_f32_32x32x16_bf16 v[96:111], v[184:187], v[40:43], v[96:111]
  ds_read_b64_tr_b16 v[56:57], v20 offset:12288
  ds_read_b64_tr_b16 v[58:59], v20 offset:13312
  s_waitcnt lgkmcnt(7)
  v_mfma_f32_32x32x16_bf16 v[112:127], v[184:187], v[44:47], v[112:127]
  ds_read_b64_tr_b16 v[60:61], v21 offset:12288
  ds_read_b64_tr_b16 v[62:63], v21 offset:13312
  s_waitcnt lgkmcnt(8)
  v_dot2_f32_bf16 v140, v188, s60, v140
  v_dot2_f32_bf16 v141, v188, v188, v141
  v_dot2_f32_bf16 v142, v189, s60, v142
  v_dot2_f32_bf16 v143, v189, v189, v143
  v_dot2_f32_bf16 v140, v190, s60, v140
  v_dot2_f32_bf16 v141, v190, v190, v141
  v_dot2_f32_bf16 v142, v191, s60, v142
  v_dot2_f32_bf16 v143, v191, v191, v143
  s_barrier
  s_nop 7
  s_waitcnt lgkmcnt(6)
  v_mfma_f32_32x32x16_bf16 v[64:79], v[188:191], v[48:51], v[64:79]
  ds_read_b128 v[192:195], v128 offset:16384
  ds_read_b64_tr_b16 v[32:33], v18 offset:16384
  ds_read_b64_tr_b16 v[34:35], v18 offset:17408
  s_waitcnt lgkmcnt(7)
  v_mfma_f32_32x32x16_bf16 v[80:95], v[188:191], v[52:55], v[80:95]
  ds_read_b64_tr_b16 v[36:37], v19 offset:16384
  ds_read_b64_tr_b16 v[38:39], v19 offset:17408
  s_waitcnt lgkmcnt(7)
  v_mfma_f32_32x32x16_bf16 v[96:111], v[188:191], v[56:59], v[96:111]
  ds_read_b64_tr_b16 v[40:41], v20 offset:16384
  ds_read_b64_tr_b16 v[42:43], v20 offset:17408
  s_waitcnt lgkmcnt(7)
  v_mfma_f32_32x32x16_bf16 v[112:127], v[188:191], v[60:63], v[112:127]
  ds_read_b64_tr_b16 v[44:45], v21 offset:16384
  ds_read_b64_tr_b16 v[46:47], v21 offset:17408
  s_waitcnt lgkmcnt(8)
  v_dot2_f32_bf16 v140, v192, s60, v140
  v_dot2_f32_bf16 v141, v192, v192, v141
  v_dot2_f32_bf16 v142, v193, s60, v142
  v_dot2_f32_bf16 v143, v193, v193, v143
  v_dot2_f32_bf16 v140, v194, s60, v140
  v_dot2_f32_bf16 v141, v194, v194, v141
  v_dot2_f32_bf16 v142, v195, s60, v142
  v_dot2_f32_bf16 v143, v195, v195, v143
  s_nop 7
  s_waitcnt lgkmcnt(6)
  v_mfma_f32_32x32x16_bf16 v[64:79], v[192:195], v[32:35], v[64:79]
  ds_read_b128 v[196:199], v129 offset:16384
  ds_read_b64_tr_b16 v[48:49], v18 offset:20480
  ds_read_b64_tr_b16 v[50:51], v18 offset:21504
  s_waitcnt lgkmcnt(7)
  v_mfma_f32_32x32x16_bf16 v[80:95], v[192:195], v[36:39], v[80:95]
  ds_read_b64_tr_b16 v[52:53], v19 offset:20480
  ds_read_b64_tr_b16 v[54:55], v19 offset:21504
  s_waitcnt lgkmcnt(7)
  v_mfma_f32_32x32x16_bf16 v[96:111], v[192:195], v[40:43], v[96:111]
  ds_read_b64_tr_b16 v[56:57], v20 offset:20480
  ds_read_b64_tr_b16 v[58:59], v20 offset:21504
  s_waitcnt lgkmcnt(7)
  v_mfma_f32_32x32x16_bf16 v[112:127], v[192:195], v[44:47], v[112:127]
  ds_read_b64_tr_b16 v[60:61], v21 offset:20480
  ds_read_b64_tr_b16 v[62:63], v21 offset:21504
  s_waitcnt lgkmcnt(8)
  v_dot2_f32_bf16 v140, v196, s60, v140
  v_dot2_f32_bf16 v141, v196, v196, v141
  v_dot2_f32_bf16 v142, v197, s60, v142
  v_dot2_f32_bf16 v143, v197, v197, v143
  v_dot2_f32_bf16 v140, v198, s60, v140
  v_dot2_f32_bf16 v141, v198, v198, v141
  v_dot2_f32_bf16 v142, v199, s60, v142
  v_dot2_f32_bf16 v143, v199, v199, v143
  s_nop 7
  s_waitcnt lgkmcnt(6)
  v_mfma_f32_32x32x16_bf16 v[64:79], v[196:199], v[48:51], v[64:79]
  ds_read_b128 v[200:203], v130 offset:16384
  ds_read_b64_tr_b16 v[32:33], v18 offset:24576
  ds_read_b64_tr_b16 v[34:35], v18 offset:25600
  s_waitcnt lgkmcnt(7)
  v_mfma_f32_32x32x16_bf16 v[80:95], v[196:199], v[52:55], v[80:95]
  ds_read_b64_tr_b16 v[36:37], v19 offset:24576
  ds_read_b64_tr_b16 v[38:39], v19 offset:25600
  s_waitcnt lgkmcnt(7)
  v_mfma_f32_32x32x16_bf16 v[96:111], v[196:199], v[56:59], v[96:111]
  ds_read_b64_tr_b16 v[40:41], v20 offset:24576
  ds_read_b64_tr_b16 v[42:43], v20 offset:25600
  s_waitcnt lgkmcnt(7)
  v_mfma_f32_32x32x16_bf16 v[112:127], v[196:199], v[60:63], v[112:127]
  ds_read_b64_tr_b16 v[44:45], v21 offset:24576
  ds_read_b64_tr_b16 v[46:47], v21 offset:25600
  s_waitcnt lgkmcnt(8)
  v_dot2_f32_bf16 v140, v200, s60, v140
  v_dot2_f32_bf16 v141, v200, v200, v141
  v_dot2_f32_bf16 v142, v201, s60, v142
  v_dot2_f32_bf16 v143, v201, v201, v143
  v_dot2_f32_bf16 v140, v202, s60, v140
  v_dot2_f32_bf16 v141, v202, v202, v141
  v_dot2_f32_bf16 v142, v203, s60, v142
  v_dot2_f32_bf16 v143, v203, v203, v143
  s_nop 7
  s_waitcnt lgkmcnt(6)
  v_mfma_f32_32x32x16_bf16 v[64:79], v[200:203], v[32:35], v[64:79]
  ds_read_b128 v[204:207], v131 offset:16384
  ds_read_b64_tr_b16 v[48:49], v18 offset:28672
  ds_read_b64_tr_b16 v[50:51], v18 offset:29696
  s_waitcnt lgkmcnt(7)
  v_mfma_f32_32x32x16_bf16 v[80:95], v[200:203], v[36:39], v[80:95]
  ds_read_b64_tr_b16 v[52:53], v19 offset:28672
  ds_read_b64_tr_b16 v[54:55], v19 offset:29696
  s_waitcnt lgkmcnt(7)
  v_mfma_f32_32x32x16_bf16 v[96:111], v[200:203], v[40:43], v[96:111]
  ds_read_b64_tr_b16 v[56:57], v20 offset:28672
  ds_read_b64_tr_b16 v[58:59], v20 offset:29696
  s_waitcnt lgkmcnt(7)
  v_mfma_f32_32x32x16_bf16 v[112:127], v[200:203], v[44:47], v[112:127]
  ds_read_b64_tr_b16 v[60:61], v21 offset:28672
  ds_read_b64_tr_b16 v[62:63], v21 offset:29696
  s_waitcnt lgkmcnt(8)
  v_dot2_f32_bf16 v140, v204, s60, v140
  v_dot2_f32_bf16 v141, v204, v204, v141
  v_dot2_f32_bf16 v142, v205, s60, v142
  v_dot2_f32_bf16 v143, v205, v205, v143
  v_dot2_f32_bf16 v140, v206, s60, v140
  v_dot2_f32_bf16 v141, v206, v206, v141
  v_dot2_f32_bf16 v142, v207, s60, v142
  v_dot2_f32_bf16 v143, v207, v207, v143
  s_barrier
  s_nop 7
  s_waitcnt lgkmcnt(6)
  v_mfma_f32_32x32x16_bf16 v[64:79], v[204:207], v[48:51], v[64:79]
  ds_read_b128 v[176:179], v128 offset:32768
  ds_read_b64_tr_b16 v[32:33], v18 offset:32768
  ds_read_b64_tr_b16 v[34:35], v18 offset:33792
  s_waitcnt lgkmcnt(7)
  v_mfma_f32_32x32x16_bf16 v[80:95], v[204:207], v[52:55], v[80:95]
  ds_read_b64_tr_b16 v[36:37], v19 offset:32768
  ds_read_b64_tr_b16 v[38:39], v19 offset:33792
  s_waitcnt lgkmcnt(7)
  v_mfma_f32_32x32x16_bf16 v[96:111], v[204:207], v[56:59], v[96:111]
  ds_read_b64_tr_b16 v[40:41], v20 offset:32768
  ds_read_b64_tr_b16 v[42:43], v20 offset:33792
  s_waitcnt lgkmcnt(7)
  v_mfma_f32_32x32x16_bf16 v[112:127], v[204:207], v[60:63], v[112:127]
  ds_read_b64_tr_b16 v[44:45], v21 offset:32768
  ds_read_b64_tr_b16 v[46:47], v21 offset:33792
  s_waitcnt lgkmcnt(8)
  v_dot2_f32_bf16 v140, v176, s60, v140
  v_dot2_f32_bf16 v141, v176, v176, v141
  v_dot2_f32_bf16 v142, v177, s60, v142
  v_dot2_f32_bf16 v143, v177, v177, v143
  v_dot2_f32_bf16 v140, v178, s60, v140
  v_dot2_f32_bf16 v141, v178, v178, v141
  v_dot2_f32_bf16 v142, v179, s60, v142
  v_dot2_f32_bf16 v143, v179, v179, v143
  s_nop 7
  s_waitcnt lgkmcnt(6)
  v_mfma_f32_32x32x16_bf16 v[64:79], v[176:179], v[32:35], v[64:79]
  ds_read_b128 v[180:183], v129 offset:32768
  ds_read_b64_tr_b16 v[48:49], v18 offset:36864
  ds_read_b64_tr_b16 v[50:51], v18 offset:37888
  s_waitcnt lgkmcnt(7)
  v_mfma_f32_32x32x16_bf16 v[80:95], v[176:179], v[36:39], v[80:95]
  ds_read_b64_tr_b16 v[52:53], v19 offset:36864
  ds_read_b64_tr_b16 v[54:55], v19 offset:37888
  s_waitcnt lgkmcnt(7)
  v_mfma_f32_32x32x16_bf16 v[96:111], v[176:179], v[40:43], v[96:111]
  ds_read_b64_tr_b16 v[56:57], v20 offset:36864
  ds_read_b64_tr_b16 v[58:59], v20 offset:37888
  s_waitcnt lgkmcnt(7)
  v_mfma_f32_32x32x16_bf16 v[112:127], v[176:179], v[44:47], v[112:127]
  ds_read_b64_tr_b16 v[60:61], v21 offset:36864
  ds_read_b64_tr_b16 v[62:63], v21 offset:37888
  s_waitcnt lgkmcnt(8)
  v_dot2_f32_bf16 v140, v180, s60, v140
  v_dot2_f32_bf16 v141, v180, v180, v141
  v_dot2_f32_bf16 v142, v181, s60, v142
  v_dot2_f32_bf16 v143, v181, v181, v143
  v_dot2_f32_bf16 v140, v182, s60, v140
  v_dot2_f32_bf16 v141, v182, v182, v141
  v_dot2_f32_bf16 v142, v183, s60, v142
  v_dot2_f32_bf16 v143, v183, v183, v143
  s_nop 7
  s_waitcnt lgkmcnt(6)
  v_mfma_f32_32x32x16_bf16 v[64:79], v[180:183], v[48:51], v[64:79]
  ds_read_b128 v[184:187], v130 offset:32768
  ds_read_b64_tr_b16 v[32:33], v18 offset:40960
  ds_read_b64_tr_b16 v[34:35], v18 offset:41984
  s_waitcnt lgkmcnt(7)
  v_mfma_f32_32x32x16_bf16 v[80:95], v[180:183], v[52:55], v[80:95]
  ds_read_b64_tr_b16 v[36:37], v19 offset:40960
  ds_read_b64_tr_b16 v[38:39], v19 offset:41984
  s_waitcnt lgkmcnt(7)
  v_mfma_f32_32x32x16_bf16 v[96:111], v[180:183], v[56:59], v[96:111]
  ds_read_b64_tr_b16 v[40:41], v20 offset:40960
  ds_read_b64_tr_b16 v[42:43], v20 offset:41984
  s_waitcnt lgkmcnt(7)
  v_mfma_f32_32x32x16_bf16 v[112:127], v[180:183], v[60:63], v[112:127]
  ds_read_b64_tr_b16 v[44:45], v21 offset:40960
  ds_read_b64_tr_b16 v[46:47], v21 offset:41984
  s_waitcnt lgkmcnt(8)
  v_dot2_f32_bf16 v140, v184, s60, v140
  v_dot2_f32_bf16 v141, v184, v184, v141
  v_dot2_f32_bf16 v142, v185, s60, v142
  v_dot2_f32_bf16 v143, v185, v185, v143
  v_dot2_f32_bf16 v140, v186, s60, v140
  v_dot2_f32_bf16 v141, v186, v186, v141
  v_dot2_f32_bf16 v142, v187, s60, v142
  v_dot2_f32_bf16 v143, v187, v187, v143
  s_nop 7
  s_waitcnt lgkmcnt(6)
  v_mfma_f32_32x32x16_bf16 v[64:79], v[184:187], v[32:35], v[64:79]
  ds_read_b128 v[188:191], v131 offset:32768
  ds_read_b64_tr_b16 v[48:49], v18 offset:45056
  ds_read_b64_tr_b16 v[50:51], v18 offset:46080
  s_waitcnt lgkmcnt(7)
  v_mfma_f32_32x32x16_bf16 v[80:95], v[184:187], v[36:39], v[80:95]
  ds_read_b64_tr_b16 v[52:53], v19 offset:45056
  ds_read_b64_tr_b16 v[54:55], v19 offset:46080
  s_waitcnt lgkmcnt(7)
  v_mfma_f32_32x32x16_bf16 v[96:111], v[184:187], v[40:43], v[96:111]
  ds_read_b64_tr_b16 v[56:57], v20 offset:45056
  ds_read_b64_tr_b16 v[58:59], v20 offset:46080
  s_waitcnt lgkmcnt(7)
  v_mfma_f32_32x32x16_bf16 v[112:127], v[184:187], v[44:47], v[112:127]
  ds_read_b64_tr_b16 v[60:61], v21 offset:45056
  ds_read_b64_tr_b16 v[62:63], v21 offset:46080
  s_waitcnt lgkmcnt(8)
  v_dot2_f32_bf16 v140, v188, s60, v140
  v_dot2_f32_bf16 v141, v188, v188, v141
  v_dot2_f32_bf16 v142, v189, s60, v142
  v_dot2_f32_bf16 v143, v189, v189, v143
  v_dot2_f32_bf16 v140, v190, s60, v140
  v_dot2_f32_bf16 v141, v190, v190, v141
  v_dot2_f32_bf16 v142, v191, s60, v142
  v_dot2_f32_bf16 v143, v191, v191, v143
  s_barrier
  s_nop 7
  s_waitcnt lgkmcnt(6)
  v_mfma_f32_32x32x16_bf16 v[64:79], v[188:191], v[48:51], v[64:79]
  ds_read_b128 v[192:195], v128 offset:49152
  ds_read_b64_tr_b16 v[32:33], v18 offset:49152
  ds_read_b64_tr_b16 v[34:35], v18 offset:50176
  s_waitcnt lgkmcnt(7)
  v_mfma_f32_32x32x16_bf16 v[80:95], v[188:191], v[52:55], v[80:95]
  ds_read_b64_tr_b16 v[36:37], v19 offset:49152
  ds_read_b64_tr_b16 v[38:39], v19 offset:50176
  s_waitcnt lgkmcnt(7)
  v_mfma_f32_32x32x16_bf16 v[96:111], v[188:191], v[56:59], v[96:111]
  ds_read_b64_tr_b16 v[40:41], v20 offset:49152
  ds_read_b64_tr_b16 v[42:43], v20 offset:50176
  s_waitcnt lgkmcnt(7)
  v_mfma_f32_32x32x16_bf16 v[112:127], v[188:191], v[60:63], v[112:127]
  ds_read_b64_tr_b16 v[44:45], v21 offset:49152
  ds_read_b64_tr_b16 v[46:47], v21 offset:50176
  s_waitcnt lgkmcnt(8)
  v_dot2_f32_bf16 v140, v192, s60, v140
  v_dot2_f32_bf16 v141, v192, v192, v141
  v_dot2_f32_bf16 v142, v193, s60, v142
  v_dot2_f32_bf16 v143, v193, v193, v143
  v_dot2_f32_bf16 v140, v194, s60, v140
  v_dot2_f32_bf16 v141, v194, v194, v141
  v_dot2_f32_bf16 v142, v195, s60, v142
  v_dot2_f32_bf16 v143, v195, v195, v143
  s_nop 7
  s_waitcnt lgkmcnt(6)
  v_mfma_f32_32x32x16_bf16 v[64:79], v[192:195], v[32:35], v[64:79]
  ds_read_b128 v[196:199], v129 offset:49152
  ds_read_b64_tr_b16 v[48:49], v18 offset:53248
  ds_read_b64_tr_b16 v[50:51], v18 offset:54272
  s_waitcnt lgkmcnt(7)
  v_mfma_f32_32x32x16_bf16 v[80:95], v[192:195], v[36:39], v[80:95]
  ds_read_b64_tr_b16 v[52:53], v19 offset:53248
  ds_read_b64_tr_b16 v[54:55], v19 offset:54272
  s_waitcnt lgkmcnt(7)
  v_mfma_f32_32x32x16_bf16 v[96:111], v[192:195], v[40:43], v[96:111]
  ds_read_b64_tr_b16 v[56:57], v20 offset:53248
  ds_read_b64_tr_b16 v[58:59], v20 offset:54272
  s_waitcnt lgkmcnt(7)
  v_mfma_f32_32x32x16_bf16 v[112:127], v[192:195], v[44:47], v[112:127]
  ds_read_b64_tr_b16 v[60:61], v21 offset:53248
  ds_read_b64_tr_b16 v[62:63], v21 offset:54272
  s_waitcnt lgkmcnt(8)
  v_dot2_f32_bf16 v140, v196, s60, v140
  v_dot2_f32_bf16 v141, v196, v196, v141
  v_dot2_f32_bf16 v142, v197, s60, v142
  v_dot2_f32_bf16 v143, v197, v197, v143
  v_dot2_f32_bf16 v140, v198, s60, v140
  v_dot2_f32_bf16 v141, v198, v198, v141
  v_dot2_f32_bf16 v142, v199, s60, v142
  v_dot2_f32_bf16 v143, v199, v199, v143
  s_nop 7
  s_waitcnt lgkmcnt(6)
  v_mfma_f32_32x32x16_bf16 v[64:79], v[196:199], v[48:51], v[64:79]
  ds_read_b128 v[200:203], v130 offset:49152
  ds_read_b64_tr_b16 v[32:33], v18 offset:57344
  ds_read_b64_tr_b16 v[34:35], v18 offset:58368
  s_waitcnt lgkmcnt(7)
  v_mfma_f32_32x32x16_bf16 v[80:95], v[196:199], v[52:55], v[80:95]
  ds_read_b64_tr_b16 v[36:37], v19 offset:57344
  ds_read_b64_tr_b16 v[38:39], v19 offset:58368
  s_waitcnt lgkmcnt(7)
  v_mfma_f32_32x32x16_bf16 v[96:111], v[196:199], v[56:59], v[96:111]
  ds_read_b64_tr_b16 v[40:41], v20 offset:57344
  ds_read_b64_tr_b16 v[42:43], v20 offset:58368
  s_waitcnt lgkmcnt(7)
  v_mfma_f32_32x32x16_bf16 v[112:127], v[196:199], v[60:63], v[112:127]
  ds_read_b64_tr_b16 v[44:45], v21 offset:57344
  ds_read_b64_tr_b16 v[46:47], v21 offset:58368
  s_waitcnt lgkmcnt(8)
  v_dot2_f32_bf16 v140, v200, s60, v140
  v_dot2_f32_bf16 v141, v200, v200, v141
  v_dot2_f32_bf16 v142, v201, s60, v142
  v_dot2_f32_bf16 v143, v201, v201, v143
  v_dot2_f32_bf16 v140, v202, s60, v140
  v_dot2_f32_bf16 v141, v202, v202, v141
  v_dot2_f32_bf16 v142, v203, s60, v142
  v_dot2_f32_bf16 v143, v203, v203, v143
  s_nop 7
  s_waitcnt lgkmcnt(6)
  v_mfma_f32_32x32x16_bf16 v[64:79], v[200:203], v[32:35], v[64:79]
  ds_read_b128 v[204:207], v131 offset:49152
  ds_read_b64_tr_b16 v[48:49], v18 offset:61440
  ds_read_b64_tr_b16 v[50:51], v18 offset:62464
  s_waitcnt lgkmcnt(7)
  v_mfma_f32_32x32x16_bf16 v[80:95], v[200:203], v[36:39], v[80:95]
  ds_read_b64_tr_b16 v[52:53], v19 offset:61440
  ds_read_b64_tr_b16 v[54:55], v19 offset:62464
  s_waitcnt lgkmcnt(7)
  v_mfma_f32_32x32x16_bf16 v[96:111], v[200:203], v[40:43], v[96:111]
  ds_read_b64_tr_b16 v[56:57], v20 offset:61440
  ds_read_b64_tr_b16 v[58:59], v20 offset:62464
  s_waitcnt lgkmcnt(7)
  v_mfma_f32_32x32x16_bf16 v[112:127], v[200:203], v[44:47], v[112:127]
  ds_read_b64_tr_b16 v[60:61], v21 offset:61440
  ds_read_b64_tr_b16 v[62:63], v21 offset:62464
  s_waitcnt lgkmcnt(8)
  v_dot2_f32_bf16 v140, v204, s60, v140
  v_dot2_f32_bf16 v141, v204, v204, v141
  v_dot2_f32_bf16 v142, v205, s60, v142
  v_dot2_f32_bf16 v143, v205, v205, v143
  v_dot2_f32_bf16 v140, v206, s60, v140
  v_dot2_f32_bf16 v141, v206, v206, v141
  v_dot2_f32_bf16 v142, v207, s60, v142
  v_dot2_f32_bf16 v143, v207, v207, v143
  s_barrier
  s_nop 7
  v_add_u32 v18, 65536, v18
  v_add_u32 v128, 65536, v128
  v_add_u32 v19, 65536, v19
  v_add_u32 v129, 65536, v129
  v_add_u32 v20, 65536, v20
  v_add_u32 v130, 65536, v130
  v_add_u32 v21, 65536, v21
  v_add_u32 v131, 65536, v131
  s_waitcnt lgkmcnt(6)
  v_mfma_f32_32x32x16_bf16 v[64:79], v[204:207], v[48:51], v[64:79]
  ds_read_b128 v[176:179], v128 offset:0
  ds_read_b64_tr_b16 v[32:33], v18 offset:0
  ds_read_b64_tr_b16 v[34:35], v18 offset:1024
  s_waitcnt lgkmcnt(7)
  v_mfma_f32_32x32x16_bf16 v[80:95], v[204:207], v[52:55], v[80:95]
  ds_read_b64_tr_b16 v[36:37], v19 offset:0
  ds_read_b64_tr_b16 v[38:39], v19 offset:1024
  s_waitcnt lgkmcnt(7)
  v_mfma_f32_32x32x16_bf16 v[96:111], v[204:207], v[56:59], v[96:111]
  ds_read_b64_tr_b16 v[40:41], v20 offset:0
  ds_read_b64_tr_b16 v[42:43], v20 offset:1024
  s_waitcnt lgkmcnt(7)
  v_mfma_f32_32x32x16_bf16 v[112:127], v[204:207], v[60:63], v[112:127]
  ds_read_b64_tr_b16 v[44:45], v21 offset:0
  ds_read_b64_tr_b16 v[46:47], v21 offset:1024
  s_waitcnt lgkmcnt(8)
  v_dot2_f32_bf16 v140, v176, s60, v140
  v_dot2_f32_bf16 v141, v176, v176, v141
  v_dot2_f32_bf16 v142, v177, s60, v142
  v_dot2_f32_bf16 v143, v177, v177, v143
  v_dot2_f32_bf16 v140, v178, s60, v140
  v_dot2_f32_bf16 v141, v178, v178, v141
  v_dot2_f32_bf16 v142, v179, s60, v142
  v_dot2_f32_bf16 v143, v179, v179, v143
  s_waitcnt lgkmcnt(6)
  v_mfma_f32_32x32x16_bf16 v[64:79], v[176:179], v[32:35], v[64:79]
  ds_read_b128 v[180:183], v129 offset:0
  ds_read_b64_tr_b16 v[48:49], v18 offset:4096
  ds_read_b64_tr_b16 v[50:51], v18 offset:5120
  s_waitcnt lgkmcnt(7)
  v_mfma_f32_32x32x16_bf16 v[80:95], v[176:179], v[36:39], v[80:95]
  ds_read_b64_tr_b16 v[52:53], v19 offset:4096
  ds_read_b64_tr_b16 v[54:55], v19 offset:5120
  s_waitcnt lgkmcnt(7)
  v_mfma_f32_32x32x16_bf16 v[96:111], v[176:179], v[40:43], v[96:111]
  ds_read_b64_tr_b16 v[56:57], v20 offset:4096
  ds_read_b64_tr_b16 v[58:59], v20 offset:5120
  s_waitcnt lgkmcnt(7)
  v_mfma_f32_32x32x16_bf16 v[112:127], v[176:179], v[44:47], v[112:127]
  ds_read_b64_tr_b16 v[60:61], v21 offset:4096
  ds_read_b64_tr_b16 v[62:63], v21 offset:5120
  s_waitcnt lgkmcnt(8)
  v_dot2_f32_bf16 v140, v180, s60, v140
  v_dot2_f32_bf16 v141, v180, v180, v141
  v_dot2_f32_bf16 v142, v181, s60, v142
  v_dot2_f32_bf16 v143, v181, v181, v143
  v_dot2_f32_bf16 v140, v182, s60, v140
  v_dot2_f32_bf16 v141, v182, v182, v141
  v_dot2_f32_bf16 v142, v183, s60, v142
  v_dot2_f32_bf16 v143, v183, v183, v143
  s_waitcnt lgkmcnt(6)
  v_mfma_f32_32x32x16_bf16 v[64:79], v[180:183], v[48:51], v[64:79]
  ds_read_b128 v[184:187], v130 offset:0
  ds_read_b64_tr_b16 v[32:33], v18 offset:8192
  ds_read_b64_tr_b16 v[34:35], v18 offset:9216
  s_waitcnt lgkmcnt(7)
  v_mfma_f32_32x32x16_bf16 v[80:95], v[180:183], v[52:55], v[80:95]
  ds_read_b64_tr_b16 v[36:37], v19 offset:8192
  ds_read_b64_tr_b16 v[38:39], v19 offset:9216
  s_waitcnt lgkmcnt(7)
  v_mfma_f32_32x32x16_bf16 v[96:111], v[180:183], v[56:59], v[96:111]
  ds_read_b64_tr_b16 v[40:41], v20 offset:8192
  ds_read_b64_tr_b16 v[42:43], v20 offset:9216
  s_waitcnt lgkmcnt(7)
  v_mfma_f32_32x32x16_bf16 v[112:127], v[180:183], v[60:63], v[112:127]
  ds_read_b64_tr_b16 v[44:45], v21 offset:8192
  ds_read_b64_tr_b16 v[46:47], v21 offset:9216
  s_waitcnt lgkmcnt(8)
  v_dot2_f32_bf16 v140, v184, s60, v140
  v_dot2_f32_bf16 v141, v184, v184, v141
  v_dot2_f32_bf16 v142, v185, s60, v142
  v_dot2_f32_bf16 v143, v185, v185, v143
  v_dot2_f32_bf16 v140, v186, s60, v140
  v_dot2_f32_bf16 v141, v186, v186, v141
  v_dot2_f32_bf16 v142, v187, s60, v142
  v_dot2_f32_bf16 v143, v187, v187, v143
  s_waitcnt lgkmcnt(6)
  v_mfma_f32_32x32x16_bf16 v[64:79], v[184:187], v[32:35], v[64:79]
  ds_read_b128 v[188:191], v131 offset:0
  ds_read_b64_tr_b16 v[48:49], v18 offset:12288
  ds_read_b64_tr_b16 v[50:51], v18 offset:13312
  s_waitcnt lgkmcnt(7)
  v_mfma_f32_32x32x16_bf16 v[80:95], v[184:187], v[36:39], v[80:95]
  ds_read_b64_tr_b16 v[52:53], v19 offset:12288
  ds_read_b64_tr_b16 v[54:55], v19 offset:13312
  s_waitcnt lgkmcnt(7)
  v_mfma_f32_32x32x16_bf16 v[96:111], v[184:187], v[40:43], v[96:111]
  ds_read_b64_tr_b16 v[56:57], v20 offset:12288
  ds_read_b64_tr_b16 v[58:59], v20 offset:13312
  s_waitcnt lgkmcnt(7)
  v_mfma_f32_32x32x16_bf16 v[112:127], v[184:187], v[44:47], v[112:127]
  ds_read_b64_tr_b16 v[60:61], v21 offset:12288
  ds_read_b64_tr_b16 v[62:63], v21 offset:13312
  s_waitcnt lgkmcnt(8)
  v_dot2_f32_bf16 v140, v188, s60, v140
  v_dot2_f32_bf16 v141, v188, v188, v141
  v_dot2_f32_bf16 v142, v189, s60, v142
  v_dot2_f32_bf16 v143, v189, v189, v143
  v_dot2_f32_bf16 v140, v190, s60, v140
  v_dot2_f32_bf16 v141, v190, v190, v141
  v_dot2_f32_bf16 v142, v191, s60, v142
  v_dot2_f32_bf16 v143, v191, v191, v143
  s_barrier
  v_subrev_u32 v18, 65536, v18
  v_subrev_u32 v128, 65536, v128
  v_subrev_u32 v19, 65536, v19
  v_subrev_u32 v129, 65536, v129
  v_subrev_u32 v20, 65536, v20
  v_subrev_u32 v130, 65536, v130
  v_subrev_u32 v21, 65536, v21
  v_subrev_u32 v131, 65536, v131
  s_waitcnt lgkmcnt(6)
  v_mfma_f32_32x32x16_bf16 v[64:79], v[188:191], v[48:51], v[64:79]
  ds_read_b128 v[192:195], v128 offset:0
  ds_read_b64_tr_b16 v[32:33], v18 offset:0
  ds_read_b64_tr_b16 v[34:35], v18 offset:1024
  s_waitcnt lgkmcnt(7)
  v_mfma_f32_32x32x16_bf16 v[80:95], v[188:191], v[52:55], v[80:95]
  ds_read_b64_tr_b16 v[36:37], v19 offset:0
  ds_read_b64_tr_b16 v[38:39], v19 offset:1024
  s_waitcnt lgkmcnt(7)
  v_mfma_f32_32x32x16_bf16 v[96:111], v[188:191], v[56:59], v[96:111]
  ds_read_b64_tr_b16 v[40:41], v20 offset:0
  ds_read_b64_tr_b16 v[42:43], v20 offset:1024
  s_waitcnt lgkmcnt(7)
  v_mfma_f32_32x32x16_bf16 v[112:127], v[188:191], v[60:63], v[112:127]
  ds_read_b64_tr_b16 v[44:45], v21 offset:0
  ds_read_b64_tr_b16 v[46:47], v21 offset:1024
  s_waitcnt lgkmcnt(8)
  v_dot2_f32_bf16 v140, v192, s60, v140
  v_dot2_f32_bf16 v141, v192, v192, v141
  v_dot2_f32_bf16 v142, v193, s60, v142
  v_dot2_f32_bf16 v143, v193, v193, v143
  v_dot2_f32_bf16 v140, v194, s60, v140
  v_dot2_f32_bf16 v141, v194, v194, v141
  v_dot2_f32_bf16 v142, v195, s60, v142
  v_dot2_f32_bf16 v143, v195, v195, v143
  s_waitcnt lgkmcnt(6)
  v_mfma_f32_32x32x16_bf16 v[64:79], v[192:195], v[32:35], v[64:79]
  ds_read_b128 v[196:199], v129 offset:0
  ds_read_b64_tr_b16 v[48:49], v18 offset:4096
  ds_read_b64_tr_b16 v[50:51], v18 offset:5120
  s_waitcnt lgkmcnt(7)
  v_mfma_f32_32x32x16_bf16 v[80:95], v[192:195], v[36:39], v[80:95]
  ds_read_b64_tr_b16 v[52:53], v19 offset:4096
  ds_read_b64_tr_b16 v[54:55], v19 offset:5120
  s_waitcnt lgkmcnt(7)
  v_mfma_f32_32x32x16_bf16 v[96:111], v[192:195], v[40:43], v[96:111]
  ds_read_b64_tr_b16 v[56:57], v20 offset:4096
  ds_read_b64_tr_b16 v[58:59], v20 offset:5120
  s_waitcnt lgkmcnt(7)
  v_mfma_f32_32x32x16_bf16 v[112:127], v[192:195], v[44:47], v[112:127]
  ds_read_b64_tr_b16 v[60:61], v21 offset:4096
  ds_read_b64_tr_b16 v[62:63], v21 offset:5120
  s_waitcnt lgkmcnt(8)
  v_dot2_f32_bf16 v140, v196, s60, v140
  v_dot2_f32_bf16 v141, v196, v196, v141
  v_dot2_f32_bf16 v142, v197, s60, v142
  v_dot2_f32_bf16 v143, v197, v197, v143
  v_dot2_f32_bf16 v140, v198, s60, v140
  v_dot2_f32_bf16 v141, v198, v198, v141
  v_dot2_f32_bf16 v142, v199, s60, v142
  v_dot2_f32_bf16 v143, v199, v199, v143
  s_waitcnt lgkmcnt(6)
  v_mfma_f32_32x32x16_bf16 v[64:79], v[196:199], v[48:51], v[64:79]
  ds_read_b128 v[200:203], v130 offset:0
  ds_read_b64_tr_b16 v[32:33], v18 offset:8192
  ds_read_b64_tr_b16 v[34:35], v18 offset:9216
  s_waitcnt lgkmcnt(7)
  v_mfma_f32_32x32x16_bf16 v[80:95], v[196:199], v[52:55], v[80:95]
  ds_read_b64_tr_b16 v[36:37], v19 offset:8192
  ds_read_b64_tr_b16 v[38:39], v19 offset:9216
  s_waitcnt lgkmcnt(7)
  v_mfma_f32_32x32x16_bf16 v[96:111], v[196:199], v[56:59], v[96:111]
  ds_read_b64_tr_b16 v[40:41], v20 offset:8192
  ds_read_b64_tr_b16 v[42:43], v20 offset:9216
  s_waitcnt lgkmcnt(7)
  v_mfma_f32_32x32x16_bf16 v[112:127], v[196:199], v[60:63], v[112:127]
  ds_read_b64_tr_b16 v[44:45], v21 offset:8192
  ds_read_b64_tr_b16 v[46:47], v21 offset:9216
  s_waitcnt lgkmcnt(8)
  v_dot2_f32_bf16 v140, v200, s60, v140
  v_dot2_f32_bf16 v141, v200, v200, v141
  v_dot2_f32_bf16 v142, v201, s60, v142
  v_dot2_f32_bf16 v143, v201, v201, v143
  v_dot2_f32_bf16 v140, v202, s60, v140
  v_dot2_f32_bf16 v141, v202, v202, v141
  v_dot2_f32_bf16 v142, v203, s60, v142
  v_dot2_f32_bf16 v143, v203, v203, v143
  s_waitcnt lgkmcnt(6)
  v_mfma_f32_32x32x16_bf16 v[64:79], v[200:203], v[32:35], v[64:79]
  ds_read_b128 v[204:207], v131 offset:0
  ds_read_b64_tr_b16 v[48:49], v18 offset:12288
  ds_read_b64_tr_b16 v[50:51], v18 offset:13312
  s_waitcnt lgkmcnt(7)
  v_mfma_f32_32x32x16_bf16 v[80:95], v[200:203], v[36:39], v[80:95]
  ds_read_b64_tr_b16 v[52:53], v19 offset:12288
  ds_read_b64_tr_b16 v[54:55], v19 offset:13312
  s_waitcnt lgkmcnt(7)
  v_mfma_f32_32x32x16_bf16 v[96:111], v[200:203], v[40:43], v[96:111]
  ds_read_b64_tr_b16 v[56:57], v20 offset:12288
  ds_read_b64_tr_b16 v[58:59], v20 offset:13312
  s_waitcnt lgkmcnt(7)
  v_mfma_f32_32x32x16_bf16 v[112:127], v[200:203], v[44:47], v[112:127]
  ds_read_b64_tr_b16 v[60:61], v21 offset:12288
  ds_read_b64_tr_b16 v[62:63], v21 offset:13312
  s_waitcnt lgkmcnt(8)
  v_dot2_f32_bf16 v140, v204, s60, v140
  v_dot2_f32_bf16 v141, v204, v204, v141
  v_dot2_f32_bf16 v142, v205, s60, v142
  v_dot2_f32_bf16 v143, v205, v205, v143
  v_dot2_f32_bf16 v140, v206, s60, v140
  v_dot2_f32_bf16 v141, v206, v206, v141
  v_dot2_f32_bf16 v142, v207, s60, v142
  v_dot2_f32_bf16 v143, v207, v207, v143
  s_barrier
  s_waitcnt lgkmcnt(6)
  v_mfma_f32_32x32x16_bf16 v[64:79], v[204:207], v[48:51], v[64:79]
  ds_read_b128 v[176:179], v128 offset:16384
  ds_read_b64_tr_b16 v[32:33], v18 offset:16384
  ds_read_b64_tr_b16 v[34:35], v18 offset:17408
  s_waitcnt lgkmcnt(7)
  v_mfma_f32_32x32x16_bf16 v[80:95], v[204:207], v[52:55], v[80:95]
  ds_read_b64_tr_b16 v[36:37], v19 offset:16384
  ds_read_b64_tr_b16 v[38:39], v19 offset:17408
  s_waitcnt lgkmcnt(7)
  v_mfma_f32_32x32x16_bf16 v[96:111], v[204:207], v[56:59], v[96:111]
  ds_read_b64_tr_b16 v[40:41], v20 offset:16384
  ds_read_b64_tr_b16 v[42:43], v20 offset:17408
  s_waitcnt lgkmcnt(7)
  v_mfma_f32_32x32x16_bf16 v[112:127], v[204:207], v[60:63], v[112:127]
  ds_read_b64_tr_b16 v[44:45], v21 offset:16384
  ds_read_b64_tr_b16 v[46:47], v21 offset:17408
  s_waitcnt lgkmcnt(8)
  v_dot2_f32_bf16 v140, v176, s60, v140
  v_dot2_f32_bf16 v141, v176, v176, v141
  v_dot2_f32_bf16 v142, v177, s60, v142
  v_dot2_f32_bf16 v143, v177, v177, v143
  v_dot2_f32_bf16 v140, v178, s60, v140
  v_dot2_f32_bf16 v141, v178, v178, v141
  v_dot2_f32_bf16 v142, v179, s60, v142
  v_dot2_f32_bf16 v143, v179, v179, v143
  buffer_load_dwordx3 v[208:210], off, s[20:23], 0 sc1
  s_waitcnt lgkmcnt(6)
  v_mfma_f32_32x32x16_bf16 v[64:79], v[176:179], v[32:35], v[64:79]
  ds_read_b128 v[180:183], v129 offset:16384
  ds_read_b64_tr_b16 v[48:49], v18 offset:20480
  ds_read_b64_tr_b16 v[50:51], v18 offset:21504
  s_waitcnt lgkmcnt(7)
  v_mfma_f32_32x32x16_bf16 v[80:95], v[176:179], v[36:39], v[80:95]
  ds_read_b64_tr_b16 v[52:53], v19 offset:20480
  ds_read_b64_tr_b16 v[54:55], v19 offset:21504
  s_waitcnt lgkmcnt(7)
  v_mfma_f32_32x32x16_bf16 v[96:111], v[176:179], v[40:43], v[96:111]
  ds_read_b64_tr_b16 v[56:57], v20 offset:20480
  ds_read_b64_tr_b16 v[58:59], v20 offset:21504
  s_waitcnt lgkmcnt(7)
  v_mfma_f32_32x32x16_bf16 v[112:127], v[176:179], v[44:47], v[112:127]
  ds_read_b64_tr_b16 v[60:61], v21 offset:20480
  ds_read_b64_tr_b16 v[62:63], v21 offset:21504
  s_waitcnt lgkmcnt(8)
  v_dot2_f32_bf16 v140, v180, s60, v140
  v_dot2_f32_bf16 v141, v180, v180, v141
  v_dot2_f32_bf16 v142, v181, s60, v142
  v_dot2_f32_bf16 v143, v181, v181, v143
  v_dot2_f32_bf16 v140, v182, s60, v140
  v_dot2_f32_bf16 v141, v182, v182, v141
  v_dot2_f32_bf16 v142, v183, s60, v142
  v_dot2_f32_bf16 v143, v183, v183, v143
  s_waitcnt lgkmcnt(6)
  v_mfma_f32_32x32x16_bf16 v[64:79], v[180:183], v[48:51], v[64:79]
  ds_read_b128 v[184:187], v130 offset:16384
  ds_read_b64_tr_b16 v[32:33], v18 offset:24576
  ds_read_b64_tr_b16 v[34:35], v18 offset:25600
  s_waitcnt lgkmcnt(7)
  v_mfma_f32_32x32x16_bf16 v[80:95], v[180:183], v[52:55], v[80:95]
  ds_read_b64_tr_b16 v[36:37], v19 offset:24576
  ds_read_b64_tr_b16 v[38:39], v19 offset:25600
  s_waitcnt lgkmcnt(7)
  v_mfma_f32_32x32x16_bf16 v[96:111], v[180:183], v[56:59], v[96:111]
  ds_read_b64_tr_b16 v[40:41], v20 offset:24576
  ds_read_b64_tr_b16 v[42:43], v20 offset:25600
  s_waitcnt lgkmcnt(7)
  v_mfma_f32_32x32x16_bf16 v[112:127], v[180:183], v[60:63], v[112:127]
  ds_read_b64_tr_b16 v[44:45], v21 offset:24576
  ds_read_b64_tr_b16 v[46:47], v21 offset:25600
  s_waitcnt lgkmcnt(8)
  v_dot2_f32_bf16 v140, v184, s60, v140
  v_dot2_f32_bf16 v141, v184, v184, v141
  v_dot2_f32_bf16 v142, v185, s60, v142
  v_dot2_f32_bf16 v143, v185, v185, v143
  v_dot2_f32_bf16 v140, v186, s60, v140
  v_dot2_f32_bf16 v141, v186, v186, v141
  v_dot2_f32_bf16 v142, v187, s60, v142
  v_dot2_f32_bf16 v143, v187, v187, v143
  s_waitcnt lgkmcnt(6)
  v_mfma_f32_32x32x16_bf16 v[64:79], v[184:187], v[32:35], v[64:79]
  ds_read_b128 v[188:191], v131 offset:16384
  ds_read_b64_tr_b16 v[48:49], v18 offset:28672
  ds_read_b64_tr_b16 v[50:51], v18 offset:29696
  s_waitcnt lgkmcnt(7)
  v_mfma_f32_32x32x16_bf16 v[80:95], v[184:187], v[36:39], v[80:95]
  ds_read_b64_tr_b16 v[52:53], v19 offset:28672
  ds_read_b64_tr_b16 v[54:55], v19 offset:29696
  s_waitcnt lgkmcnt(7)
  v_mfma_f32_32x32x16_bf16 v[96:111], v[184:187], v[40:43], v[96:111]
  ds_read_b64_tr_b16 v[56:57], v20 offset:28672
  ds_read_b64_tr_b16 v[58:59], v20 offset:29696
  s_waitcnt lgkmcnt(7)
  v_mfma_f32_32x32x16_bf16 v[112:127], v[184:187], v[44:47], v[112:127]
  ds_read_b64_tr_b16 v[60:61], v21 offset:28672
  ds_read_b64_tr_b16 v[62:63], v21 offset:29696
  s_waitcnt lgkmcnt(8)
  v_dot2_f32_bf16 v140, v188, s60, v140
  v_dot2_f32_bf16 v141, v188, v188, v141
  v_dot2_f32_bf16 v142, v189, s60, v142
  v_dot2_f32_bf16 v143, v189, v189, v143
  v_dot2_f32_bf16 v140, v190, s60, v140
  v_dot2_f32_bf16 v141, v190, v190, v141
  v_dot2_f32_bf16 v142, v191, s60, v142
  v_dot2_f32_bf16 v143, v191, v191, v143
  s_barrier
  s_waitcnt lgkmcnt(6)
  v_mfma_f32_32x32x16_bf16 v[64:79], v[188:191], v[48:51], v[64:79]
  ds_read_b128 v[192:195], v128 offset:32768
  ds_read_b64_tr_b16 v[32:33], v18 offset:32768
  ds_read_b64_tr_b16 v[34:35], v18 offset:33792
  s_waitcnt lgkmcnt(7)
  v_mfma_f32_32x32x16_bf16 v[80:95], v[188:191], v[52:55], v[80:95]
  ds_read_b64_tr_b16 v[36:37], v19 offset:32768
  ds_read_b64_tr_b16 v[38:39], v19 offset:33792
  s_waitcnt lgkmcnt(7)
  v_mfma_f32_32x32x16_bf16 v[96:111], v[188:191], v[56:59], v[96:111]
  ds_read_b64_tr_b16 v[40:41], v20 offset:32768
  ds_read_b64_tr_b16 v[42:43], v20 offset:33792
  s_waitcnt lgkmcnt(7)
  v_mfma_f32_32x32x16_bf16 v[112:127], v[188:191], v[60:63], v[112:127]
  ds_read_b64_tr_b16 v[44:45], v21 offset:32768
  ds_read_b64_tr_b16 v[46:47], v21 offset:33792
  s_waitcnt lgkmcnt(8)
  v_dot2_f32_bf16 v140, v192, s60, v140
  v_dot2_f32_bf16 v141, v192, v192, v141
  v_dot2_f32_bf16 v142, v193, s60, v142
  v_dot2_f32_bf16 v143, v193, v193, v143
  v_dot2_f32_bf16 v140, v194, s60, v140
  v_dot2_f32_bf16 v141, v194, v194, v141
  v_dot2_f32_bf16 v142, v195, s60, v142
  v_dot2_f32_bf16 v143, v195, v195, v143
  s_waitcnt lgkmcnt(6)
  v_mfma_f32_32x32x16_bf16 v[64:79], v[192:195], v[32:35], v[64:79]
  ds_read_b128 v[196:199], v129 offset:32768
  ds_read_b64_tr_b16 v[48:49], v18 offset:36864
  ds_read_b64_tr_b16 v[50:51], v18 offset:37888
  s_waitcnt lgkmcnt(7)
  v_mfma_f32_32x32x16_bf16 v[80:95], v[192:195], v[36:39], v[80:95]
  ds_read_b64_tr_b16 v[52:53], v19 offset:36864
  ds_read_b64_tr_b16 v[54:55], v19 offset:37888
  s_waitcnt lgkmcnt(7)
  v_mfma_f32_32x32x16_bf16 v[96:111], v[192:195], v[40:43], v[96:111]
  ds_read_b64_tr_b16 v[56:57], v20 offset:36864
  ds_read_b64_tr_b16 v[58:59], v20 offset:37888
  s_waitcnt lgkmcnt(7)
  v_mfma_f32_32x32x16_bf16 v[112:127], v[192:195], v[44:47], v[112:127]
  ds_read_b64_tr_b16 v[60:61], v21 offset:36864
  ds_read_b64_tr_b16 v[62:63], v21 offset:37888
  s_waitcnt lgkmcnt(8)
  v_dot2_f32_bf16 v140, v196, s60, v140
  v_dot2_f32_bf16 v141, v196, v196, v141
  v_dot2_f32_bf16 v142, v197, s60, v142
  v_dot2_f32_bf16 v143, v197, v197, v143
  v_dot2_f32_bf16 v140, v198, s60, v140
  v_dot2_f32_bf16 v141, v198, v198, v141
  v_dot2_f32_bf16 v142, v199, s60, v142
  v_dot2_f32_bf16 v143, v199, v199, v143
  s_waitcnt lgkmcnt(6)
  v_mfma_f32_32x32x16_bf16 v[64:79], v[196:199], v[48:51], v[64:79]
  ds_read_b128 v[200:203], v130 offset:32768
  ds_read_b64_tr_b16 v[32:33], v18 offset:40960
  ds_read_b64_tr_b16 v[34:35], v18 offset:41984
  s_waitcnt lgkmcnt(7)
  v_mfma_f32_32x32x16_bf16 v[80:95], v[196:199], v[52:55], v[80:95]
  ds_read_b64_tr_b16 v[36:37], v19 offset:40960
  ds_read_b64_tr_b16 v[38:39], v19 offset:41984
  s_waitcnt lgkmcnt(7)
  v_mfma_f32_32x32x16_bf16 v[96:111], v[196:199], v[56:59], v[96:111]
  ds_read_b64_tr_b16 v[40:41], v20 offset:40960
  ds_read_b64_tr_b16 v[42:43], v20 offset:41984
  s_waitcnt lgkmcnt(7)
  v_mfma_f32_32x32x16_bf16 v[112:127], v[196:199], v[60:63], v[112:127]
  ds_read_b64_tr_b16 v[44:45], v21 offset:40960
  ds_read_b64_tr_b16 v[46:47], v21 offset:41984
  s_waitcnt lgkmcnt(8)
  v_dot2_f32_bf16 v140, v200, s60, v140
  v_dot2_f32_bf16 v141, v200, v200, v141
  v_dot2_f32_bf16 v142, v201, s60, v142
  v_dot2_f32_bf16 v143, v201, v201, v143
  v_dot2_f32_bf16 v140, v202, s60, v140
  v_dot2_f32_bf16 v141, v202, v202, v141
  v_dot2_f32_bf16 v142, v203, s60, v142
  v_dot2_f32_bf16 v143, v203, v203, v143
  s_waitcnt lgkmcnt(6)
  v_mfma_f32_32x32x16_bf16 v[64:79], v[200:203], v[32:35], v[64:79]
  ds_read_b128 v[204:207], v131 offset:32768
  ds_read_b64_tr_b16 v[48:49], v18 offset:45056
  ds_read_b64_tr_b16 v[50:51], v18 offset:46080
  s_waitcnt lgkmcnt(7)
  v_mfma_f32_32x32x16_bf16 v[80:95], v[200:203], v[36:39], v[80:95]
  ds_read_b64_tr_b16 v[52:53], v19 offset:45056
  ds_read_b64_tr_b16 v[54:55], v19 offset:46080
  s_waitcnt lgkmcnt(7)
  v_mfma_f32_32x32x16_bf16 v[96:111], v[200:203], v[40:43], v[96:111]
  ds_read_b64_tr_b16 v[56:57], v20 offset:45056
  ds_read_b64_tr_b16 v[58:59], v20 offset:46080
  s_waitcnt lgkmcnt(7)
  v_mfma_f32_32x32x16_bf16 v[112:127], v[200:203], v[44:47], v[112:127]
  ds_read_b64_tr_b16 v[60:61], v21 offset:45056
  ds_read_b64_tr_b16 v[62:63], v21 offset:46080
  s_waitcnt lgkmcnt(8)
  v_dot2_f32_bf16 v140, v204, s60, v140
  v_dot2_f32_bf16 v141, v204, v204, v141
  v_dot2_f32_bf16 v142, v205, s60, v142
  v_dot2_f32_bf16 v143, v205, v205, v143
  v_dot2_f32_bf16 v140, v206, s60, v140
  v_dot2_f32_bf16 v141, v206, v206, v141
  v_dot2_f32_bf16 v142, v207, s60, v142
  v_dot2_f32_bf16 v143, v207, v207, v143
  s_barrier
  s_waitcnt lgkmcnt(6)
  v_mfma_f32_32x32x16_bf16 v[64:79], v[204:207], v[48:51], v[64:79]
  ds_read_b64 v[144:145], v10 offset:0
  ds_read_b64 v[148:149], v10 offset:256
  ds_read_b64 v[152:153], v10 offset:512
  s_waitcnt lgkmcnt(7)
  v_mfma_f32_32x32x16_bf16 v[80:95], v[204:207], v[52:55], v[80:95]
  ds_read_b64 v[156:157], v10 offset:768
  s_waitcnt lgkmcnt(6)
  v_mfma_f32_32x32x16_bf16 v[96:111], v[204:207], v[56:59], v[96:111]
  s_waitcnt lgkmcnt(4)
  v_mfma_f32_32x32x16_bf16 v[112:127], v[204:207], v[60:63], v[112:127]
  s_nop 2
  v_add_f32 v2, v140, v142
  v_add_f32 v3, v141, v143
  v_mov_b32 v4, v2
  v_mov_b32 v5, v3
  s_nop 1
  v_permlane32_swap_b32 v2, v4
  v_permlane32_swap_b32 v3, v5
  s_nop 1
  v_add_f32 v2, v2, v4
  v_add_f32 v3, v3, v5
  v_mul_f32 v2, 0xbb000000, v2
  v_mul_f32 v3, 0x3b000000, v3
  v_cvt_pk_bf16_f32 v4, v2, v2
  v_and_b32 v4, 0xffff0000, v4
  v_sub_f32 v4, v2, v4
  v_cvt_pk_bf16_f32 v4, v2, v4
  v_cndmask_b32_e64 v28, 0, v4, s[90:91]
  v_cndmask_b32_e64 v29, 0, v4, s[90:91]
  v_fma_f32 v3, -v2, v2, v3
  s_waitcnt lgkmcnt(0)
  v_mfma_f32_32x32x16_bf16 v[64:79], v[28:31], v[144:147], v[64:79]
  v_max_f32 v3, 0, v3
  v_add_f32 v3, 0x3727c5ac, v3
  v_rsq_f32 v6, v3
  s_nop 0
  ds_write_b32 v12, v6
  ds_read_b128 v[160:163], v14 offset:0
  ds_read_b128 v[164:167], v14 offset:32
  ds_read_b128 v[168:171], v14 offset:64
  ds_read_b128 v[172:175], v14 offset:96
  v_mfma_f32_32x32x16_bf16 v[80:95], v[28:31], v[148:151], v[80:95]
  v_mfma_f32_32x32x16_bf16 v[96:111], v[28:31], v[152:155], v[96:111]
  v_mfma_f32_32x32x16_bf16 v[112:127], v[28:31], v[156:159], v[112:127]
  s_waitcnt vmcnt(0) lgkmcnt(0)
  s_mov_b32 s33, 0
L_tok_3:
  v_readfirstlane_b32 s76, v208
  v_readfirstlane_b32 s77, v209
  v_readfirstlane_b32 s101, v210
  s_and_b32 s62, s76, s101
  s_and_b32 s62, s62, 1
  s_cbranch_scc1 L_tokd_4
  s_add_u32 s33, s33, 1
  s_cmp_gt_u32 s33, 16384
  s_cbranch_scc1 L_tokd_4
  s_sleep 2
  buffer_load_dwordx3 v[208:210], off, s[20:23], 0 sc1
  s_waitcnt vmcnt(0)
  s_branch L_tok_3
L_tokd_4:
  s_xor_b32 s94, s101, s6
  s_and_b32 s94, s94, 4
  s_lshl_b32 s94, s94, 11
  s_add_u32 s84, s84, s94
  s_add_u32 s85, s84, 4096
  s_nop 7
  v_pk_mul_f32 v[64:65], v[64:65], v[160:161]
  v_pk_mul_f32 v[66:67], v[66:67], v[162:163]
  v_pk_mul_f32 v[68:69], v[68:69], v[164:165]
  v_pk_mul_f32 v[70:71], v[70:71], v[166:167]
  v_cvt_pk_bf16_f32 v32, v64, v65
  v_cvt_pk_bf16_f32 v33, v66, v67
  v_cvt_pk_bf16_f32 v34, v68, v69
  v_cvt_pk_bf16_f32 v35, v70, v71
  buffer_store_dwordx4 v[32:35], v13, s[8:11], s84 offen offset:0 sc1
  v_pk_mul_f32 v[72:73], v[72:73], v[168:169]
  v_pk_mul_f32 v[74:75], v[74:75], v[170:171]
  v_pk_mul_f32 v[76:77], v[76:77], v[172:173]
  v_pk_mul_f32 v[78:79], v[78:79], v[174:175]
  v_cvt_pk_bf16_f32 v36, v72, v73
  v_cvt_pk_bf16_f32 v37, v74, v75
  v_cvt_pk_bf16_f32 v38, v76, v77
  v_cvt_pk_bf16_f32 v39, v78, v79
  buffer_store_dwordx4 v[36:39], v13, s[8:11], s84 offen offset:512 sc1
  v_pk_mul_f32 v[80:81], v[80:81], v[160:161]
  v_pk_mul_f32 v[82:83], v[82:83], v[162:163]
  v_pk_mul_f32 v[84:85], v[84:85], v[164:165]
  v_pk_mul_f32 v[86:87], v[86:87], v[166:167]
  v_cvt_pk_bf16_f32 v40, v80, v81
  v_cvt_pk_bf16_f32 v41, v82, v83
  v_cvt_pk_bf16_f32 v42, v84, v85
  v_cvt_pk_bf16_f32 v43, v86, v87
  buffer_store_dwordx4 v[40:43], v13, s[8:11], s84 offen offset:2048 sc1
  v_pk_mul_f32 v[88:89], v[88:89], v[168:169]
  v_pk_mul_f32 v[90:91], v[90:91], v[170:171]
  v_pk_mul_f32 v[92:93], v[92:93], v[172:173]
  v_pk_mul_f32 v[94:95], v[94:95], v[174:175]
  v_cvt_pk_bf16_f32 v44, v88, v89
  v_cvt_pk_bf16_f32 v45, v90, v91
  v_cvt_pk_bf16_f32 v46, v92, v93
  v_cvt_pk_bf16_f32 v47, v94, v95
  buffer_store_dwordx4 v[44:47], v13, s[8:11], s84 offen offset:2560 sc1
  v_pk_mul_f32 v[96:97], v[96:97], v[160:161]
  v_pk_mul_f32 v[98:99], v[98:99], v[162:163]
  v_pk_mul_f32 v[100:101], v[100:101], v[164:165]
  v_pk_mul_f32 v[102:103], v[102:103], v[166:167]
  v_cvt_pk_bf16_f32 v48, v96, v97
  v_cvt_pk_bf16_f32 v49, v98, v99
  v_cvt_pk_bf16_f32 v50, v100, v101
  v_cvt_pk_bf16_f32 v51, v102, v103
  buffer_store_dwordx4 v[48:51], v13, s[8:11], s85 offen offset:0 sc1
  v_pk_mul_f32 v[104:105], v[104:105], v[168:169]
  v_pk_mul_f32 v[106:107], v[106:107], v[170:171]
  v_pk_mul_f32 v[108:109], v[108:109], v[172:173]
  v_pk_mul_f32 v[110:111], v[110:111], v[174:175]
  v_cvt_pk_bf16_f32 v52, v104, v105
  v_cvt_pk_bf16_f32 v53, v106, v107
  v_cvt_pk_bf16_f32 v54, v108, v109
  v_cvt_pk_bf16_f32 v55, v110, v111
  buffer_store_dwordx4 v[52:55], v13, s[8:11], s85 offen offset:512 sc1
  v_pk_mul_f32 v[112:113], v[112:113], v[160:161]
  v_pk_mul_f32 v[114:115], v[114:115], v[162:163]
  v_pk_mul_f32 v[116:117], v[116:117], v[164:165]
  v_pk_mul_f32 v[118:119], v[118:119], v[166:167]
  v_cvt_pk_bf16_f32 v56, v112, v113
  v_cvt_pk_bf16_f32 v57, v114, v115
  v_cvt_pk_bf16_f32 v58, v116, v117
  v_cvt_pk_bf16_f32 v59, v118, v119
  buffer_store_dwordx4 v[56:59], v13, s[8:11], s85 offen offset:2048 sc1
  v_pk_mul_f32 v[120:121], v[120:121], v[168:169]
  v_pk_mul_f32 v[122:123], v[122:123], v[170:171]
  v_pk_mul_f32 v[124:125], v[124:125], v[172:173]
  v_pk_mul_f32 v[126:127], v[126:127], v[174:175]
  v_cvt_pk_bf16_f32 v60, v120, v121
  v_cvt_pk_bf16_f32 v61, v122, v123
  v_cvt_pk_bf16_f32 v62, v124, v125
  v_cvt_pk_bf16_f32 v63, v126, v127
  buffer_store_dwordx4 v[60:63], v13, s[8:11], s85 offen offset:2560 sc1
  s_and_b32 s62, s78, 127
  s_and_b32 s78, s62, 63
  s_lshl_b32 s78, s78, 7
  s_lshr_b32 s63, s62, 6
  s_lshl_b32 s63, s63, 14
  s_add_u32 s78, s78, s63
  s_xor_b32 s63, s94, 0x2000
  s_add_u32 s78, s78, s63
  s_add_u32 s78, s78, s95
  s_branch L_mega_rot
L_helper:
  s_mov_b32 s95, 27262976
  s_sub_u32 s24, s7, 24
  s_lshl_b32 s24, s24, 3
  s_add_u32 s27, s24, s5
  s_lshl_b32 s27, s27, 10
  s_add_u32 s83, s24, s6
  v_lshlrev_b32 v3, 4, v1
  s_getpc_b64 s[28:29]
L_pc:
  s_sub_u32 s28, s28, L_pc-mega_kernel
  s_subb_u32 s29, s29, 0
  s_and_b32 s29, s29, 0xffff
  s_mov_b32 s30, L_text_end-mega_kernel
  s_mov_b32 s31, 0x20000
  buffer_load_dwordx4 v[220:223], v3, s[28:31], s27 offen
  v_and_b32 v4, 15, v1
  v_lshrrev_b32 v5, 2, v4
  v_and_b32 v4, 3, v4
  v_bfe_u32 v6, v1, 4, 1
  v_lshrrev_b32 v7, 5, v1
  v_lshl_add_u32 v8, v7, 2, v5
  v_lshlrev_b32 v9, 5, v6
  v_lshl_add_u32 v9, v4, 3, v9
  s_waitcnt lgkmcnt(0)
  s_mov_b32 s8, s54
  s_and_b32 s9, s55, 0xffff
  s_mov_b32 s10, 268435456
  s_mov_b32 s11, 0x20000
  s_mov_b32 s20, s52
  s_and_b32 s21, s53, 0xffff
  s_mov_b32 s22, 256
  s_mov_b32 s23, 0x20000
  s_cmp_lt_u32 s5, 2
  s_cbranch_scc1 L_colsum
  s_cmp_lt_u32 s5, 7
  s_cbranch_scc1 L_repack
  s_cmp_lg_u32 s83, 0
  s_cbranch_scc1 L_help_cal
  s_memrealtime s[28:29]
  s_waitcnt lgkmcnt(0)
  s_or_b32 s28, s28, 1
  v_mov_b32 v4, s28
  v_mov_b32 v5, s29
  s_mov_b64 exec, 1
  buffer_store_dwordx2 v[4:5], off, s[20:23], 0 sc1
  s_mov_b64 exec, -1
L_help_cal:
  s_cmp_lg_u32 s83, 56
  s_cbranch_scc1 L_help_warm
  s_setprio 3
  v_lshrrev_b32 v4, 3, v1
  v_lshlrev_b32 v5, 13, v4
  v_and_b32 v6, 7, v1
  v_lshl_add_u32 v5, v6, 4, v5
  s_mov_b32 s28, 29360128
  buffer_store_dwordx4 v[4:7], v5, s[8:11], s28 offen sc1
  s_add_u32 s28, s54, 29360128
  s_addc_u32 s29, s55, 0
  s_load_dword s30, s[28:29], 0x800 glc
  s_mov_b32 s56, -1
  s_mov_b32 s57, -1
  s_mov_b32 s31, 0
  s_waitcnt vmcnt(0) lgkmcnt(0)
L_cal:
  s_memtime s[58:59]
  s_waitcnt lgkmcnt(0)
  s_load_dword s30, s[28:29], s31 glc
  s_waitcnt lgkmcnt(0)
  s_memtime s[60:61]
  s_waitcnt lgkmcnt(0)
  s_sub_u32 s58, s60, s58
  s_min_u32 s59, s56, s58
  s_min_u32 s60, s57, s58
  s_bitcmp1_b32 s31, 13
  s_cselect_b32 s56, s56, s59
  s_cselect_b32 s57, s60, s57
  s_add_u32 s31, s31, 8192
  s_cmp_lt_u32 s31, 49152
  s_cbranch_scc1 L_cal
  s_setprio 0
  s_cmp_gt_u32 s56, s57
  s_cselect_b32 s30, 5, 1
  s_getreg_b32 s31, hwreg(HW_REG_XCC_ID)
  s_and_b32 s31, s31, 3
  s_cmp_eq_u32 s31, 3
  s_cselect_b32 s28, 0x44, 0
  s_xor_b32 s30, s30, s28
  s_lshl_b32 s31, s31, 4
  s_or_b32 s30, s30, s31
  v_mov_b32 v4, s30
  s_mov_b64 exec, 1
  buffer_store_dword v4, off, s[20:23], 0 offset:8 sc1
  s_branch L_help_done
L_help_warm:
  s_sleep 16
  s_sleep 16
  v_lshlrev_b32 v4, 7, v1
  s_mul_i32 s28, s83, 24576
  s_add_u32 s28, s28, 27262976
  buffer_load_dword v10, v4, s[8:11], s28 offen sc1
  s_add_u32 s28, s28, 8192
  buffer_load_dword v11, v4, s[8:11], s28 offen sc1
  s_add_u32 s28, s28, 8192
  buffer_load_dword v12, v4, s[8:11], s28 offen sc1
  s_add_u32 s28, s28, 8192
  s_branch L_help_done
L_repack:
  s_lshl_b32 s24, s83, 2
  s_add_u32 s24, s24, s5
  s_add_u32 s24, s24, 61
  s_cmp_eq_u32 s5, 2
  s_cselect_b32 s24, s83, s24
  s_cmp_ge_u32 s24, 288
  s_cbranch_scc1 L_help_done
  s_cmp_eq_u32 s5, 2
  s_sleep 16
  s_sleep 16
  s_cbranch_scc1 L_rep_go
  s_sleep 16
  s_sleep 16
L_rep_go:
  s_lshl_b32 s34, s5, 13
  v_lshrrev_b32 v10, 5, v1
  v_lshlrev_b32 v10, 10, v10
  v_and_b32 v11, 31, v1
  v_lshl_add_u32 v16, v11, 4, v10
  v_lshlrev_b32 v8, 9, v8
  s_add_u32 s31, s34, 49152
  v_add3_u32 v17, v8, v9, s31
  s_waitcnt lgkmcnt(0)
  s_mov_b32 s8, s54
  s_and_b32 s9, s55, 0xffff
  s_mov_b32 s10, 268435456
  s_mov_b32 s11, 0x20000
  s_add_u32 s25, s24, 0
  s_min_u32 s25, s25, 287
  s_lshr_b32 s26, s25, 1
  s_and_b32 s25, s25, 1
  s_cmp_ge_u32 s26, 32
  s_cselect_b32 s12, s48, s40
  s_cselect_b32 s13, s49, s41
  s_cselect_b32 s27, 32, 0
  s_cselect_b32 s57, 112, 32
  s_cselect_b32 s56, 1048576, 0
  s_and_b32 s13, s13, 0xffff
  s_lshl_b32 s14, s57, 14
  s_mov_b32 s15, 0x20000
  s_sub_u32 s26, s26, s27
  s_lshl_b32 s57, s57, 11
  s_mul_i32 s27, s57, s25
  s_lshl_b32 s27, s27, 2
  s_add_u32 s56, s56, s27
  s_lshl_b32 s27, s26, 11
  s_add_u32 s56, s56, s27
  s_add_u32 s56, s56, 23068672
  s_lshl_b32 s27, s26, 14
  s_lshl_b32 s25, s25, 9
  s_add_u32 s27, s27, s25
  s_add_u32 m0, s31, 0
  s_nop 0
  buffer_load_dwordx4 v16, s[12:15], s27 offen lds
  s_add_u32 s27, s27, 2048
  s_add_u32 m0, s31, 1024
  s_nop 0
  buffer_load_dwordx4 v16, s[12:15], s27 offen lds
  s_add_u32 s27, s27, 2048
  s_add_u32 m0, s31, 2048
  s_nop 0
  buffer_load_dwordx4 v16, s[12:15], s27 offen lds
  s_add_u32 s27, s27, 2048
  s_add_u32 m0, s31, 3072
  s_nop 0
  buffer_load_dwordx4 v16, s[12:15], s27 offen lds
  s_add_u32 s27, s27, 2048
  s_add_u32 m0, s31, 4096
  s_nop 0
  buffer_load_dwordx4 v16, s[12:15], s27 offen lds
  s_add_u32 s27, s27, 2048
  s_add_u32 m0, s31, 5120
  s_nop 0
  buffer_load_dwordx4 v16, s[12:15], s27 offen lds
  s_add_u32 s27, s27, 2048
  s_add_u32 m0, s31, 6144
  s_nop 0
  buffer_load_dwordx4 v16, s[12:15], s27 offen lds
  s_add_u32 s27, s27, 2048
  s_add_u32 m0, s31, 7168
  s_nop 0
  buffer_load_dwordx4 v16, s[12:15], s27 offen lds
  s_add_u32 s27, s27, 2048
  s_waitcnt vmcnt(0) lgkmcnt(0)
  ds_read_b64_tr_b16 v[32:33], v17 offset:0
  ds_read_b64_tr_b16 v[34:35], v17 offset:4096
  ds_read_b64_tr_b16 v[36:37], v17 offset:64
  ds_read_b64_tr_b16 v[38:39], v17 offset:4160
  ds_read_b64_tr_b16 v[40:41], v17 offset:128
  ds_read_b64_tr_b16 v[42:43], v17 offset:4224
  ds_read_b64_tr_b16 v[44:45], v17 offset:192
  ds_read_b64_tr_b16 v[46:47], v17 offset:4288
  ds_read_b64_tr_b16 v[48:49], v17 offset:256
  ds_read_b64_tr_b16 v[50:51], v17 offset:4352
  ds_read_b64_tr_b16 v[52:53], v17 offset:320
  ds_read_b64_tr_b16 v[54:55], v17 offset:4416
  ds_read_b64_tr_b16 v[56:57], v17 offset:384
  ds_read_b64_tr_b16 v[58:59], v17 offset:4480
  ds_read_b64_tr_b16 v[60:61], v17 offset:448
  ds_read_b64_tr_b16 v[62:63], v17 offset:4544
  s_waitcnt lgkmcnt(14)
  buffer_store_dwordx4 v[32:35], v3, s[8:11], s56 offen offset:0 sc1
  s_waitcnt lgkmcnt(12)
  buffer_store_dwordx4 v[36:39], v3, s[8:11], s56 offen offset:1024 sc1
  s_add_u32 s56, s56, s57
  s_waitcnt lgkmcnt(10)
  buffer_store_dwordx4 v[40:43], v3, s[8:11], s56 offen offset:0 sc1
  s_waitcnt lgkmcnt(8)
  buffer_store_dwordx4 v[44:47], v3, s[8:11], s56 offen offset:1024 sc1
  s_add_u32 s56, s56, s57
  s_waitcnt lgkmcnt(6)
  buffer_store_dwordx4 v[48:51], v3, s[8:11], s56 offen offset:0 sc1
  s_waitcnt lgkmcnt(4)
  buffer_store_dwordx4 v[52:55], v3, s[8:11], s56 offen offset:1024 sc1
  s_add_u32 s56, s56, s57
  s_waitcnt lgkmcnt(2)
  buffer_store_dwordx4 v[56:59], v3, s[8:11], s56 offen offset:0 sc1
  s_waitcnt lgkmcnt(0)
  buffer_store_dwordx4 v[60:63], v3, s[8:11], s56 offen offset:1024 sc1
  s_add_u32 s56, s56, s57
  s_cmp_lg_u32 s5, 2
  s_cbranch_scc1 L_help_done
  buffer_load_dwordx3 v[208:210], off, s[20:23], 0 sc1
  s_waitcnt vmcnt(0)
  s_mov_b32 s33, 0
L_tok_5:
  v_readfirstlane_b32 s76, v208
  v_readfirstlane_b32 s77, v209
  s_cmp_lg_u32 s76, 0
  s_cbranch_scc1 L_tokd_6
  s_add_u32 s33, s33, 1
  s_cmp_gt_u32 s33, 16384
  s_cbranch_scc1 L_tokd_6
  s_sleep 2
  buffer_load_dwordx3 v[208:210], off, s[20:23], 0 sc1
  s_waitcnt vmcnt(0)
  s_branch L_tok_5
L_tokd_6:
  s_cmp_lg_u32 s5, 2
  s_cbranch_scc1 L_pub_7
  s_lshl_b32 s33, s83, 7
  s_add_u32 s33, s33, s95
  s_add_u32 s33, s33, 1081344
  v_mov_b32 v2, s76
  v_mov_b32 v3, s77
  s_mov_b64 exec, 1
  buffer_store_dwordx2 v[2:3], off, s[8:11], s33 sc1
  s_mov_b64 exec, -1
L_pub_7:
  s_branch L_help_done
L_colsum:
  s_mul_i32 s26, s83, 28672
  s_cmp_eq_u32 s5, 0
  s_cselect_b32 s12, s44, s46
  s_cselect_b32 s13, s45, s47
  s_and_b32 s13, s13, 0xffff
  s_mov_b32 s14, 1835008
  s_mov_b32 s15, 0x20000
  s_sleep 16
  s_sleep 16
  s_sleep 16
  s_sleep 16
  buffer_load_dwordx4 v[192:195], v3, s[12:15], s26 offen offset:0
  buffer_load_dwordx4 v[196:199], v3, s[12:15], s26 offen offset:1024
  buffer_load_dwordx4 v[200:203], v3, s[12:15], s26 offen offset:2048
  buffer_load_dwordx4 v[204:207], v3, s[12:15], s26 offen offset:3072
  s_add_u32 s26, s26, 4096
  buffer_load_dwordx4 v[208:211], v3, s[12:15], s26 offen offset:0
  buffer_load_dwordx4 v[212:215], v3, s[12:15], s26 offen offset:1024
  buffer_load_dwordx4 v[216:219], v3, s[12:15], s26 offen offset:2048
  buffer_load_dwordx4 v[220:223], v3, s[12:15], s26 offen offset:3072
  s_add_u32 s26, s26, 4096
  buffer_load_dwordx4 v[224:227], v3, s[12:15], s26 offen offset:0
  buffer_load_dwordx4 v[228:231], v3, s[12:15], s26 offen offset:1024
  buffer_load_dwordx4 v[232:235], v3, s[12:15], s26 offen offset:2048
  buffer_load_dwordx4 v[236:239], v3, s[12:15], s26 offen offset:3072
  s_add_u32 s26, s26, 4096
  buffer_load_dwordx4 v[240:243], v3, s[12:15], s26 offen offset:0
  buffer_load_dwordx4 v[244:247], v3, s[12:15], s26 offen offset:1024
  buffer_load_dwordx4 v[248:251], v3, s[12:15], s26 offen offset:2048
  buffer_load_dwordx4 v[252:255], v3, s[12:15], s26 offen offset:3072
  s_add_u32 s26, s26, 4096
  buffer_load_dwordx4 v[192:195], v3, s[12:15], s26 offen offset:0
  buffer_load_dwordx4 v[196:199], v3, s[12:15], s26 offen offset:1024
  buffer_load_dwordx4 v[200:203], v3, s[12:15], s26 offen offset:2048
  buffer_load_dwordx4 v[204:207], v3, s[12:15], s26 offen offset:3072
  s_add_u32 s26, s26, 4096
  buffer_load_dwordx4 v[208:211], v3, s[12:15], s26 offen offset:0
  buffer_load_dwordx4 v[212:215], v3, s[12:15], s26 offen offset:1024
  buffer_load_dwordx4 v[216:219], v3, s[12:15], s26 offen offset:2048
  buffer_load_dwordx4 v[220:223], v3, s[12:15], s26 offen offset:3072
  s_add_u32 s26, s26, 4096
  buffer_load_dwordx4 v[224:227], v3, s[12:15], s26 offen offset:0
  buffer_load_dwordx4 v[228:231], v3, s[12:15], s26 offen offset:1024
  buffer_load_dwordx4 v[232:235], v3, s[12:15], s26 offen offset:2048
  buffer_load_dwordx4 v[236:239], v3, s[12:15], s26 offen offset:3072
  v_mov_b32 v4, 0
  s_barrier
  ds_read_b96 v[8:10], v4
  s_waitcnt lgkmcnt(0)
  v_readfirstlane_b32 s76, v8
  v_readfirstlane_b32 s77, v9
  v_readfirstlane_b32 s101, v10
  s_mov_b32 s75, 1
  s_branch L_help_fl
L_help_done:
  s_mov_b64 exec, -1
  buffer_load_dwordx3 v[208:210], off, s[20:23], 0 sc1
  s_waitcnt vmcnt(0) lgkmcnt(0)
  s_mov_b32 s33, 0
L_tok_8:
  v_readfirstlane_b32 s76, v208
  v_readfirstlane_b32 s77, v209
  v_readfirstlane_b32 s101, v210
  s_and_b32 s62, s76, s101
  s_and_b32 s62, s62, 1
  s_cbranch_scc1 L_tokd_9
  s_add_u32 s33, s33, 1
  s_cmp_gt_u32 s33, 16384
  s_cbranch_scc1 L_tokd_9
  s_sleep 2
  buffer_load_dwordx3 v[208:210], off, s[20:23], 0 sc1
  s_waitcnt vmcnt(0)
  s_branch L_tok_8
L_tokd_9:
  s_xor_b32 s94, s101, s6
  s_and_b32 s94, s94, 4
  s_lshl_b32 s94, s94, 11
  v_mov_b32 v4, 0
  ds_write_b96 v4, v[208:210]
  s_waitcnt lgkmcnt(0)
  s_barrier
L_help_fl:
  s_lshl_b32 s78, s83, 7
  s_add_u32 s78, s78, 28311552
  s_branch L_mega_rot
L_qkv_a_pub:
  s_waitcnt vmcnt(0) lgkmcnt(0)
  s_mov_b32 s33, 0
L_tok_10:
  v_readfirstlane_b32 s76, v208
  v_readfirstlane_b32 s77, v209
  v_readfirstlane_b32 s101, v210
  s_and_b32 s62, s76, s101
  s_and_b32 s62, s62, 1
  s_cbranch_scc1 L_tokd_11
  s_add_u32 s33, s33, 1
  s_cmp_gt_u32 s33, 16384
  s_cbranch_scc1 L_tokd_11
  s_sleep 2
  buffer_load_dwordx3 v[208:210], off, s[20:23], 0 sc1
  s_waitcnt vmcnt(0)
  s_branch L_tok_10
L_tokd_11:
  s_xor_b32 s94, s101, s6
  s_and_b32 s94, s94, 4
  s_lshl_b32 s94, s94, 11
L_mega_rot:
  s_lshr_b32 s33, s101, 4
  s_add_u32 s6, s6, s33
  s_and_b32 s6, s6, 7
  s_xor_b32 s94, s101, s6
  s_and_b32 s94, s94, 4
  s_lshl_b32 s94, s94, 11
L_mega_layer:
  s_lshr_b32 s24, s7, 2
  s_and_b32 s26, s6, 3
  s_lshl_b32 s26, s26, 3
  s_add_u32 s24, s24, s26
  s_and_b32 s25, s7, 3
  s_and_b32 s26, s6, 4
  s_add_u32 s25, s25, s26
  s_cmp_lg_u32 s5, 6
  s_cbranch_scc1 L_mattn_noaddr
  v_and_b32 v2, 1, v1
  v_mul_u32_u24 v2, 12, v2
  v_lshrrev_b32 v11, 1, v1
  v_cmp_le_u32 vcc, 3, v11
  v_subrev_u32 v12, 2, v11
  v_cndmask_b32 v11, v11, v12, vcc
  v_lshl_add_u32 v2, v11, 2, v2
  s_lshr_b32 s33, s24, 3
  s_lshl_b32 s32, s25, 5
  s_add_u32 s60, s33, s32
  s_and_b32 s62, s60, 127
  s_and_b32 s33, s62, 63
  s_lshl_b32 s33, s33, 7
  s_lshr_b32 s63, s62, 6
  s_lshl_b32 s63, s63, 14
  s_add_u32 s33, s33, s63
  s_xor_b32 s63, s94, 0x2000
  s_add_u32 s33, s33, s63
  s_sub_u32 s61, s60, 32
  s_and_b32 s62, s61, 127
  s_and_b32 s32, s62, 63
  s_lshl_b32 s32, s32, 7
  s_lshr_b32 s63, s62, 6
  s_lshl_b32 s63, s63, 14
  s_add_u32 s32, s32, s63
  s_xor_b32 s63, s94, 0x2000
  s_add_u32 s32, s32, s63
  s_xor_b32 s61, s61, s60
  s_and_b32 s61, s61, 128
  s_lshl_b32 s61, s61, 6
  s_xor_b32 s32, s32, s61
  v_mov_b32 v12, s33
  v_mov_b32 v11, s32
  v_cndmask_b32 v12, v12, v11, vcc
  v_lshl_add_u32 v2, v2, 7, v12
  v_add_u32 v2, s95, v2
L_mattn_noaddr:
  s_mov_b32 s29, s24
  s_mov_b32 s30, s25
  s_min_u32 s27, s7, 27
  s_mul_i32 s24, s27, 37
  s_lshr_b32 s24, s24, 8
  s_mul_i32 s25, s24, 7
  s_sub_u32 s25, s27, s25
  s_and_b32 s26, s6, 3
  s_lshl_b32 s26, s26, 3
  s_lshr_b32 s26, 0x715000e, s26
  s_and_b32 s26, s26, 0xff
  s_add_u32 s25, s25, s26
  v_lshrrev_b32 v3, 3, v1
  v_and_b32 v4, 7, v1
  v_lshrrev_b32 v5, 2, v4
  v_bfe_u32 v6, v3, 1, 1
  v_xor_b32 v5, v5, v6
  v_and_b32 v4, 3, v4
  v_lshl_add_u32 v4, v5, 2, v4
  v_lshrrev_b32 v5, 2, v3
  v_xor_b32 v4, v4, v5
  v_lshlrev_b32 v4, 4, v4
  v_mul_u32_u24 v3, 3584, v3
  s_lshl_b32 s28, s25, 7
  v_add3_u32 v168, v3, v4, s28
  s_mul_i32 s80, s5, 28672
  s_lshl_b32 s79, s5, 11
  s_mov_b32 s12, s44
  s_and_b32 s13, s45, 0xffff
  s_mov_b32 s14, 1835008
  s_mov_b32 s15, 0x20000
  s_sub_u32 s16, s46, 1024
  s_subb_u32 s17, s47, 0
  s_and_b32 s17, s17, 0xffff
  s_mov_b32 s18, 1836032
  s_mov_b32 s19, 0x20000
  s_and_b32 s26, s5, 1
  s_lshl_b32 s26, s26, 10
  v_lshl_add_u32 v169, v1, 4, s26
  v_xor_b32 v170, 1024, v169
  s_and_b32 s25, s7, 7
  s_lshl_b32 s25, s25, 2
  s_and_b32 s26, s5, 3
  s_add_u32 s25, s25, s26
  s_lshl_b32 s82, s25, 14
  s_add_u32 s82, s82, 23068672
  s_lshr_b32 s24, s7, 3
  s_lshl_b32 s26, s6, 3
  s_add_u32 s24, s24, s26
  s_and_b32 s26, s5, 2
  s_lshl_b32 s26, s26, 1
  s_add_u32 s24, s24, s26
  s_and_b32 s25, s7, 7
  s_lshl_b32 s25, s25, 1
  s_and_b32 s26, s5, 1
  s_add_u32 s25, s25, s26
  s_and_b32 s27, s24, 31
  s_lshl_b32 s27, s27, 16
  s_lshr_b32 s28, s25, 2
  s_lshl_b32 s28, s28, 14
  s_add_u32 s27, s27, s28
  s_and_b32 s28, s25, 3
  s_lshl_b32 s28, s28, 11
  s_add_u32 s27, s27, s28
  s_add_u32 s27, s27, s3
  s_add_u32 s72, s27, s94
  s_add_u32 s27, s72, 4282384384
  s_lshl_b32 s24, s24, 15
  s_lshl_b32 s25, s25, 6
  s_add_u32 s24, s24, s25
  v_and_b32 v3, 31, v1
  v_lshlrev_b32 v3, 10, v3
  v_lshrrev_b32 v4, 5, v1
  v_lshl_add_u32 v3, v4, 4, v3
  v_lshlrev_b32 v4, 4, v1
  s_cmp_eq_u32 s4, 0
  s_cselect_b64 vcc, -1, 0
  s_cselect_b32 s74, s24, s27
  s_cselect_b32 s73, 32, 1024
  s_cselect_b32 s96, s36, s54
  s_cselect_b32 s97, s37, s55
  s_cselect_b32 s98, 2097152, s10
  s_and_b32 s97, s97, 0xffff
  s_mov_b32 s99, 0x20000
  s_add_u32 s73, s73, s74
  v_cndmask_b32 v171, v4, v3, vcc
  s_mov_b32 s24, s29
  s_mov_b32 s25, s30
  s_lshl_b32 s83, s25, 5
  s_add_u32 s83, s83, s24
  s_and_b32 s62, s83, 127
  s_and_b32 s83, s62, 63
  s_lshl_b32 s83, s83, 7
  s_lshr_b32 s63, s62, 6
  s_lshl_b32 s63, s63, 14
  s_add_u32 s83, s83, s63
  s_xor_b32 s63, s94, 0x2000
  s_add_u32 s83, s83, s63
  s_add_u32 s83, s83, s95
  s_add_u32 s83, s83, 32768
  v_lshlrev_b32 v100, 4, v1
  v_and_b32 v102, 31, v1
  v_lshrrev_b32 v3, 5, v1
  s_lshl_b32 s27, s25, 3
  s_add_u32 s27, s27, s5
  s_lshr_b32 s32, s24, 3
  s_lshl_b32 s32, s32, 14
  s_and_b32 s33, s24, 7
  s_lshl_b32 s33, s33, 10
  s_add_u32 s32, s32, s33
  s_add_u32 s32, s32, s3
  s_add_u32 s32, s32, s94
  s_and_b32 s28, s27, 31
  s_lshl_b32 s28, s28, 16
  s_add_u32 s28, s28, s32
  s_lshl_b32 s30, s25, 3
  s_lshl_b32 s31, s5, 1
  s_add_u32 s35, s30, s31
  s_sub_u32 s30, s35, 8
  s_max_i32 s30, s30, 0
  s_xor_b32 s33, s30, s27
  s_and_b32 s33, s33, 32
  s_lshl_b32 s33, s33, 8
  s_xor_b32 s32, s32, s33
  s_and_b32 s30, s30, 31
  s_lshl_b32 s30, s30, 16
  s_add_u32 s30, s30, s32
  v_lshl_add_u32 v103, v3, 4, v102
  v_lshlrev_b32 v103, 4, v103
  v_lshlrev_b32 v13, 2, v3
  v_sub_u32 v13, v102, v13
  v_cvt_f32_i32 v13, v13
  v_mul_f32 v13, 0x71800000, v13
  v_add_f32 v16, 0x71000000, v13
  v_min_f32 v32, 0, v16
  v_min_f32_e64 v16, 0, -v16
  v_add_f32 v17, 0xf1000000, v13
  v_min_f32 v33, 0, v17
  v_min_f32_e64 v17, 0, -v17
  v_add_f32 v18, 0xf1c00000, v13
  v_min_f32 v34, 0, v18
  v_min_f32_e64 v18, 0, -v18
  v_add_f32 v19, 0xf2200000, v13
  v_min_f32 v35, 0, v19
  v_min_f32_e64 v19, 0, -v19
  v_add_f32 v20, 0xf2f00000, v13
  v_min_f32 v36, 0, v20
  v_min_f32_e64 v20, 0, -v20
  v_add_f32 v21, 0xf3080000, v13
  v_min_f32 v37, 0, v21
  v_min_f32_e64 v21, 0, -v21
  v_add_f32 v22, 0xf3180000, v13
  v_min_f32 v38, 0, v22
  v_min_f32_e64 v22, 0, -v22
  v_add_f32 v23, 0xf3280000, v13
  v_min_f32 v39, 0, v23
  v_min_f32_e64 v23, 0, -v23
  v_add_f32 v24, 0xf3780000, v13
  v_min_f32 v40, 0, v24
  v_min_f32_e64 v24, 0, -v24
  v_add_f32 v25, 0xf3840000, v13
  v_min_f32 v41, 0, v25
  v_min_f32_e64 v25, 0, -v25
  v_add_f32 v26, 0xf38c0000, v13
  v_min_f32 v42, 0, v26
  v_min_f32_e64 v26, 0, -v26
  v_add_f32 v27, 0xf3940000, v13
  v_min_f32 v43, 0, v27
  v_min_f32_e64 v27, 0, -v27
  v_add_f32 v28, 0xf3bc0000, v13
  v_mov_b32 v4, s76
  v_mov_b32 v5, s77
  s_cmp_eq_u32 s78, -1
  s_cselect_b32 s33, 1, s5
  s_mov_b64 exec, 1
  s_cmp_lg_u32 s75, 0
  s_cbranch_scc1 L_mattn_nw
  s_waitcnt vmcnt(0) lgkmcnt(0)
L_mattn_nw:
  s_mov_b32 s75, 0
  s_cmp_lg_u32 s33, 0
  s_barrier
  s_cbranch_scc1 L_pub_12
  buffer_store_dwordx2 v[4:5], off, s[8:11], s78 sc1
L_pub_12:
  s_mov_b64 exec, -1
  v_min_f32 v44, 0, v28
  v_min_f32_e64 v28, 0, -v28
  v_add_f32 v29, 0xf3c40000, v13
  v_min_f32 v45, 0, v29
  v_min_f32_e64 v29, 0, -v29
  v_add_f32 v30, 0xf3cc0000, v13
  v_min_f32 v46, 0, v30
  v_min_f32_e64 v30, 0, -v30
  v_add_f32 v31, 0xf3d40000, v13
  v_min_f32 v47, 0, v31
  v_min_f32_e64 v31, 0, -v31
  s_lshl_b32 s31, s5, 10
  s_add_u32 s31, s31, 114688
  v_add_u32 v8, s31, v100
  s_lshl_b32 s31, s5, 11
  s_add_u32 s31, s31, 114688
  v_add_u32 v9, s31, v100
  v_mov_b32 v10, 0xf149f2ca
  s_sub_i32 s34, 8, s27
  s_max_i32 s34, s34, 0
  v_cmp_gt_u32 vcc, 16, v102
  s_cmp_lt_u32 s35, 8
  s_cselect_b64 s[58:59], 0, vcc
  s_cselect_b64 s[56:57], 0, -1
  v_mov_b32 v12, 0x3f803f80
  v_cmp_eq_u32 vcc, 16, v102
  s_lshl_b32 s29, s5, 12
  s_add_u32 s29, s29, 114688
  v_cndmask_b32 v12, 0, v12, vcc
  v_mov_b32 v13, v12
  v_mov_b32 v14, v12
  v_mov_b32 v15, v12
  v_add_u32 v11, s29, v100
  v_cmp_le_u32 s[60:61], 16, v102
  s_cmp_lg_u32 s5, 6
  s_cbranch_scc1 L_mattn_np1
  s_cmp_eq_u32 s25, 0
  s_cselect_b32 exec_lo, 0x3f, 0x3ff
  s_mov_b32 exec_hi, 0
  s_mov_b32 s33, 0
  s_sleep 4
  buffer_load_dwordx2 v[104:105], v2, s[8:11], 0 offen sc1
  s_mov_b64 exec, s[60:61]
  ds_write_b128 v11, v[12:15] offset:16384
  ds_write_b128 v11, v[12:15] offset:17408
  ds_write_b128 v11, v[12:15] offset:18432
  ds_write_b128 v11, v[12:15] offset:19456
  s_cmp_eq_u32 s25, 0
  s_cselect_b32 exec_lo, 0x3f, 0x3ff
  s_mov_b32 exec_hi, 0
  s_branch L_mattn_pollh
L_mattn_poll:
  buffer_load_dwordx2 v[104:105], v2, s[8:11], 0 offen sc1
L_mattn_pollh:
  s_waitcnt vmcnt(0)
  v_cmp_ne_u64 vcc, s[76:77], v[104:105]
  s_add_u32 s33, s33, 1
  s_cbranch_vccz L_mattn_polled
  s_sleep 1
  s_cmp_lt_u32 s33, 16384
  s_cbranch_scc1 L_mattn_poll
L_mattn_polled:
  s_mov_b64 exec, -1
  s_branch L_mattn_nopoll
L_mattn_np1:
  s_mov_b64 exec, s[60:61]
  ds_write_b128 v11, v[12:15] offset:16384
  ds_write_b128 v11, v[12:15] offset:17408
  ds_write_b128 v11, v[12:15] offset:18432
  ds_write_b128 v11, v[12:15] offset:19456
  s_mov_b64 exec, -1
  s_lshr_b32 s33, s5, 1
  s_cmp_eq_u32 s33, 3
  s_cbranch_scc1 L_mattn_nopre
  s_add_u32 m0, s79, 0
  s_add_u32 s81, s80, 0
  buffer_load_dwordx4 v168, s[12:15], s81 offen lds
  buffer_load_dwordx4 v168, s[16:19], s81 offen offset:1024 lds
  s_add_u32 m0, s79, 16384
  s_add_u32 s81, s80, 229376
  buffer_load_dwordx4 v168, s[12:15], s81 offen lds
  buffer_load_dwordx4 v168, s[16:19], s81 offen offset:1024 lds
  s_cmp_lg_u32 s33, 2
  s_cbranch_scc1 L_mattn_px0
  s_add_u32 m0, s79, 4096
  s_add_u32 s81, s80, 57344
  buffer_load_dwordx4 v168, s[12:15], s81 offen lds
  buffer_load_dwordx4 v168, s[16:19], s81 offen offset:1024 lds
L_mattn_px0:
  s_cmp_lg_u32 s33, 1
  s_cbranch_scc1 L_mattn_px1
  s_add_u32 m0, s79, 24576
  s_add_u32 s81, s80, 344064
  buffer_load_dwordx4 v168, s[12:15], s81 offen lds
  buffer_load_dwordx4 v168, s[16:19], s81 offen offset:1024 lds
L_mattn_px1:
L_mattn_nopre:
  s_lshl_b32 s33, s4, 4
  s_add_u32 s33, s33, s5
  s_cmp_lg_u32 s33, 7
  s_cbranch_scc1 L_hia
  s_mov_b32 s33, 28344320
  v_lshl_add_u32 v2, v1, 7, s33
  buffer_load_dwordx2 v[172:173], v2, s[8:11], 0 offen sc1
L_hia:
L_mattn_nopoll:
  s_barrier
  buffer_load_dwordx4 v[4:7], v100, s[8:11], s28 offen
  s_mov_b64 exec, s[56:57]
  s_add_u32 m0, s31, 0
  s_add_u32 s33, s30, 4194304
  buffer_load_dwordx4 v100, s[8:11], s33 offen lds
  s_add_u32 m0, s31, 1024
  s_add_u32 s33, s30, 4259840
  buffer_load_dwordx4 v100, s[8:11], s33 offen lds
  s_mov_b64 exec, -1
  s_barrier
  s_mov_b64 exec, s[58:59]
  s_add_u32 m0, s29, 16384
  s_add_u32 s33, s30, 8388608
  buffer_load_dwordx4 v103, s[8:11], s33 offen lds
  s_add_u32 m0, s29, 17408
  s_add_u32 s33, s30, 8389120
  buffer_load_dwordx4 v103, s[8:11], s33 offen lds
  s_add_u32 m0, s29, 18432
  s_add_u32 s33, s30, 8454144
  buffer_load_dwordx4 v103, s[8:11], s33 offen lds
  s_add_u32 m0, s29, 19456
  s_add_u32 s33, s30, 8454656
  buffer_load_dwordx4 v103, s[8:11], s33 offen lds
  s_mov_b64 exec, -1
  s_cmp_lt_u32 s35, 8
  s_cbranch_scc0 L_mattn_w4
  s_waitcnt vmcnt(0)
L_mattn_w4:
  s_waitcnt vmcnt(4)
L_mattn_vj:
  s_barrier
  ds_read_b128 v[96:99], v8 offset:8192
  ds_read_b128 v[92:95], v8 offset:7168
  ds_read_b128 v[88:91], v8 offset:6144
  ds_read_b128 v[84:87], v8 offset:5120
  ds_read_b128 v[80:83], v8 offset:4096
  ds_read_b128 v[76:79], v8 offset:3072
  ds_read_b128 v[72:75], v8 offset:2048
  ds_read_b128 v[68:71], v8 offset:1024
  ds_read_b128 v[64:67], v8 offset:0
  s_add_u32 m0, s79, 32768
  s_add_u32 s81, s80, 458752
  buffer_load_dwordx4 v168, s[12:15], s81 offen lds
  buffer_load_dwordx4 v168, s[16:19], s81 offen offset:1024 lds
  s_waitcnt lgkmcnt(8)
  v_mfma_f32_32x32x16_bf16 v[112:127], v[96:99], v[4:7], v[32:47]
  s_waitcnt lgkmcnt(7)
  v_mfma_f32_32x32x16_bf16 v[128:143], v[92:95], v[4:7], 0
  s_nop 5
  v_max3_f32 v10, v112, v113, v10
  v_max3_f32 v10, v114, v115, v10
  v_max3_f32 v10, v116, v117, v10
  v_max3_f32 v10, v118, v119, v10
  v_max3_f32 v10, v120, v121, v10
  v_max3_f32 v10, v122, v123, v10
  v_max3_f32 v10, v124, v125, v10
  v_max3_f32 v10, v126, v127, v10
  s_waitcnt lgkmcnt(6)
  v_mfma_f32_32x32x16_bf16 v[112:127], v[88:91], v[4:7], 0
  s_cmp_eq_u32 s34, 8
  s_cbranch_scc1 L_mattn_p1e
  s_nop 0
  v_max3_f32 v10, v128, v129, v10
  v_max3_f32 v10, v130, v131, v10
  v_max3_f32 v10, v132, v133, v10
  v_max3_f32 v10, v134, v135, v10
  v_max3_f32 v10, v136, v137, v10
  v_max3_f32 v10, v138, v139, v10
  v_max3_f32 v10, v140, v141, v10
  v_max3_f32 v10, v142, v143, v10
  s_waitcnt lgkmcnt(5)
  v_mfma_f32_32x32x16_bf16 v[128:143], v[84:87], v[4:7], 0
  s_cmp_eq_u32 s34, 7
  s_cbranch_scc1 L_mattn_p1e
  s_nop 0
  v_max3_f32 v10, v112, v113, v10
  v_max3_f32 v10, v114, v115, v10
  v_max3_f32 v10, v116, v117, v10
  v_max3_f32 v10, v118, v119, v10
  v_max3_f32 v10, v120, v121, v10
  v_max3_f32 v10, v122, v123, v10
  v_max3_f32 v10, v124, v125, v10
  v_max3_f32 v10, v126, v127, v10
  s_waitcnt lgkmcnt(4)
  v_mfma_f32_32x32x16_bf16 v[112:127], v[80:83], v[4:7], 0
  s_cmp_eq_u32 s34, 6
  s_cbranch_scc1 L_mattn_p1e
  s_nop 0
  v_max3_f32 v10, v128, v129, v10
  v_max3_f32 v10, v130, v131, v10
  v_max3_f32 v10, v132, v133, v10
  v_max3_f32 v10, v134, v135, v10
  v_max3_f32 v10, v136, v137, v10
  v_max3_f32 v10, v138, v139, v10
  v_max3_f32 v10, v140, v141, v10
  v_max3_f32 v10, v142, v143, v10
  s_waitcnt lgkmcnt(3)
  v_mfma_f32_32x32x16_bf16 v[128:143], v[76:79], v[4:7], 0
  s_cmp_eq_u32 s34, 5
  s_cbranch_scc1 L_mattn_p1e
  s_nop 0
  v_max3_f32 v10, v112, v113, v10
  v_max3_f32 v10, v114, v115, v10
  v_max3_f32 v10, v116, v117, v10
  v_max3_f32 v10, v118, v119, v10
  v_max3_f32 v10, v120, v121, v10
  v_max3_f32 v10, v122, v123, v10
  v_max3_f32 v10, v124, v125, v10
  v_max3_f32 v10, v126, v127, v10
  s_waitcnt lgkmcnt(2)
  v_mfma_f32_32x32x16_bf16 v[112:127], v[72:75], v[4:7], 0
  s_cmp_eq_u32 s34, 4
  s_cbranch_scc1 L_mattn_p1e
  s_nop 0
  v_max3_f32 v10, v128, v129, v10
  v_max3_f32 v10, v130, v131, v10
  v_max3_f32 v10, v132, v133, v10
  v_max3_f32 v10, v134, v135, v10
  v_max3_f32 v10, v136, v137, v10
  v_max3_f32 v10, v138, v139, v10
  v_max3_f32 v10, v140, v141, v10
  v_max3_f32 v10, v142, v143, v10
  s_waitcnt lgkmcnt(1)
  v_mfma_f32_32x32x16_bf16 v[128:143], v[68:71], v[4:7], 0
  s_cmp_eq_u32 s34, 3
  s_cbranch_scc1 L_mattn_p1e
  s_nop 0
  v_max3_f32 v10, v112, v113, v10
  v_max3_f32 v10, v114, v115, v10
  v_max3_f32 v10, v116, v117, v10
  v_max3_f32 v10, v118, v119, v10
  v_max3_f32 v10, v120, v121, v10
  v_max3_f32 v10, v122, v123, v10
  v_max3_f32 v10, v124, v125, v10
  v_max3_f32 v10, v126, v127, v10
  s_waitcnt lgkmcnt(0)
  v_mfma_f32_32x32x16_bf16 v[112:127], v[64:67], v[4:7], v[16:31]
  s_cmp_eq_u32 s34, 2
  s_cbranch_scc1 L_mattn_p1e
  s_nop 0
  v_max3_f32 v10, v128, v129, v10
  v_max3_f32 v10, v130, v131, v10
  v_max3_f32 v10, v132, v133, v10
  v_max3_f32 v10, v134, v135, v10
  v_max3_f32 v10, v136, v137, v10
  v_max3_f32 v10, v138, v139, v10
  v_max3_f32 v10, v140, v141, v10
  v_max3_f32 v10, v142, v143, v10
  s_nop 1
  s_cmp_eq_u32 s34, 1
  s_cbranch_scc1 L_mattn_p1e
  s_nop 0
  v_max3_f32 v10, v112, v113, v10
  v_max3_f32 v10, v114, v115, v10
  v_max3_f32 v10, v116, v117, v10
  v_max3_f32 v10, v118, v119, v10
  v_max3_f32 v10, v120, v121, v10
  v_max3_f32 v10, v122, v123, v10
  v_max3_f32 v10, v124, v125, v10
  v_max3_f32 v10, v126, v127, v10
  s_nop 1
L_mattn_p1e:
  s_waitcnt vmcnt(2) lgkmcnt(0)
  s_lshl_b32 s33, s4, 4
  s_add_u32 s33, s33, s5
  s_cmp_lg_u32 s33, 7
  s_cbranch_scc1 L_hca
  v_cmp_ne_u64 vcc, s[76:77], v[172:173]
  s_mov_b32 s33, 28344320
  s_cbranch_vccz L_hca
  v_lshl_add_u32 v2, v1, 7, s33
  s_mov_b32 s33, 0
L_hca_poll:
  buffer_load_dwordx2 v[172:173], v2, s[8:11], 0 offen sc1
  s_waitcnt vmcnt(0)
  v_cmp_ne_u64 vcc, s[76:77], v[172:173]
  s_add_u32 s33, s33, 1
  s_cbranch_vccz L_hca_polled
  s_sleep 1
  s_cmp_lt_u32 s33, 16384
  s_cbranch_scc1 L_hca_poll
L_hca_polled:
  s_mov_b64 exec, -1
L_hca:
  s_lshl_b32 s33, s4, 4
  s_add_u32 s33, s33, s5
  s_cmp_lg_u32 s33, 7
  s_cbranch_scc1 L_hib
  s_mov_b32 s33, 28311552
  v_lshl_add_u32 v2, v1, 7, s33
  buffer_load_dwordx2 v[172:173], v2, s[8:11], 0 offen sc1
L_hib:
  s_barrier
  s_cmp_lt_u32 s5, 4
  s_cbranch_scc1 L_mattn_np
  s_setprio 1
L_mattn_np:
  ds_read_b128 v[160:163], v9 offset:32768
  ds_read_b128 v[164:167], v9 offset:33792
  v_mov_b32 v11, v10
  s_nop 1
  v_permlane32_swap_b32 v10, v11
  s_nop 1
  v_max_f32 v10, v10, v11
  v_sub_f32 v32, v32, v10
  v_sub_f32 v33, v33, v10
  v_sub_f32 v34, v34, v10
  v_sub_f32 v35, v35, v10
  v_sub_f32 v36, v36, v10
  v_sub_f32 v37, v37, v10
  v_sub_f32 v38, v38, v10
  v_sub_f32 v39, v39, v10
  v_sub_f32 v40, v40, v10
  v_sub_f32 v41, v41, v10
  v_sub_f32 v42, v42, v10
  v_sub_f32 v43, v43, v10
  v_sub_f32 v44, v44, v10
  v_sub_f32 v45, v45, v10
  v_sub_f32 v46, v46, v10
  v_sub_f32 v47, v47, v10
  s_nop 0
  v_mfma_f32_32x32x16_bf16 v[112:127], v[96:99], v[4:7], v[32:47]
  v_sub_f32 v48, 0, v10
  v_sub_f32 v49, 0, v10
  v_sub_f32 v50, 0, v10
  v_sub_f32 v51, 0, v10
  v_sub_f32 v52, 0, v10
  v_sub_f32 v53, 0, v10
  v_sub_f32 v54, 0, v10
  v_sub_f32 v55, 0, v10
  v_sub_f32 v56, 0, v10
  v_sub_f32 v57, 0, v10
  v_sub_f32 v58, 0, v10
  v_sub_f32 v59, 0, v10
  v_sub_f32 v60, 0, v10
  v_sub_f32 v61, 0, v10
  v_sub_f32 v62, 0, v10
  v_sub_f32 v63, 0, v10
  s_nop 0
  v_mfma_f32_32x32x16_bf16 v[128:143], v[92:95], v[4:7], v[48:63]
  v_sub_f32 v16, v16, v10
  v_sub_f32 v17, v17, v10
  v_sub_f32 v18, v18, v10
  v_sub_f32 v19, v19, v10
  v_sub_f32 v20, v20, v10
  v_sub_f32 v21, v21, v10
  v_sub_f32 v22, v22, v10
  v_sub_f32 v23, v23, v10
  v_sub_f32 v24, v24, v10
  v_sub_f32 v25, v25, v10
  v_sub_f32 v26, v26, v10
  v_sub_f32 v27, v27, v10
  v_sub_f32 v28, v28, v10
  v_sub_f32 v29, v29, v10
  v_sub_f32 v30, v30, v10
  v_sub_f32 v31, v31, v10
  v_exp_f32 v112, v112
  v_exp_f32 v113, v113
  v_exp_f32 v114, v114
  v_exp_f32 v115, v115
  v_exp_f32 v116, v116
  v_exp_f32 v117, v117
  v_exp_f32 v118, v118
  v_exp_f32 v119, v119
  v_cvt_pk_bf16_f32 v104, v112, v113
  v_cvt_pk_bf16_f32 v105, v114, v115
  v_cvt_pk_bf16_f32 v106, v116, v117
  v_cvt_pk_bf16_f32 v107, v118, v119
  s_cmp_ge_u32 s5, 4
  s_cbranch_scc1 L_nb_13
  s_add_u32 s81, s82, 0
  buffer_load_dwordx4 v[192:195], v169, s[8:11], s81 offen offset:0
  buffer_load_dwordx4 v[196:199], v170, s[8:11], s81 offen offset:0
  buffer_load_dwordx4 v[200:203], v169, s[8:11], s81 offen offset:2048
  buffer_load_dwordx4 v[204:207], v170, s[8:11], s81 offen offset:2048
  s_branch L_ne_14
L_nb_13:
  s_add_u32 s81, s80, 1490944
  buffer_load_dwordx4 v[192:195], v168, s[12:15], s81 offen
L_ne_14:
  v_exp_f32 v120, v120
  v_exp_f32 v121, v121
  v_exp_f32 v122, v122
  v_exp_f32 v123, v123
  s_waitcnt lgkmcnt(1)
  v_mfma_f32_32x32x16_bf16 v[144:159], v[160:163], v[104:107], 0
  ds_read_b128 v[160:163], v9 offset:30720
  v_exp_f32 v124, v124
  v_exp_f32 v125, v125
  v_exp_f32 v126, v126
  v_exp_f32 v127, v127
  v_cvt_pk_bf16_f32 v108, v120, v121
  v_cvt_pk_bf16_f32 v109, v122, v123
  v_cvt_pk_bf16_f32 v110, v124, v125
  v_cvt_pk_bf16_f32 v111, v126, v127
  s_cmp_eq_u32 s34, 8
  s_cbranch_scc1 L_mattn_t8
  v_exp_f32 v128, v128
  v_exp_f32 v129, v129
  v_exp_f32 v130, v130
  v_exp_f32 v131, v131
  s_waitcnt lgkmcnt(1)
  v_mfma_f32_32x32x16_bf16 v[144:159], v[164:167], v[108:111], v[144:159]
  ds_read_b128 v[164:167], v9 offset:31744
  v_exp_f32 v132, v132
  v_exp_f32 v133, v133
  v_exp_f32 v134, v134
  v_exp_f32 v135, v135
  v_mfma_f32_32x32x16_bf16 v[112:127], v[88:91], v[4:7], v[48:63]
  v_cvt_pk_bf16_f32 v104, v128, v129
  v_cvt_pk_bf16_f32 v105, v130, v131
  v_cvt_pk_bf16_f32 v106, v132, v133
  v_cvt_pk_bf16_f32 v107, v134, v135
  s_add_u32 m0, s79, 49152
  s_add_u32 s81, s80, 688128
  buffer_load_dwordx4 v168, s[12:15], s81 offen lds
  buffer_load_dwordx4 v168, s[16:19], s81 offen offset:1024 lds
  v_exp_f32 v136, v136
  v_exp_f32 v137, v137
  v_exp_f32 v138, v138
  v_exp_f32 v139, v139
  s_waitcnt lgkmcnt(1)
  v_mfma_f32_32x32x16_bf16 v[144:159], v[160:163], v[104:107], v[144:159]
  ds_read_b128 v[160:163], v9 offset:28672
  v_exp_f32 v140, v140
  v_exp_f32 v141, v141
  v_exp_f32 v142, v142
  v_exp_f32 v143, v143
  v_cvt_pk_bf16_f32 v108, v136, v137
  v_cvt_pk_bf16_f32 v109, v138, v139
  v_cvt_pk_bf16_f32 v110, v140, v141
  v_cvt_pk_bf16_f32 v111, v142, v143
  s_cmp_eq_u32 s34, 7
  s_cbranch_scc1 L_mattn_t7
  v_exp_f32 v112, v112
  v_exp_f32 v113, v113
  v_exp_f32 v114, v114
  v_exp_f32 v115, v115
  s_waitcnt lgkmcnt(1)
  v_mfma_f32_32x32x16_bf16 v[144:159], v[164:167], v[108:111], v[144:159]
  ds_read_b128 v[164:167], v9 offset:29696
  v_exp_f32 v116, v116
  v_exp_f32 v117, v117
  v_exp_f32 v118, v118
  v_exp_f32 v119, v119
  v_mfma_f32_32x32x16_bf16 v[128:143], v[84:87], v[4:7], v[48:63]
  v_cvt_pk_bf16_f32 v104, v112, v113
  v_cvt_pk_bf16_f32 v105, v114, v115
  v_cvt_pk_bf16_f32 v106, v116, v117
  v_cvt_pk_bf16_f32 v107, v118, v119
  s_cmp_ge_u32 s5, 4
  s_cbranch_scc1 L_nb_15
  s_add_u32 s81, s82, 4096
  buffer_load_dwordx4 v[208:211], v169, s[8:11], s81 offen offset:0
  buffer_load_dwordx4 v[212:215], v170, s[8:11], s81 offen offset:0
  buffer_load_dwordx4 v[216:219], v169, s[8:11], s81 offen offset:2048
  buffer_load_dwordx4 v[220:223], v170, s[8:11], s81 offen offset:2048
  s_branch L_ne_16
L_nb_15:
  s_add_u32 s81, s80, 1490944
  buffer_load_dwordx4 v[196:199], v168, s[16:19], s81 offen offset:1024
L_ne_16:
  v_exp_f32 v120, v120
  v_exp_f32 v121, v121
  v_exp_f32 v122, v122
  v_exp_f32 v123, v123
  s_waitcnt lgkmcnt(1)
  v_mfma_f32_32x32x16_bf16 v[144:159], v[160:163], v[104:107], v[144:159]
  ds_read_b128 v[160:163], v9 offset:26624
  v_exp_f32 v124, v124
  v_exp_f32 v125, v125
  v_exp_f32 v126, v126
  v_exp_f32 v127, v127
  v_cvt_pk_bf16_f32 v108, v120, v121
  v_cvt_pk_bf16_f32 v109, v122, v123
  v_cvt_pk_bf16_f32 v110, v124, v125
  v_cvt_pk_bf16_f32 v111, v126, v127
  s_cmp_eq_u32 s34, 6
  s_cbranch_scc1 L_mattn_t6
  s_setprio 0
  v_exp_f32 v128, v128
  v_exp_f32 v129, v129
  v_exp_f32 v130, v130
  v_exp_f32 v131, v131
  s_waitcnt lgkmcnt(1)
  v_mfma_f32_32x32x16_bf16 v[144:159], v[164:167], v[108:111], v[144:159]
  ds_read_b128 v[164:167], v9 offset:27648
  v_exp_f32 v132, v132
  v_exp_f32 v133, v133
  v_exp_f32 v134, v134
  v_exp_f32 v135, v135
  v_mfma_f32_32x32x16_bf16 v[112:127], v[80:83], v[4:7], v[48:63]
  v_cvt_pk_bf16_f32 v104, v128, v129
  v_cvt_pk_bf16_f32 v105, v130, v131
  v_cvt_pk_bf16_f32 v106, v132, v133
  v_cvt_pk_bf16_f32 v107, v134, v135
  s_add_u32 m0, s79, 65536
  s_add_u32 s81, s80, 917504
  buffer_load_dwordx4 v168, s[12:15], s81 offen lds
  buffer_load_dwordx4 v168, s[16:19], s81 offen offset:1024 lds
  v_exp_f32 v136, v136
  v_exp_f32 v137, v137
  v_exp_f32 v138, v138
  v_exp_f32 v139, v139
  s_waitcnt lgkmcnt(1)
  v_mfma_f32_32x32x16_bf16 v[144:159], v[160:163], v[104:107], v[144:159]
  ds_read_b128 v[160:163], v9 offset:24576
  v_exp_f32 v140, v140
  v_exp_f32 v141, v141
  v_exp_f32 v142, v142
  v_exp_f32 v143, v143
  v_cvt_pk_bf16_f32 v108, v136, v137
  v_cvt_pk_bf16_f32 v109, v138, v139
  v_cvt_pk_bf16_f32 v110, v140, v141
  v_cvt_pk_bf16_f32 v111, v142, v143
  s_cmp_eq_u32 s34, 5
  s_cbranch_scc1 L_mattn_t5
  v_exp_f32 v112, v112
  v_exp_f32 v113, v113
  v_exp_f32 v114, v114
  v_exp_f32 v115, v115
  s_waitcnt lgkmcnt(1)
  v_mfma_f32_32x32x16_bf16 v[144:159], v[164:167], v[108:111], v[144:159]
  ds_read_b128 v[164:167], v9 offset:25600
  v_exp_f32 v116, v116
  v_exp_f32 v117, v117
  v_exp_f32 v118, v118
  v_exp_f32 v119, v119
  v_mfma_f32_32x32x16_bf16 v[128:143], v[76:79], v[4:7], v[48:63]
  v_cvt_pk_bf16_f32 v104, v112, v113
  v_cvt_pk_bf16_f32 v105, v114, v115
  v_cvt_pk_bf16_f32 v106, v116, v117
  v_cvt_pk_bf16_f32 v107, v118, v119
  s_cmp_ge_u32 s5, 4
  s_cbranch_scc1 L_nb_17
  s_add_u32 s81, s82, 8192
  buffer_load_dwordx4 v[224:227], v169, s[8:11], s81 offen offset:0
  buffer_load_dwordx4 v[228:231], v170, s[8:11], s81 offen offset:0
  buffer_load_dwordx4 v[232:235], v169, s[8:11], s81 offen offset:2048
  buffer_load_dwordx4 v[236:239], v170, s[8:11], s81 offen offset:2048
  s_branch L_ne_18
L_nb_17:
  s_add_u32 s81, s80, 1605632
  buffer_load_dwordx4 v[200:203], v168, s[12:15], s81 offen
L_ne_18:
  v_exp_f32 v120, v120
  v_exp_f32 v121, v121
  v_exp_f32 v122, v122
  v_exp_f32 v123, v123
  s_waitcnt lgkmcnt(1)
  v_mfma_f32_32x32x16_bf16 v[144:159], v[160:163], v[104:107], v[144:159]
  ds_read_b128 v[160:163], v9 offset:22528
  v_exp_f32 v124, v124
  v_exp_f32 v125, v125
  v_exp_f32 v126, v126
  v_exp_f32 v127, v127
  v_cvt_pk_bf16_f32 v108, v120, v121
  v_cvt_pk_bf16_f32 v109, v122, v123
  v_cvt_pk_bf16_f32 v110, v124, v125
  v_cvt_pk_bf16_f32 v111, v126, v127
  s_cmp_eq_u32 s34, 4
  s_cbranch_scc1 L_mattn_t4
  v_exp_f32 v128, v128
  v_exp_f32 v129, v129
  v_exp_f32 v130, v130
  v_exp_f32 v131, v131
  s_waitcnt lgkmcnt(1)
  v_mfma_f32_32x32x16_bf16 v[144:159], v[164:167], v[108:111], v[144:159]
  ds_read_b128 v[164:167], v9 offset:23552
  v_exp_f32 v132, v132
  v_exp_f32 v133, v133
  v_exp_f32 v134, v134
  v_exp_f32 v135, v135
  v_mfma_f32_32x32x16_bf16 v[112:127], v[72:75], v[4:7], v[48:63]
  v_cvt_pk_bf16_f32 v104, v128, v129
  v_cvt_pk_bf16_f32 v105, v130, v131
  v_cvt_pk_bf16_f32 v106, v132, v133
  v_cvt_pk_bf16_f32 v107, v134, v135
  s_add_u32 m0, s79, 81920
  s_add_u32 s81, s80, 1146880
  buffer_load_dwordx4 v168, s[12:15], s81 offen lds
  buffer_load_dwordx4 v168, s[16:19], s81 offen offset:1024 lds
  v_exp_f32 v136, v136
  v_exp_f32 v137, v137
  v_exp_f32 v138, v138
  v_exp_f32 v139, v139
  s_waitcnt lgkmcnt(1)
  v_mfma_f32_32x32x16_bf16 v[144:159], v[160:163], v[104:107], v[144:159]
  ds_read_b128 v[160:163], v9 offset:20480
  v_exp_f32 v140, v140
  v_exp_f32 v141, v141
  v_exp_f32 v142, v142
  v_exp_f32 v143, v143
  v_cvt_pk_bf16_f32 v108, v136, v137
  v_cvt_pk_bf16_f32 v109, v138, v139
  v_cvt_pk_bf16_f32 v110, v140, v141
  v_cvt_pk_bf16_f32 v111, v142, v143
  s_cmp_eq_u32 s34, 3
  s_cbranch_scc1 L_mattn_t3
  v_exp_f32 v112, v112
  v_exp_f32 v113, v113
  v_exp_f32 v114, v114
  v_exp_f32 v115, v115
  s_waitcnt lgkmcnt(1)
  v_mfma_f32_32x32x16_bf16 v[144:159], v[164:167], v[108:111], v[144:159]
  ds_read_b128 v[164:167], v9 offset:21504
  v_exp_f32 v116, v116
  v_exp_f32 v117, v117
  v_exp_f32 v118, v118
  v_exp_f32 v119, v119
  v_mfma_f32_32x32x16_bf16 v[128:143], v[68:71], v[4:7], v[48:63]
  v_cvt_pk_bf16_f32 v104, v112, v113
  v_cvt_pk_bf16_f32 v105, v114, v115
  v_cvt_pk_bf16_f32 v106, v116, v117
  v_cvt_pk_bf16_f32 v107, v118, v119
  s_cmp_ge_u32 s5, 4
  s_cbranch_scc1 L_nb_19
  s_add_u32 s81, s82, 12288
  buffer_load_dwordx4 v[240:243], v169, s[8:11], s81 offen offset:0
  buffer_load_dwordx4 v[244:247], v170, s[8:11], s81 offen offset:0
  buffer_load_dwordx4 v[248:251], v169, s[8:11], s81 offen offset:2048
  buffer_load_dwordx4 v[252:255], v170, s[8:11], s81 offen offset:2048
  s_branch L_ne_20
L_nb_19:
  s_add_u32 s81, s80, 1605632
  buffer_load_dwordx4 v[204:207], v168, s[16:19], s81 offen offset:1024
L_ne_20:
  v_exp_f32 v120, v120
  v_exp_f32 v121, v121
  v_exp_f32 v122, v122
  v_exp_f32 v123, v123
  s_waitcnt lgkmcnt(1)
  v_mfma_f32_32x32x16_bf16 v[144:159], v[160:163], v[104:107], v[144:159]
  ds_read_b128 v[160:163], v9 offset:18432
  v_exp_f32 v124, v124
  v_exp_f32 v125, v125
  v_exp_f32 v126, v126
  v_exp_f32 v127, v127
  v_cvt_pk_bf16_f32 v108, v120, v121
  v_cvt_pk_bf16_f32 v109, v122, v123
  v_cvt_pk_bf16_f32 v110, v124, v125
  v_cvt_pk_bf16_f32 v111, v126, v127
  s_cmp_eq_u32 s34, 2
  s_cbranch_scc1 L_mattn_t2
  v_exp_f32 v128, v128
  v_exp_f32 v129, v129
  v_exp_f32 v130, v130
  v_exp_f32 v131, v131
  s_waitcnt lgkmcnt(1)
  v_mfma_f32_32x32x16_bf16 v[144:159], v[164:167], v[108:111], v[144:159]
  ds_read_b128 v[164:167], v9 offset:19456
  v_exp_f32 v132, v132
  v_exp_f32 v133, v133
  v_exp_f32 v134, v134
  v_exp_f32 v135, v135
  v_mfma_f32_32x32x16_bf16 v[112:127], v[64:67], v[4:7], v[16:31]
  v_cvt_pk_bf16_f32 v104, v128, v129
  v_cvt_pk_bf16_f32 v105, v130, v131
  v_cvt_pk_bf16_f32 v106, v132, v133
  v_cvt_pk_bf16_f32 v107, v134, v135
  s_add_u32 m0, s79, 98304
  s_add_u32 s81, s80, 1376256
  buffer_load_dwordx4 v168, s[12:15], s81 offen lds
  buffer_load_dwordx4 v168, s[16:19], s81 offen offset:1024 lds
  s_cmp_ge_u32 s5, 4
  s_cbranch_scc1 L_nr_21
  buffer_load_dwordx4 v[176:179], v171, s[96:99], s74 offen
  buffer_load_dwordx4 v[180:183], v171, s[96:99], s73 offen
L_nr_21:
  v_exp_f32 v136, v136
  v_exp_f32 v137, v137
  v_exp_f32 v138, v138
  v_exp_f32 v139, v139
  s_waitcnt lgkmcnt(1)
  v_mfma_f32_32x32x16_bf16 v[144:159], v[160:163], v[104:107], v[144:159]
  ds_read_b128 v[160:163], v9 offset:16384
  v_exp_f32 v140, v140
  v_exp_f32 v141, v141
  v_exp_f32 v142, v142
  v_exp_f32 v143, v143
  v_cvt_pk_bf16_f32 v108, v136, v137
  v_cvt_pk_bf16_f32 v109, v138, v139
  v_cvt_pk_bf16_f32 v110, v140, v141
  v_cvt_pk_bf16_f32 v111, v142, v143
  s_cmp_eq_u32 s34, 1
  s_cbranch_scc1 L_mattn_t1
  v_exp_f32 v112, v112
  v_exp_f32 v113, v113
  v_exp_f32 v114, v114
  v_exp_f32 v115, v115
  s_waitcnt lgkmcnt(1)
  v_mfma_f32_32x32x16_bf16 v[144:159], v[164:167], v[108:111], v[144:159]
  ds_read_b128 v[164:167], v9 offset:17408
  v_exp_f32 v116, v116
  v_exp_f32 v117, v117
  v_exp_f32 v118, v118
  v_exp_f32 v119, v119
  v_cvt_pk_bf16_f32 v104, v112, v113
  v_cvt_pk_bf16_f32 v105, v114, v115
  v_cvt_pk_bf16_f32 v106, v116, v117
  v_cvt_pk_bf16_f32 v107, v118, v119
  v_exp_f32 v120, v120
  v_exp_f32 v121, v121
  v_exp_f32 v122, v122
  v_exp_f32 v123, v123
  s_waitcnt lgkmcnt(1)
  v_mfma_f32_32x32x16_bf16 v[144:159], v[160:163], v[104:107], v[144:159]
  v_exp_f32 v124, v124
  v_exp_f32 v125, v125
  v_exp_f32 v126, v126
  v_exp_f32 v127, v127
  v_cvt_pk_bf16_f32 v108, v120, v121
  v_cvt_pk_bf16_f32 v109, v122, v123
  v_cvt_pk_bf16_f32 v110, v124, v125
  v_cvt_pk_bf16_f32 v111, v126, v127
  s_branch L_mattn_p2e
L_mattn_t8:
  s_add_u32 m0, s79, 49152
  s_add_u32 s81, s80, 688128
  buffer_load_dwordx4 v168, s[12:15], s81 offen lds
  buffer_load_dwordx4 v168, s[16:19], s81 offen offset:1024 lds
L_mattn_t7:
  s_cmp_ge_u32 s5, 4
  s_cbranch_scc1 L_nb_22
  s_add_u32 s81, s82, 4096
  buffer_load_dwordx4 v[208:211], v169, s[8:11], s81 offen offset:0
  buffer_load_dwordx4 v[212:215], v170, s[8:11], s81 offen offset:0
  buffer_load_dwordx4 v[216:219], v169, s[8:11], s81 offen offset:2048
  buffer_load_dwordx4 v[220:223], v170, s[8:11], s81 offen offset:2048
  s_branch L_ne_23
L_nb_22:
  s_add_u32 s81, s80, 1490944
  buffer_load_dwordx4 v[196:199], v168, s[16:19], s81 offen offset:1024
L_ne_23:
L_mattn_t6:
  s_add_u32 m0, s79, 65536
  s_add_u32 s81, s80, 917504
  buffer_load_dwordx4 v168, s[12:15], s81 offen lds
  buffer_load_dwordx4 v168, s[16:19], s81 offen offset:1024 lds
L_mattn_t5:
  s_cmp_ge_u32 s5, 4
  s_cbranch_scc1 L_nb_24
  s_add_u32 s81, s82, 8192
  buffer_load_dwordx4 v[224:227], v169, s[8:11], s81 offen offset:0
  buffer_load_dwordx4 v[228:231], v170, s[8:11], s81 offen offset:0
  buffer_load_dwordx4 v[232:235], v169, s[8:11], s81 offen offset:2048
  buffer_load_dwordx4 v[236:239], v170, s[8:11], s81 offen offset:2048
  s_branch L_ne_25
L_nb_24:
  s_add_u32 s81, s80, 1605632
  buffer_load_dwordx4 v[200:203], v168, s[12:15], s81 offen
L_ne_25:
L_mattn_t4:
  s_add_u32 m0, s79, 81920
  s_add_u32 s81, s80, 1146880
  buffer_load_dwordx4 v168, s[12:15], s81 offen lds
  buffer_load_dwordx4 v168, s[16:19], s81 offen offset:1024 lds
L_mattn_t3:
  s_cmp_ge_u32 s5, 4
  s_cbranch_scc1 L_nb_26
  s_add_u32 s81, s82, 12288
  buffer_load_dwordx4 v[240:243], v169, s[8:11], s81 offen offset:0
  buffer_load_dwordx4 v[244:247], v170, s[8:11], s81 offen offset:0
  buffer_load_dwordx4 v[248:251], v169, s[8:11], s81 offen offset:2048
  buffer_load_dwordx4 v[252:255], v170, s[8:11], s81 offen offset:2048
  s_branch L_ne_27
L_nb_26:
  s_add_u32 s81, s80, 1605632
  buffer_load_dwordx4 v[204:207], v168, s[16:19], s81 offen offset:1024
L_ne_27:
L_mattn_t2:
  s_add_u32 m0, s79, 98304
  s_add_u32 s81, s80, 1376256
  buffer_load_dwordx4 v168, s[12:15], s81 offen lds
  buffer_load_dwordx4 v168, s[16:19], s81 offen offset:1024 lds
  s_cmp_ge_u32 s5, 4
  s_cbranch_scc1 L_nr_28
  buffer_load_dwordx4 v[176:179], v171, s[96:99], s74 offen
  buffer_load_dwordx4 v[180:183], v171, s[96:99], s73 offen
L_nr_28:
L_mattn_t1:
L_mattn_p2e:
  s_waitcnt lgkmcnt(0)
  s_nop 0
  v_mfma_f32_32x32x16_bf16 v[144:159], v[164:167], v[108:111], v[144:159]
  s_setprio 0
  s_nop 15
  v_mov_b32 v11, v152
  v_mov_b32 v12, v152
  s_nop 1
  v_permlane32_swap_b32 v11, v12
  s_nop 1
  v_rcp_f32 v11, v11
  s_nop 0
  v_mul_f32 v144, v144, v11
  v_mul_f32 v145, v145, v11
  v_mul_f32 v146, v146, v11
  v_mul_f32 v147, v147, v11
  v_mul_f32 v148, v148, v11
  v_mul_f32 v149, v149, v11
  v_mul_f32 v150, v150, v11
  v_mul_f32 v151, v151, v11
  v_cvt_pk_bf16_f32 v104, v144, v145
  v_cvt_pk_bf16_f32 v105, v146, v147
  v_cvt_pk_bf16_f32 v106, v148, v149
  v_cvt_pk_bf16_f32 v107, v150, v151
  s_add_u32 s28, s28, 12582912
  buffer_store_dwordx4 v[104:107], v100, s[8:11], s28 offen sc1
  v_mov_b32 v4, s76
  v_mov_b32 v5, s77
  s_cmp_lg_u32 s5, 0
  s_mov_b64 exec, 1
  s_waitcnt vmcnt(0) lgkmcnt(0)
  s_barrier
  s_cbranch_scc1 L_pub_29
  buffer_store_dwordx2 v[4:5], off, s[8:11], s83 sc1
L_pub_29:
  s_mov_b64 exec, -1
  s_cmp_ge_u32 s5, 4
  s_cbranch_scc1 L_mwo_B
  s_lshr_b32 s24, s7, 3
  s_lshl_b32 s26, s6, 2
  s_add_u32 s24, s24, s26
  s_and_b32 s25, s7, 7
  v_lshlrev_b32 v17, 4, v1
  s_and_b32 s26, s5, 1
  s_lshl_b32 s27, s26, 10
  v_add_u32 v18, s27, v17
  v_xor_b32 v19, 1024, v18
  s_mul_i32 s29, s5, 8
  s_mul_i32 s32, s25, 32
  s_add_u32 s32, s32, s29
  s_lshl_b32 s32, s32, 11
  s_add_u32 s32, s32, 23068672
  s_bfe_u32 s26, s5, 0x10001
  s_andn2_b32 s30, s24, 3
  s_add_u32 s30, s30, s24
  s_xor_b32 s27, s26, 0
  s_lshl_b32 s27, s27, 2
  s_add_u32 s27, s27, s30
  s_and_b32 s27, s27, 31
  s_lshl_b32 s27, s27, 2
  s_add_u32 s27, s27, s5
  s_lshl_b32 s27, s27, 14
  s_add_u32 s27, s27, s3
  s_add_u32 s27, s27, s94
  s_add_u32 s56, s27, 12582912
  s_xor_b32 s27, s26, 1
  s_lshl_b32 s27, s27, 2
  s_add_u32 s27, s27, s30
  s_and_b32 s27, s27, 31
  s_lshl_b32 s27, s27, 2
  s_add_u32 s27, s27, s5
  s_lshl_b32 s27, s27, 14
  s_add_u32 s27, s27, s3
  s_add_u32 s27, s27, s94
  s_add_u32 s57, s27, 12582912
  s_lshl_b32 s58, s26, 2
  s_add_u32 s58, s58, s30
  s_and_b32 s59, s5, 1
  s_lshl_b32 s27, s25, 1
  s_add_u32 s59, s59, s27
  s_add_u32 s84, s72, 16777216
  s_lshl_b32 s62, s58, 5
  s_and_b32 s62, s62, 1023
  s_and_b32 s85, s62, 63
  s_lshl_b32 s85, s85, 7
  s_lshr_b32 s63, s62, 6
  s_lshl_b32 s63, s63, 14
  s_add_u32 s85, s85, s63
  s_xor_b32 s63, s94, 0x2000
  s_add_u32 s85, s85, s63
  s_lshl_b32 s28, s59, 8
  s_add_u32 s85, s85, s28
  s_add_u32 s85, s85, s3
  s_add_u32 s85, s85, 18874368
  s_lshl_b32 s78, s24, 3
  s_add_u32 s78, s78, s25
  s_and_b32 s62, s78, 127
  s_and_b32 s78, s62, 63
  s_lshl_b32 s78, s78, 7
  s_lshr_b32 s63, s62, 6
  s_lshl_b32 s63, s63, 14
  s_add_u32 s78, s78, s63
  s_xor_b32 s63, s94, 0x2000
  s_add_u32 s78, s78, s63
  s_add_u32 s78, s78, s95
  s_add_u32 s78, s78, 65536
  v_and_b32 v3, 31, v1
  v_lshlrev_b32 v29, 3, v3
  s_and_b32 s26, s5, 3
  s_lshr_b32 s28, s5, 2
  s_lshl_b32 s28, s28, 2
  s_xor_b32 s27, s26, 1
  s_mul_i32 s27, s27, 3
  s_add_u32 s27, s27, s28
  s_add_u32 s27, s27, 0
  s_lshl_b32 s27, s27, 12
  s_add_u32 s27, s27, 114688
  v_add_u32 v21, s27, v17
  s_xor_b32 s27, s26, 2
  s_mul_i32 s27, s27, 3
  s_add_u32 s27, s27, s28
  s_add_u32 s27, s27, 1
  s_lshl_b32 s27, s27, 12
  s_add_u32 s27, s27, 114688
  v_add_u32 v22, s27, v17
  s_xor_b32 s27, s26, 3
  s_mul_i32 s27, s27, 3
  s_add_u32 s27, s27, s28
  s_add_u32 s27, s27, 2
  s_lshl_b32 s27, s27, 12
  s_add_u32 s27, s27, 114688
  v_add_u32 v23, s27, v17
  s_mul_i32 s27, s26, 12288
  s_add_u32 s27, s27, 114688
  v_add_u32 v24, s27, v17
  s_mov_b32 s88, 0xffff0000
  s_mov_b32 s89, 0x3f803f80
  s_mov_b64 exec, -1
  s_cmp_lg_u32 s4, 0
  s_cbranch_scc1 L_rsw_30
  v_permlane32_swap_b32 v176, v178
  v_permlane32_swap_b32 v177, v179
  v_permlane32_swap_b32 v180, v182
  v_permlane32_swap_b32 v181, v183
  s_nop 1
L_rsw_30:
  v_lshlrev_b32 v64, 16, v176
  v_and_b32 v65, s88, v176
  v_lshlrev_b32 v66, 16, v177
  v_and_b32 v67, s88, v177
  v_lshlrev_b32 v68, 16, v178
  v_and_b32 v69, s88, v178
  v_lshlrev_b32 v70, 16, v179
  v_and_b32 v71, s88, v179
  v_lshlrev_b32 v72, 16, v180
  v_and_b32 v73, s88, v180
  v_lshlrev_b32 v74, 16, v181
  v_and_b32 v75, s88, v181
  v_lshlrev_b32 v76, 16, v182
  v_and_b32 v77, s88, v182
  v_lshlrev_b32 v78, 16, v183
  v_and_b32 v79, s88, v183
  s_cmp_lg_u32 s5, 0
  s_cbranch_scc1 L_mwo_nopoll
  s_lshl_b32 s27, s6, 5
  s_and_b32 s62, s27, 127
  s_and_b32 s33, s62, 63
  s_lshl_b32 s33, s33, 7
  s_lshr_b32 s63, s62, 6
  s_lshl_b32 s63, s63, 14
  s_add_u32 s33, s33, s63
  s_xor_b32 s63, s94, 0x2000
  s_add_u32 s33, s33, s63
  s_add_u32 s33, s33, s95
  s_add_u32 s33, s33, 32768
  v_lshl_add_u32 v2, v1, 7, s33
  s_mov_b32 exec_lo, 0xffffffff
  s_mov_b32 exec_hi, 0x0
  s_mov_b32 s33, 0
L_mwo_poll:
  buffer_load_dwordx2 v[26:27], v2, s[8:11], 0 offen sc1
  s_waitcnt vmcnt(0)
  v_cmp_ne_u64 vcc, s[76:77], v[26:27]
  s_add_u32 s33, s33, 1
  s_cbranch_vccz L_mwo_polled
  s_sleep 1
  s_cmp_lt_u32 s33, 16384
  s_cbranch_scc1 L_mwo_poll
L_mwo_polled:
  s_mov_b64 exec, -1
L_mwo_nopoll:
  s_barrier
  buffer_load_dwordx4 v[128:131], v17, s[8:11], s57 offen offset:0
  buffer_load_dwordx4 v[132:135], v17, s[8:11], s57 offen offset:1024
  buffer_load_dwordx4 v[136:139], v17, s[8:11], s57 offen offset:2048
  buffer_load_dwordx4 v[140:143], v17, s[8:11], s57 offen offset:3072
  s_add_u32 s57, s57, 4096
  buffer_load_dwordx4 v[144:147], v17, s[8:11], s57 offen offset:0
  buffer_load_dwordx4 v[148:151], v17, s[8:11], s57 offen offset:1024
  buffer_load_dwordx4 v[152:155], v17, s[8:11], s57 offen offset:2048
  buffer_load_dwordx4 v[156:159], v17, s[8:11], s57 offen offset:3072
  s_waitcnt vmcnt(7)
  v_mfma_f32_32x32x16_bf16 v[96:111], v[192:195], v[128:131], 0
  buffer_load_dwordx4 v[160:163], v17, s[8:11], s56 offen offset:0
  v_mfma_f32_32x32x16_bf16 v[112:127], v[196:199], v[128:131], 0
  buffer_load_dwordx4 v[164:167], v17, s[8:11], s56 offen offset:1024
  s_waitcnt vmcnt(8)
  v_mfma_f32_32x32x16_bf16 v[96:111], v[200:203], v[132:135], v[96:111]
  buffer_load_dwordx4 v[168:171], v17, s[8:11], s56 offen offset:2048
  v_mfma_f32_32x32x16_bf16 v[112:127], v[204:207], v[132:135], v[112:127]
  buffer_load_dwordx4 v[172:175], v17, s[8:11], s56 offen offset:3072
  s_waitcnt vmcnt(9)
  v_mfma_f32_32x32x16_bf16 v[96:111], v[208:211], v[136:139], v[96:111]
  s_add_u32 s56, s56, 4096
  buffer_load_dwordx4 v[176:179], v17, s[8:11], s56 offen offset:0
  v_mfma_f32_32x32x16_bf16 v[112:127], v[212:215], v[136:139], v[112:127]
  buffer_load_dwordx4 v[180:183], v17, s[8:11], s56 offen offset:1024
  s_waitcnt vmcnt(10)
  v_mfma_f32_32x32x16_bf16 v[96:111], v[216:219], v[140:143], v[96:111]
  buffer_load_dwordx4 v[184:187], v17, s[8:11], s56 offen offset:2048
  v_mfma_f32_32x32x16_bf16 v[112:127], v[220:223], v[140:143], v[112:127]
  buffer_load_dwordx4 v[188:191], v17, s[8:11], s56 offen offset:3072
  s_waitcnt vmcnt(11)
  v_mfma_f32_32x32x16_bf16 v[96:111], v[224:227], v[144:147], v[96:111]
  v_mfma_f32_32x32x16_bf16 v[112:127], v[228:231], v[144:147], v[112:127]
  s_waitcnt vmcnt(10)
  v_mfma_f32_32x32x16_bf16 v[96:111], v[232:235], v[148:151], v[96:111]
  v_mfma_f32_32x32x16_bf16 v[112:127], v[236:239], v[148:151], v[112:127]
  s_waitcnt vmcnt(9)
  v_mfma_f32_32x32x16_bf16 v[96:111], v[240:243], v[152:155], v[96:111]
  v_mfma_f32_32x32x16_bf16 v[112:127], v[244:247], v[152:155], v[112:127]
  s_waitcnt vmcnt(8)
  v_mfma_f32_32x32x16_bf16 v[96:111], v[248:251], v[156:159], v[96:111]
  v_mfma_f32_32x32x16_bf16 v[112:127], v[252:255], v[156:159], v[112:127]
  s_waitcnt vmcnt(7)
  v_mfma_f32_32x32x16_bf16 v[80:95], v[196:199], v[160:163], 0
  s_nop 7
  ds_write_b128 v22, v[96:99] offset:0
  s_waitcnt vmcnt(6)
  v_mfma_f32_32x32x16_bf16 v[80:95], v[204:207], v[164:167], v[80:95]
  ds_write_b128 v22, v[100:103] offset:1024
  s_waitcnt vmcnt(5)
  v_mfma_f32_32x32x16_bf16 v[80:95], v[212:215], v[168:171], v[80:95]
  ds_write_b128 v22, v[104:107] offset:2048
  s_waitcnt vmcnt(4)
  v_mfma_f32_32x32x16_bf16 v[80:95], v[220:223], v[172:175], v[80:95]
  ds_write_b128 v22, v[108:111] offset:3072
  s_waitcnt vmcnt(3)
  v_mfma_f32_32x32x16_bf16 v[80:95], v[228:231], v[176:179], v[80:95]
  ds_write_b128 v23, v[112:115] offset:0
  v_mfma_f32_32x32x16_bf16 v[64:79], v[192:195], v[160:163], v[64:79]
  ds_write_b128 v23, v[116:119] offset:1024
  s_waitcnt vmcnt(2)
  v_mfma_f32_32x32x16_bf16 v[80:95], v[236:239], v[180:183], v[80:95]
  ds_write_b128 v23, v[120:123] offset:2048
  v_mfma_f32_32x32x16_bf16 v[64:79], v[200:203], v[164:167], v[64:79]
  ds_write_b128 v23, v[124:127] offset:3072
  s_waitcnt vmcnt(1)
  v_mfma_f32_32x32x16_bf16 v[80:95], v[244:247], v[184:187], v[80:95]
  v_mfma_f32_32x32x16_bf16 v[64:79], v[208:211], v[168:171], v[64:79]
  s_waitcnt vmcnt(0)
  v_mfma_f32_32x32x16_bf16 v[80:95], v[252:255], v[188:191], v[80:95]
  v_mfma_f32_32x32x16_bf16 v[64:79], v[216:219], v[172:175], v[64:79]
  s_nop 9
  ds_write_b128 v21, v[80:83] offset:0
  v_mfma_f32_32x32x16_bf16 v[64:79], v[224:227], v[176:179], v[64:79]
  ds_write_b128 v21, v[84:87] offset:1024
  v_mfma_f32_32x32x16_bf16 v[64:79], v[232:235], v[180:183], v[64:79]
  ds_write_b128 v21, v[88:91] offset:2048
  v_mfma_f32_32x32x16_bf16 v[64:79], v[240:243], v[184:187], v[64:79]
  ds_write_b128 v21, v[92:95] offset:3072
  v_mfma_f32_32x32x16_bf16 v[64:79], v[248:251], v[188:191], v[64:79]
  s_waitcnt lgkmcnt(0)
  s_barrier
  ds_read_b128 v[128:131], v24 offset:4096
  ds_read_b128 v[132:135], v24 offset:5120
  ds_read_b128 v[136:139], v24 offset:6144
  ds_read_b128 v[140:143], v24 offset:7168
  ds_read_b128 v[144:147], v24 offset:8192
  ds_read_b128 v[148:151], v24 offset:9216
  ds_read_b128 v[152:155], v24 offset:10240
  ds_read_b128 v[156:159], v24 offset:11264
  ds_read_b128 v[96:99], v24 offset:0
  ds_read_b128 v[100:103], v24 offset:1024
  ds_read_b128 v[104:107], v24 offset:2048
  ds_read_b128 v[108:111], v24 offset:3072
  s_waitcnt lgkmcnt(11)
  v_pk_add_f32 v[64:65], v[64:65], v[128:129]
  v_pk_add_f32 v[66:67], v[66:67], v[130:131]
  s_waitcnt lgkmcnt(10)
  v_pk_add_f32 v[68:69], v[68:69], v[132:133]
  v_pk_add_f32 v[70:71], v[70:71], v[134:135]
  s_waitcnt lgkmcnt(9)
  v_pk_add_f32 v[72:73], v[72:73], v[136:137]
  v_pk_add_f32 v[74:75], v[74:75], v[138:139]
  s_waitcnt lgkmcnt(8)
  v_pk_add_f32 v[76:77], v[76:77], v[140:141]
  v_pk_add_f32 v[78:79], v[78:79], v[142:143]
  s_waitcnt lgkmcnt(7)
  v_pk_add_f32 v[64:65], v[64:65], v[144:145]
  v_pk_add_f32 v[66:67], v[66:67], v[146:147]
  s_waitcnt lgkmcnt(6)
  v_pk_add_f32 v[68:69], v[68:69], v[148:149]
  v_pk_add_f32 v[70:71], v[70:71], v[150:151]
  s_waitcnt lgkmcnt(5)
  v_pk_add_f32 v[72:73], v[72:73], v[152:153]
  v_pk_add_f32 v[74:75], v[74:75], v[154:155]
  s_waitcnt lgkmcnt(4)
  v_pk_add_f32 v[76:77], v[76:77], v[156:157]
  v_pk_add_f32 v[78:79], v[78:79], v[158:159]
  s_waitcnt lgkmcnt(3)
  v_pk_add_f32 v[64:65], v[64:65], v[96:97]
  v_pk_add_f32 v[66:67], v[66:67], v[98:99]
  v_cvt_pk_bf16_f32 v32, v64, v65
  v_cvt_pk_bf16_f32 v33, v66, v67
  s_waitcnt lgkmcnt(2)
  v_pk_add_f32 v[68:69], v[68:69], v[100:101]
  v_pk_add_f32 v[70:71], v[70:71], v[102:103]
  v_cvt_pk_bf16_f32 v34, v68, v69
  v_cvt_pk_bf16_f32 v35, v70, v71
  buffer_store_dwordx4 v[32:35], v17, s[8:11], s84 offen sc1
  s_waitcnt lgkmcnt(1)
  v_pk_add_f32 v[72:73], v[72:73], v[104:105]
  v_pk_add_f32 v[74:75], v[74:75], v[106:107]
  v_cvt_pk_bf16_f32 v36, v72, v73
  v_cvt_pk_bf16_f32 v37, v74, v75
  s_waitcnt lgkmcnt(0)
  v_pk_add_f32 v[76:77], v[76:77], v[108:109]
  v_pk_add_f32 v[78:79], v[78:79], v[110:111]
  v_cvt_pk_bf16_f32 v38, v76, v77
  v_cvt_pk_bf16_f32 v39, v78, v79
  buffer_store_dwordx4 v[36:39], v17, s[8:11], s84 offen offset:1024 sc1
  v_mov_b32 v2, 0
  v_mov_b32 v3, 0
  v_mov_b32 v4, 0
  v_mov_b32 v5, 0
  v_dot2_f32_bf16 v2, v32, s89, v2
  v_dot2_f32_bf16 v3, v32, v32, v3
  v_dot2_f32_bf16 v4, v33, s89, v4
  v_dot2_f32_bf16 v5, v33, v33, v5
  v_dot2_f32_bf16 v2, v34, s89, v2
  v_dot2_f32_bf16 v3, v34, v34, v3
  v_dot2_f32_bf16 v4, v35, s89, v4
  v_dot2_f32_bf16 v5, v35, v35, v5
  v_dot2_f32_bf16 v2, v36, s89, v2
  v_dot2_f32_bf16 v3, v36, v36, v3
  v_dot2_f32_bf16 v4, v37, s89, v4
  v_dot2_f32_bf16 v5, v37, v37, v5
  v_dot2_f32_bf16 v2, v38, s89, v2
  v_dot2_f32_bf16 v3, v38, v38, v3
  v_dot2_f32_bf16 v4, v39, s89, v4
  v_dot2_f32_bf16 v5, v39, v39, v5
  s_nop 2
  v_pk_add_f32 v[2:3], v[2:3], v[4:5]
  s_nop 0
  v_mov_b32 v4, v2
  v_mov_b32 v5, v3
  s_nop 1
  v_permlane32_swap_b32 v2, v4
  v_permlane32_swap_b32 v3, v5
  s_nop 1
  v_pk_add_f32 v[2:3], v[2:3], v[4:5]
  buffer_store_dwordx2 v[2:3], v29, s[8:11], s85 offen sc1
  s_branch L_mwo_done
L_mwo_B:
  s_and_b32 s26, s5, 1
  s_bfe_u32 s27, s5, 0x10001
  s_lshl_b32 s27, s27, 10
  v_and_b32 v3, 15, v1
  v_lshrrev_b32 v4, 2, v3
  v_and_b32 v5, 3, v3
  v_bfe_u32 v6, v1, 4, 1
  v_lshrrev_b32 v7, 5, v1
  v_lshl_add_u32 v8, v7, 2, v4
  v_lshlrev_b32 v8, 7, v8
  v_lshlrev_b32 v9, 5, v6
  v_lshl_add_u32 v9, v5, 3, v9
  v_lshlrev_b32 v10, 4, v7
  v_xor_b32 v9, v9, v10
  v_add3_u32 v8, v8, v9, s27
  v_lshrrev_b32 v10, 1, v4
  v_xor_b32 v9, s26, v10
  v_lshl_add_u32 v224, v9, 6, v8
  v_add_u32 v225, 65536, v224
  v_lshrrev_b32 v208, 2, v1
  v_xor_b32 v208, v208, v1
  v_bfe_u32 v208, v208, 2, 1
  v_sub_u32 v208, 1, v208
  v_mul_u32_u24 v208, 0x3f80, v208
  v_lshl_or_b32 v208, v208, 16, v208
  v_mov_b32 v209, v208
  v_mov_b32 v210, v208
  v_mov_b32 v211, v208
  v_mov_b32 v212, 0
  v_mov_b32 v213, 0
  v_mov_b32 v214, 0
  v_mov_b32 v215, 0
  s_sub_u32 s27, s79, 8192
  v_lshl_add_u32 v226, v1, 4, s27
  v_add_u32 v226, 114688, v226
  s_lshl_b32 s33, s4, 4
  s_add_u32 s33, s33, s5
  s_cmp_lg_u32 s33, 7
  s_cbranch_scc1 L_hcb
  v_cmp_ne_u64 vcc, s[76:77], v[172:173]
  s_mov_b32 s33, 28311552
  s_cbranch_vccz L_hcb
  v_lshl_add_u32 v2, v1, 7, s33
  s_mov_b32 s33, 0
L_hcb_poll:
  buffer_load_dwordx2 v[172:173], v2, s[8:11], 0 offen sc1
  s_waitcnt vmcnt(0)
  v_cmp_ne_u64 vcc, s[76:77], v[172:173]
  s_add_u32 s33, s33, 1
  s_cbranch_vccz L_hcb_polled
  s_sleep 1
  s_cmp_lt_u32 s33, 16384
  s_cbranch_scc1 L_hcb_poll
L_hcb_polled:
  s_mov_b64 exec, -1
L_hcb:
  ds_read_b64_tr_b16 v[228:229], v224 offset:0
  ds_read_b64_tr_b16 v[230:231], v224 offset:2048
  ds_read_b64_tr_b16 v[232:233], v224 offset:4096
  ds_read_b64_tr_b16 v[234:235], v224 offset:6144
  ds_read_b64_tr_b16 v[236:237], v224 offset:8192
  ds_read_b64_tr_b16 v[238:239], v224 offset:10240
  ds_read_b64_tr_b16 v[240:241], v224 offset:12288
  ds_read_b64_tr_b16 v[242:243], v224 offset:14336
  s_waitcnt lgkmcnt(6)
  v_mfma_f32_16x16x32_bf16 v[212:215], v[208:211], v[228:231], v[212:215]
  s_waitcnt lgkmcnt(4)
  v_mfma_f32_16x16x32_bf16 v[212:215], v[208:211], v[232:235], v[212:215]
  s_waitcnt lgkmcnt(2)
  v_mfma_f32_16x16x32_bf16 v[212:215], v[208:211], v[236:239], v[212:215]
  s_waitcnt lgkmcnt(0)
  v_mfma_f32_16x16x32_bf16 v[212:215], v[208:211], v[240:243], v[212:215]
  ds_read_b64_tr_b16 v[228:229], v224 offset:16384
  ds_read_b64_tr_b16 v[230:231], v224 offset:18432
  ds_read_b64_tr_b16 v[232:233], v224 offset:20480
  ds_read_b64_tr_b16 v[234:235], v224 offset:22528
  ds_read_b64_tr_b16 v[236:237], v224 offset:24576
  ds_read_b64_tr_b16 v[238:239], v224 offset:26624
  ds_read_b64_tr_b16 v[240:241], v224 offset:28672
  ds_read_b64_tr_b16 v[242:243], v224 offset:30720
  s_waitcnt lgkmcnt(6)
  v_mfma_f32_16x16x32_bf16 v[212:215], v[208:211], v[228:231], v[212:215]
  s_waitcnt lgkmcnt(4)
  v_mfma_f32_16x16x32_bf16 v[212:215], v[208:211], v[232:235], v[212:215]
  s_waitcnt lgkmcnt(2)
  v_mfma_f32_16x16x32_bf16 v[212:215], v[208:211], v[236:239], v[212:215]
  s_waitcnt lgkmcnt(0)
  v_mfma_f32_16x16x32_bf16 v[212:215], v[208:211], v[240:243], v[212:215]
  ds_read_b64_tr_b16 v[228:229], v224 offset:32768
  ds_read_b64_tr_b16 v[230:231], v224 offset:34816
  ds_read_b64_tr_b16 v[232:233], v224 offset:36864
  ds_read_b64_tr_b16 v[234:235], v224 offset:38912
  ds_read_b64_tr_b16 v[236:237], v224 offset:40960
  ds_read_b64_tr_b16 v[238:239], v224 offset:43008
  ds_read_b64_tr_b16 v[240:241], v224 offset:45056
  ds_read_b64_tr_b16 v[242:243], v224 offset:47104
  s_waitcnt lgkmcnt(6)
  v_mfma_f32_16x16x32_bf16 v[212:215], v[208:211], v[228:231], v[212:215]
  s_waitcnt lgkmcnt(4)
  v_mfma_f32_16x16x32_bf16 v[212:215], v[208:211], v[232:235], v[212:215]
  s_waitcnt lgkmcnt(2)
  v_mfma_f32_16x16x32_bf16 v[212:215], v[208:211], v[236:239], v[212:215]
  s_waitcnt lgkmcnt(0)
  v_mfma_f32_16x16x32_bf16 v[212:215], v[208:211], v[240:243], v[212:215]
  s_barrier
  ds_read_b64_tr_b16 v[228:229], v224 offset:49152
  ds_read_b64_tr_b16 v[230:231], v224 offset:51200
  ds_read_b64_tr_b16 v[232:233], v224 offset:53248
  ds_read_b64_tr_b16 v[234:235], v224 offset:55296
  ds_read_b64_tr_b16 v[236:237], v224 offset:57344
  ds_read_b64_tr_b16 v[238:239], v224 offset:59392
  ds_read_b64_tr_b16 v[240:241], v224 offset:61440
  ds_read_b64_tr_b16 v[242:243], v224 offset:63488
  s_waitcnt lgkmcnt(6)
  v_mfma_f32_16x16x32_bf16 v[212:215], v[208:211], v[228:231], v[212:215]
  s_waitcnt lgkmcnt(4)
  v_mfma_f32_16x16x32_bf16 v[212:215], v[208:211], v[232:235], v[212:215]
  s_waitcnt lgkmcnt(2)
  v_mfma_f32_16x16x32_bf16 v[212:215], v[208:211], v[236:239], v[212:215]
  s_waitcnt lgkmcnt(0)
  v_mfma_f32_16x16x32_bf16 v[212:215], v[208:211], v[240:243], v[212:215]
  ds_read_b64_tr_b16 v[228:229], v225 offset:0
  ds_read_b64_tr_b16 v[230:231], v225 offset:2048
  ds_read_b64_tr_b16 v[232:233], v225 offset:4096
  ds_read_b64_tr_b16 v[234:235], v225 offset:6144
  ds_read_b64_tr_b16 v[236:237], v225 offset:8192
  ds_read_b64_tr_b16 v[238:239], v225 offset:10240
  ds_read_b64_tr_b16 v[240:241], v225 offset:12288
  ds_read_b64_tr_b16 v[242:243], v225 offset:14336
  s_waitcnt lgkmcnt(6)
  v_mfma_f32_16x16x32_bf16 v[212:215], v[208:211], v[228:231], v[212:215]
  s_waitcnt lgkmcnt(4)
  v_mfma_f32_16x16x32_bf16 v[212:215], v[208:211], v[232:235], v[212:215]
  s_waitcnt lgkmcnt(2)
  v_mfma_f32_16x16x32_bf16 v[212:215], v[208:211], v[236:239], v[212:215]
  s_waitcnt lgkmcnt(0)
  v_mfma_f32_16x16x32_bf16 v[212:215], v[208:211], v[240:243], v[212:215]
  ds_read_b64_tr_b16 v[228:229], v225 offset:16384
  ds_read_b64_tr_b16 v[230:231], v225 offset:18432
  ds_read_b64_tr_b16 v[232:233], v225 offset:20480
  ds_read_b64_tr_b16 v[234:235], v225 offset:22528
  ds_read_b64_tr_b16 v[236:237], v225 offset:24576
  ds_read_b64_tr_b16 v[238:239], v225 offset:26624
  ds_read_b64_tr_b16 v[240:241], v225 offset:28672
  ds_read_b64_tr_b16 v[242:243], v225 offset:30720
  s_waitcnt lgkmcnt(6)
  v_mfma_f32_16x16x32_bf16 v[212:215], v[208:211], v[228:231], v[212:215]
  s_waitcnt lgkmcnt(4)
  v_mfma_f32_16x16x32_bf16 v[212:215], v[208:211], v[232:235], v[212:215]
  s_waitcnt lgkmcnt(2)
  v_mfma_f32_16x16x32_bf16 v[212:215], v[208:211], v[236:239], v[212:215]
  s_waitcnt lgkmcnt(0)
  v_mfma_f32_16x16x32_bf16 v[212:215], v[208:211], v[240:243], v[212:215]
  ds_read_b64_tr_b16 v[228:229], v225 offset:32768
  ds_read_b64_tr_b16 v[230:231], v225 offset:34816
  ds_read_b64_tr_b16 v[232:233], v225 offset:36864
  ds_read_b64_tr_b16 v[234:235], v225 offset:38912
  ds_read_b64_tr_b16 v[236:237], v225 offset:40960
  ds_read_b64_tr_b16 v[238:239], v225 offset:43008
  ds_read_b64_tr_b16 v[240:241], v225 offset:45056
  ds_read_b64_tr_b16 v[242:243], v225 offset:47104
  s_waitcnt lgkmcnt(6)
  v_mfma_f32_16x16x32_bf16 v[212:215], v[208:211], v[228:231], v[212:215]
  s_waitcnt lgkmcnt(4)
  v_mfma_f32_16x16x32_bf16 v[212:215], v[208:211], v[232:235], v[212:215]
  s_waitcnt lgkmcnt(2)
  v_mfma_f32_16x16x32_bf16 v[212:215], v[208:211], v[236:239], v[212:215]
  s_waitcnt lgkmcnt(0)
  v_mfma_f32_16x16x32_bf16 v[212:215], v[208:211], v[240:243], v[212:215]
  s_barrier
L_mwo_done:
  s_cmp_ge_u32 s7, 28
  s_cbranch_scc1 L_mffn_skip
  s_mul_i32 s24, s7, 37
  s_lshr_b32 s24, s24, 8
  s_mul_i32 s25, s24, 7
  s_sub_u32 s25, s7, s25
  s_and_b32 s26, s6, 4
  s_add_u32 s24, s24, s26
  s_and_b32 s26, s6, 3
  s_lshl_b32 s26, s26, 3
  s_lshr_b32 s26, 0x715000e, s26
  s_and_b32 s26, s26, 0xff
  s_add_u32 s25, s25, s26
  s_lshl_b32 s27, s24, 3
  s_add_u32 s27, s27, s5
  s_lshl_b32 s83, s27, 5
  s_add_u32 s83, s83, s25
  s_and_b32 s62, s83, 1023
  s_and_b32 s83, s62, 63
  s_lshl_b32 s83, s83, 7
  s_lshr_b32 s63, s62, 6
  s_lshl_b32 s63, s63, 14
  s_add_u32 s83, s83, s63
  s_xor_b32 s63, s94, 0x2000
  s_add_u32 s83, s83, s63
  s_add_u32 s83, s83, s95
  s_add_u32 s83, s83, 262144
  v_lshlrev_b32 v17, 4, v1
  s_and_b32 s27, s27, 31
  s_lshl_b32 s29, s27, 16
  s_add_u32 s29, s29, s3
  s_add_u32 s29, s29, s94
  s_add_u32 s29, s29, 16777216
  v_and_b32 v3, 15, v1
  v_lshrrev_b32 v4, 2, v3
  v_and_b32 v5, 3, v3
  v_bfe_u32 v6, v1, 4, 1
  v_lshrrev_b32 v7, 5, v1
  v_lshl_add_u32 v8, v7, 2, v4
  v_mul_u32_u24 v8, 128, v8
  v_lshlrev_b32 v9, 5, v6
  v_lshl_add_u32 v9, v5, 3, v9
  v_add_u32 v8, v8, v9
  v_lshl_add_u32 v8, v6, 2, v4
  v_lshlrev_b32 v8, 7, v8
  v_lshl_add_u32 v8, v7, 12, v8
  v_and_b32 v9, 1, v5
  v_lshl_add_u32 v8, v9, 3, v8
  v_lshrrev_b32 v9, 1, v5
  v_lshl_add_u32 v8, v9, 5, v8
  v_lshrrev_b32 v10, 1, v4
  v_lshl_add_u32 v10, v10, 2, v6
  v_xor_b32 v9, 0, v10
  v_lshl_add_u32 v18, v9, 4, v8
  v_xor_b32 v9, 1, v10
  v_lshl_add_u32 v19, v9, 4, v8
  v_xor_b32 v9, 4, v10
  v_lshl_add_u32 v20, v9, 4, v8
  v_xor_b32 v9, 5, v10
  v_lshl_add_u32 v21, v9, 4, v8
  v_lshlrev_b32 v13, 4, v3
  v_lshl_add_u32 v13, v6, 9, v13
  v_lshl_add_u32 v13, v7, 10, v13
  v_lshrrev_b32 v9, 1, v4
  v_lshl_add_u32 v8, v9, 4, v5
  v_and_b32 v9, 1, v4
  v_lshl_add_u32 v8, v9, 2, v8
  v_lshlrev_b32 v8, 3, v8
  v_add_u32 v8, 131072, v8
  s_mov_b32 s90, 0xffff
  s_lshl_b32 s62, s27, 5
  s_and_b32 s30, s62, 63
  s_lshl_b32 s30, s30, 7
  s_lshr_b32 s63, s62, 6
  s_lshl_b32 s63, s63, 14
  s_add_u32 s30, s30, s63
  s_cmp_ge_u32 s5, 4
  s_cbranch_scc1 L_mffn_epiB
  v_mov_b32 v4, s76
  v_mov_b32 v5, s77
  s_cmp_lg_u32 s5, 0
  s_mov_b64 exec, 1
  s_waitcnt vmcnt(0) lgkmcnt(0)
  s_barrier
  s_cbranch_scc1 L_pub_31
  buffer_store_dwordx2 v[4:5], off, s[8:11], s78 sc1
L_pub_31:
  s_mov_b64 exec, -1
  s_xor_b32 s63, s94, 0x2000
  s_add_u32 s30, s30, s63
  s_add_u32 s30, s30, s3
  s_add_u32 s30, s30, 18874368
  v_and_b32 v11, 31, v1
  v_lshlrev_b32 v12, 3, v11
  v_lshl_add_u32 v12, v7, 11, v12
  v_lshlrev_b32 v10, 4, v11
  s_mov_b32 s91, 0
  v_lshlrev_b32 v10, 3, v11
  v_add_u32 v10, 131072, v10
  s_lshr_b32 s85, s27, 3
  s_lshl_b32 s85, s85, 22
  s_and_b32 s84, s27, 7
  s_lshl_b32 s84, s84, 18
  s_add_u32 s85, s85, s84
  s_xor_b32 s84, s94, 0x2000
  s_add_u32 s85, s85, s84
  s_add_u32 s85, s85, s3
  s_add_u32 s85, s85, 2097152
  s_lshl_b32 s62, s25, 2
  s_add_u32 s62, s62, 0
  s_mul_i32 s63, s62, 147
  s_lshr_b32 s63, s63, 10
  s_mul_i32 s63, s63, 9
  s_add_u32 s62, s62, s63
  s_lshl_b32 s62, s62, 10
  s_add_u32 s84, s62, s85
  s_lshl_b32 s62, s25, 2
  s_add_u32 s62, s62, 1
  s_mul_i32 s63, s62, 147
  s_lshr_b32 s63, s63, 10
  s_mul_i32 s63, s63, 9
  s_add_u32 s62, s62, s63
  s_lshl_b32 s62, s62, 10
  s_add_u32 s89, s62, s85
  s_lshl_b32 s62, s25, 2
  s_add_u32 s62, s62, 2
  s_mul_i32 s63, s62, 147
  s_lshr_b32 s63, s63, 10
  s_mul_i32 s63, s63, 9
  s_add_u32 s62, s62, s63
  s_lshl_b32 s62, s62, 10
  s_add_u32 s92, s62, s85
  s_lshl_b32 s62, s25, 2
  s_add_u32 s62, s62, 3
  s_mul_i32 s63, s62, 147
  s_lshr_b32 s63, s63, 10
  s_mul_i32 s63, s63, 9
  s_add_u32 s62, s62, s63
  s_lshl_b32 s62, s62, 10
  s_add_u32 s93, s62, s85
  s_sub_u32 s62, s89, s84
  s_sub_u32 s62, s62, 1024
  v_mad_u32_u24 v16, v7, s62, v13
  s_sub_u32 s62, s93, s92
  s_sub_u32 s62, s62, 1024
  v_mad_u32_u24 v11, v7, s62, v13
  s_lshl_b32 s28, s24, 5
  s_and_b32 s62, s28, 127
  s_and_b32 s33, s62, 63
  s_lshl_b32 s33, s33, 7
  s_lshr_b32 s63, s62, 6
  s_lshl_b32 s63, s63, 14
  s_add_u32 s33, s33, s63
  s_xor_b32 s63, s94, 0x2000
  s_add_u32 s33, s33, s63
  s_add_u32 s33, s33, s95
  s_add_u32 s33, s33, 65536
  v_lshl_add_u32 v2, v1, 7, s33
  s_and_b32 s28, s5, 1
  s_lshl_b32 s28, s28, 8
  s_bfe_u32 s31, s5, 0x10001
  s_lshl_b32 s31, s31, 10
  s_add_u32 s28, s28, s31
  v_lshlrev_b32 v14, 4, v1
  v_xor_b32 v14, s28, v14
  v_xor_b32 v15, 1024, v14
  s_mul_i32 s28, s5, 14
  s_and_b32 s32, s7, 7
  s_mul_i32 s32, s32, 112
  s_add_u32 s32, s32, s28
  s_lshl_b32 s32, s32, 11
  s_add_u32 s32, s32, 24117248
  s_barrier
  s_setprio 2
  s_add_u32 s34, s29, 0
  buffer_load_dwordx4 v[128:131], v13, s[8:11], s34 offen offset:0
  buffer_load_dwordx4 v[132:135], v13, s[8:11], s34 offen offset:256
  buffer_load_dwordx4 v[136:139], v13, s[8:11], s34 offen offset:2048
  buffer_load_dwordx4 v[140:143], v13, s[8:11], s34 offen offset:2304
  s_add_u32 s34, s29, 4096
  buffer_load_dwordx4 v[144:147], v13, s[8:11], s34 offen offset:0
  buffer_load_dwordx4 v[148:151], v13, s[8:11], s34 offen offset:256
  ds_read_b64_tr_b16 v[32:33], v18 offset:0
  ds_read_b64_tr_b16 v[34:35], v18 offset:2048
  ds_read_b64_tr_b16 v[36:37], v19 offset:0
  ds_read_b64_tr_b16 v[38:39], v19 offset:2048
  ds_read_b64_tr_b16 v[40:41], v20 offset:0
  ds_read_b64_tr_b16 v[42:43], v20 offset:2048
  ds_read_b64_tr_b16 v[44:45], v21 offset:0
  ds_read_b64_tr_b16 v[46:47], v21 offset:2048
  s_waitcnt vmcnt(5)
  s_waitcnt lgkmcnt(6)
  v_mfma_f32_16x16x32_bf16 v[64:67], v[32:35], v[128:131], 0
  ds_read_b64_tr_b16 v[48:49], v18 offset:1024
  s_waitcnt vmcnt(4)
  v_mfma_f32_16x16x32_bf16 v[72:75], v[32:35], v[132:135], 0
  ds_read_b64_tr_b16 v[50:51], v18 offset:3072
  s_waitcnt lgkmcnt(6)
  v_mfma_f32_16x16x32_bf16 v[68:71], v[36:39], v[128:131], 0
  ds_read_b64_tr_b16 v[52:53], v19 offset:1024
  v_mfma_f32_16x16x32_bf16 v[76:79], v[36:39], v[132:135], 0
  ds_read_b64_tr_b16 v[54:55], v19 offset:3072
  buffer_load_dwordx4 v[152:155], v13, s[8:11], s34 offen offset:2048
  s_waitcnt lgkmcnt(6)
  v_mfma_f32_16x16x32_bf16 v[80:83], v[40:43], v[128:131], 0
  ds_read_b64_tr_b16 v[56:57], v20 offset:1024
  v_mfma_f32_16x16x32_bf16 v[88:91], v[40:43], v[132:135], 0
  ds_read_b64_tr_b16 v[58:59], v20 offset:3072
  s_waitcnt lgkmcnt(6)
  v_mfma_f32_16x16x32_bf16 v[84:87], v[44:47], v[128:131], 0
  ds_read_b64_tr_b16 v[60:61], v21 offset:1024
  v_mfma_f32_16x16x32_bf16 v[92:95], v[44:47], v[132:135], 0
  ds_read_b64_tr_b16 v[62:63], v21 offset:3072
  buffer_load_dwordx4 v[156:159], v13, s[8:11], s34 offen offset:2304
  s_waitcnt lgkmcnt(6)
  v_mfma_f32_16x16x32_bf16 v[96:99], v[48:51], v[128:131], 0
  ds_read_b64_tr_b16 v[32:33], v18 offset:8192
  v_mfma_f32_16x16x32_bf16 v[104:107], v[48:51], v[132:135], 0
  ds_read_b64_tr_b16 v[34:35], v18 offset:10240
  s_waitcnt lgkmcnt(6)
  v_mfma_f32_16x16x32_bf16 v[100:103], v[52:55], v[128:131], 0
  ds_read_b64_tr_b16 v[36:37], v19 offset:8192
  v_mfma_f32_16x16x32_bf16 v[108:111], v[52:55], v[132:135], 0
  ds_read_b64_tr_b16 v[38:39], v19 offset:10240
  s_add_u32 s34, s29, 16384
  buffer_load_dwordx4 v[160:163], v13, s[8:11], s34 offen offset:0
  s_waitcnt lgkmcnt(6)
  v_mfma_f32_16x16x32_bf16 v[112:115], v[56:59], v[128:131], 0
  ds_read_b64_tr_b16 v[40:41], v20 offset:8192
  v_mfma_f32_16x16x32_bf16 v[120:123], v[56:59], v[132:135], 0
  ds_read_b64_tr_b16 v[42:43], v20 offset:10240
  s_waitcnt lgkmcnt(6)
  v_mfma_f32_16x16x32_bf16 v[116:119], v[60:63], v[128:131], 0
  ds_read_b64_tr_b16 v[44:45], v21 offset:8192
  v_mfma_f32_16x16x32_bf16 v[124:127], v[60:63], v[132:135], 0
  ds_read_b64_tr_b16 v[46:47], v21 offset:10240
  buffer_load_dwordx4 v[164:167], v13, s[8:11], s34 offen offset:256
  s_waitcnt lgkmcnt(6)
  s_waitcnt vmcnt(7)
  v_mfma_f32_16x16x32_bf16 v[64:67], v[32:35], v[136:139], v[64:67]
  ds_read_b64_tr_b16 v[48:49], v18 offset:9216
  s_waitcnt vmcnt(6)
  v_mfma_f32_16x16x32_bf16 v[72:75], v[32:35], v[140:143], v[72:75]
  ds_read_b64_tr_b16 v[50:51], v18 offset:11264
  s_waitcnt lgkmcnt(6)
  v_mfma_f32_16x16x32_bf16 v[68:71], v[36:39], v[136:139], v[68:71]
  ds_read_b64_tr_b16 v[52:53], v19 offset:9216
  v_mfma_f32_16x16x32_bf16 v[76:79], v[36:39], v[140:143], v[76:79]
  ds_read_b64_tr_b16 v[54:55], v19 offset:11264
  buffer_load_dwordx4 v[168:171], v13, s[8:11], s34 offen offset:2048
  s_waitcnt lgkmcnt(6)
  v_mfma_f32_16x16x32_bf16 v[80:83], v[40:43], v[136:139], v[80:83]
  ds_read_b64_tr_b16 v[56:57], v20 offset:9216
  v_mfma_f32_16x16x32_bf16 v[88:91], v[40:43], v[140:143], v[88:91]
  ds_read_b64_tr_b16 v[58:59], v20 offset:11264
  s_waitcnt lgkmcnt(6)
  v_mfma_f32_16x16x32_bf16 v[84:87], v[44:47], v[136:139], v[84:87]
  ds_read_b64_tr_b16 v[60:61], v21 offset:9216
  v_mfma_f32_16x16x32_bf16 v[92:95], v[44:47], v[140:143], v[92:95]
  ds_read_b64_tr_b16 v[62:63], v21 offset:11264
  buffer_load_dwordx4 v[172:175], v13, s[8:11], s34 offen offset:2304
  s_waitcnt lgkmcnt(6)
  v_mfma_f32_16x16x32_bf16 v[96:99], v[48:51], v[136:139], v[96:99]
  ds_read_b64_tr_b16 v[32:33], v18 offset:16384
  v_mfma_f32_16x16x32_bf16 v[104:107], v[48:51], v[140:143], v[104:107]
  ds_read_b64_tr_b16 v[34:35], v18 offset:18432
  s_waitcnt lgkmcnt(6)
  v_mfma_f32_16x16x32_bf16 v[100:103], v[52:55], v[136:139], v[100:103]
  ds_read_b64_tr_b16 v[36:37], v19 offset:16384
  v_mfma_f32_16x16x32_bf16 v[108:111], v[52:55], v[140:143], v[108:111]
  ds_read_b64_tr_b16 v[38:39], v19 offset:18432
  s_add_u32 s34, s29, 20480
  buffer_load_dwordx4 v[176:179], v13, s[8:11], s34 offen offset:0
  s_waitcnt lgkmcnt(6)
  v_mfma_f32_16x16x32_bf16 v[112:115], v[56:59], v[136:139], v[112:115]
  ds_read_b64_tr_b16 v[40:41], v20 offset:16384
  v_mfma_f32_16x16x32_bf16 v[120:123], v[56:59], v[140:143], v[120:123]
  ds_read_b64_tr_b16 v[42:43], v20 offset:18432
  s_waitcnt lgkmcnt(6)
  v_mfma_f32_16x16x32_bf16 v[116:119], v[60:63], v[136:139], v[116:119]
  ds_read_b64_tr_b16 v[44:45], v21 offset:16384
  v_mfma_f32_16x16x32_bf16 v[124:127], v[60:63], v[140:143], v[124:127]
  ds_read_b64_tr_b16 v[46:47], v21 offset:18432
  buffer_load_dwordx4 v[180:183], v13, s[8:11], s34 offen offset:256
  s_waitcnt lgkmcnt(6)
  s_waitcnt vmcnt(9)
  v_mfma_f32_16x16x32_bf16 v[64:67], v[32:35], v[144:147], v[64:67]
  ds_read_b64_tr_b16 v[48:49], v18 offset:17408
  s_waitcnt vmcnt(8)
  v_mfma_f32_16x16x32_bf16 v[72:75], v[32:35], v[148:151], v[72:75]
  ds_read_b64_tr_b16 v[50:51], v18 offset:19456
  s_waitcnt lgkmcnt(6)
  v_mfma_f32_16x16x32_bf16 v[68:71], v[36:39], v[144:147], v[68:71]
  ds_read_b64_tr_b16 v[52:53], v19 offset:17408
  v_mfma_f32_16x16x32_bf16 v[76:79], v[36:39], v[148:151], v[76:79]
  ds_read_b64_tr_b16 v[54:55], v19 offset:19456
  buffer_load_dwordx4 v[184:187], v13, s[8:11], s34 offen offset:2048
  s_waitcnt lgkmcnt(6)
  v_mfma_f32_16x16x32_bf16 v[80:83], v[40:43], v[144:147], v[80:83]
  ds_read_b64_tr_b16 v[56:57], v20 offset:17408
  v_mfma_f32_16x16x32_bf16 v[88:91], v[40:43], v[148:151], v[88:91]
  ds_read_b64_tr_b16 v[58:59], v20 offset:19456
  s_waitcnt lgkmcnt(6)
  v_mfma_f32_16x16x32_bf16 v[84:87], v[44:47], v[144:147], v[84:87]
  ds_read_b64_tr_b16 v[60:61], v21 offset:17408
  v_mfma_f32_16x16x32_bf16 v[92:95], v[44:47], v[148:151], v[92:95]
  ds_read_b64_tr_b16 v[62:63], v21 offset:19456
  buffer_load_dwordx4 v[188:191], v13, s[8:11], s34 offen offset:2304
  s_waitcnt lgkmcnt(6)
  v_mfma_f32_16x16x32_bf16 v[96:99], v[48:51], v[144:147], v[96:99]
  ds_read_b64_tr_b16 v[32:33], v18 offset:24576
  v_mfma_f32_16x16x32_bf16 v[104:107], v[48:51], v[148:151], v[104:107]
  ds_read_b64_tr_b16 v[34:35], v18 offset:26624
  s_waitcnt lgkmcnt(6)
  v_mfma_f32_16x16x32_bf16 v[100:103], v[52:55], v[144:147], v[100:103]
  ds_read_b64_tr_b16 v[36:37], v19 offset:24576
  v_mfma_f32_16x16x32_bf16 v[108:111], v[52:55], v[148:151], v[108:111]
  ds_read_b64_tr_b16 v[38:39], v19 offset:26624
  s_add_u32 s34, s29, 32768
  buffer_load_dwordx4 v[192:195], v13, s[8:11], s34 offen offset:0
  s_waitcnt lgkmcnt(6)
  v_mfma_f32_16x16x32_bf16 v[112:115], v[56:59], v[144:147], v[112:115]
  ds_read_b64_tr_b16 v[40:41], v20 offset:24576
  v_mfma_f32_16x16x32_bf16 v[120:123], v[56:59], v[148:151], v[120:123]
  ds_read_b64_tr_b16 v[42:43], v20 offset:26624
  s_waitcnt lgkmcnt(6)
  v_mfma_f32_16x16x32_bf16 v[116:119], v[60:63], v[144:147], v[116:119]
  ds_read_b64_tr_b16 v[44:45], v21 offset:24576
  v_mfma_f32_16x16x32_bf16 v[124:127], v[60:63], v[148:151], v[124:127]
  ds_read_b64_tr_b16 v[46:47], v21 offset:26624
  buffer_load_dwordx4 v[196:199], v13, s[8:11], s34 offen offset:256
  s_barrier
  s_waitcnt lgkmcnt(6)
  s_waitcnt vmcnt(11)
  v_mfma_f32_16x16x32_bf16 v[64:67], v[32:35], v[152:155], v[64:67]
  ds_read_b64_tr_b16 v[48:49], v18 offset:25600
  s_waitcnt vmcnt(10)
  v_mfma_f32_16x16x32_bf16 v[72:75], v[32:35], v[156:159], v[72:75]
  ds_read_b64_tr_b16 v[50:51], v18 offset:27648
  s_waitcnt lgkmcnt(6)
  v_mfma_f32_16x16x32_bf16 v[68:71], v[36:39], v[152:155], v[68:71]
  ds_read_b64_tr_b16 v[52:53], v19 offset:25600
  v_mfma_f32_16x16x32_bf16 v[76:79], v[36:39], v[156:159], v[76:79]
  ds_read_b64_tr_b16 v[54:55], v19 offset:27648
  buffer_load_dwordx4 v[200:203], v13, s[8:11], s34 offen offset:2048
  s_waitcnt lgkmcnt(6)
  v_mfma_f32_16x16x32_bf16 v[80:83], v[40:43], v[152:155], v[80:83]
  ds_read_b64_tr_b16 v[56:57], v20 offset:25600
  v_mfma_f32_16x16x32_bf16 v[88:91], v[40:43], v[156:159], v[88:91]
  ds_read_b64_tr_b16 v[58:59], v20 offset:27648
  s_waitcnt lgkmcnt(6)
  v_mfma_f32_16x16x32_bf16 v[84:87], v[44:47], v[152:155], v[84:87]
  ds_read_b64_tr_b16 v[60:61], v21 offset:25600
  v_mfma_f32_16x16x32_bf16 v[92:95], v[44:47], v[156:159], v[92:95]
  ds_read_b64_tr_b16 v[62:63], v21 offset:27648
  buffer_load_dwordx4 v[204:207], v13, s[8:11], s34 offen offset:2304
  s_waitcnt lgkmcnt(6)
  v_mfma_f32_16x16x32_bf16 v[96:99], v[48:51], v[152:155], v[96:99]
  ds_read_b64_tr_b16 v[32:33], v18 offset:32768
  v_mfma_f32_16x16x32_bf16 v[104:107], v[48:51], v[156:159], v[104:107]
  ds_read_b64_tr_b16 v[34:35], v18 offset:34816
  s_waitcnt lgkmcnt(6)
  v_mfma_f32_16x16x32_bf16 v[100:103], v[52:55], v[152:155], v[100:103]
  ds_read_b64_tr_b16 v[36:37], v19 offset:32768
  v_mfma_f32_16x16x32_bf16 v[108:111], v[52:55], v[156:159], v[108:111]
  ds_read_b64_tr_b16 v[38:39], v19 offset:34816
  s_add_u32 s34, s29, 36864
  buffer_load_dwordx4 v[208:211], v13, s[8:11], s34 offen offset:0
  s_waitcnt lgkmcnt(6)
  v_mfma_f32_16x16x32_bf16 v[112:115], v[56:59], v[152:155], v[112:115]
  ds_read_b64_tr_b16 v[40:41], v20 offset:32768
  v_mfma_f32_16x16x32_bf16 v[120:123], v[56:59], v[156:159], v[120:123]
  ds_read_b64_tr_b16 v[42:43], v20 offset:34816
  s_waitcnt lgkmcnt(6)
  v_mfma_f32_16x16x32_bf16 v[116:119], v[60:63], v[152:155], v[116:119]
  ds_read_b64_tr_b16 v[44:45], v21 offset:32768
  v_mfma_f32_16x16x32_bf16 v[124:127], v[60:63], v[156:159], v[124:127]
  ds_read_b64_tr_b16 v[46:47], v21 offset:34816
  buffer_load_dwordx4 v[212:215], v13, s[8:11], s34 offen offset:256
  s_waitcnt lgkmcnt(6)
  s_waitcnt vmcnt(13)
  v_mfma_f32_16x16x32_bf16 v[64:67], v[32:35], v[160:163], v[64:67]
  ds_read_b64_tr_b16 v[48:49], v18 offset:33792
  s_waitcnt vmcnt(12)
  v_mfma_f32_16x16x32_bf16 v[72:75], v[32:35], v[164:167], v[72:75]
  ds_read_b64_tr_b16 v[50:51], v18 offset:35840
  s_waitcnt lgkmcnt(6)
  v_mfma_f32_16x16x32_bf16 v[68:71], v[36:39], v[160:163], v[68:71]
  ds_read_b64_tr_b16 v[52:53], v19 offset:33792
  v_mfma_f32_16x16x32_bf16 v[76:79], v[36:39], v[164:167], v[76:79]
  ds_read_b64_tr_b16 v[54:55], v19 offset:35840
  buffer_load_dwordx4 v[216:219], v13, s[8:11], s34 offen offset:2048
  s_waitcnt lgkmcnt(6)
  v_mfma_f32_16x16x32_bf16 v[80:83], v[40:43], v[160:163], v[80:83]
  ds_read_b64_tr_b16 v[56:57], v20 offset:33792
  v_mfma_f32_16x16x32_bf16 v[88:91], v[40:43], v[164:167], v[88:91]
  ds_read_b64_tr_b16 v[58:59], v20 offset:35840
  s_waitcnt lgkmcnt(6)
  v_mfma_f32_16x16x32_bf16 v[84:87], v[44:47], v[160:163], v[84:87]
  ds_read_b64_tr_b16 v[60:61], v21 offset:33792
  v_mfma_f32_16x16x32_bf16 v[92:95], v[44:47], v[164:167], v[92:95]
  ds_read_b64_tr_b16 v[62:63], v21 offset:35840
  buffer_load_dwordx4 v[220:223], v13, s[8:11], s34 offen offset:2304
  s_waitcnt lgkmcnt(6)
  v_mfma_f32_16x16x32_bf16 v[96:99], v[48:51], v[160:163], v[96:99]
  ds_read_b64_tr_b16 v[32:33], v18 offset:40960
  v_mfma_f32_16x16x32_bf16 v[104:107], v[48:51], v[164:167], v[104:107]
  ds_read_b64_tr_b16 v[34:35], v18 offset:43008
  s_waitcnt lgkmcnt(6)
  v_mfma_f32_16x16x32_bf16 v[100:103], v[52:55], v[160:163], v[100:103]
  ds_read_b64_tr_b16 v[36:37], v19 offset:40960
  v_mfma_f32_16x16x32_bf16 v[108:111], v[52:55], v[164:167], v[108:111]
  ds_read_b64_tr_b16 v[38:39], v19 offset:43008
  s_add_u32 s34, s29, 49152
  buffer_load_dwordx4 v[224:227], v13, s[8:11], s34 offen offset:0
  s_waitcnt lgkmcnt(6)
  v_mfma_f32_16x16x32_bf16 v[112:115], v[56:59], v[160:163], v[112:115]
  ds_read_b64_tr_b16 v[40:41], v20 offset:40960
  v_mfma_f32_16x16x32_bf16 v[120:123], v[56:59], v[164:167], v[120:123]
  ds_read_b64_tr_b16 v[42:43], v20 offset:43008
  s_waitcnt lgkmcnt(6)
  v_mfma_f32_16x16x32_bf16 v[116:119], v[60:63], v[160:163], v[116:119]
  ds_read_b64_tr_b16 v[44:45], v21 offset:40960
  v_mfma_f32_16x16x32_bf16 v[124:127], v[60:63], v[164:167], v[124:127]
  ds_read_b64_tr_b16 v[46:47], v21 offset:43008
  buffer_load_dwordx4 v[228:231], v13, s[8:11], s34 offen offset:256
  s_waitcnt lgkmcnt(6)
  s_waitcnt vmcnt(15)
  v_mfma_f32_16x16x32_bf16 v[64:67], v[32:35], v[168:171], v[64:67]
  ds_read_b64_tr_b16 v[48:49], v18 offset:41984
  s_waitcnt vmcnt(14)
  v_mfma_f32_16x16x32_bf16 v[72:75], v[32:35], v[172:175], v[72:75]
  ds_read_b64_tr_b16 v[50:51], v18 offset:44032
  s_waitcnt lgkmcnt(6)
  v_mfma_f32_16x16x32_bf16 v[68:71], v[36:39], v[168:171], v[68:71]
  ds_read_b64_tr_b16 v[52:53], v19 offset:41984
  v_mfma_f32_16x16x32_bf16 v[76:79], v[36:39], v[172:175], v[76:79]
  ds_read_b64_tr_b16 v[54:55], v19 offset:44032
  s_waitcnt lgkmcnt(6)
  v_mfma_f32_16x16x32_bf16 v[80:83], v[40:43], v[168:171], v[80:83]
  ds_read_b64_tr_b16 v[56:57], v20 offset:41984
  v_mfma_f32_16x16x32_bf16 v[88:91], v[40:43], v[172:175], v[88:91]
  ds_read_b64_tr_b16 v[58:59], v20 offset:44032
  s_waitcnt lgkmcnt(6)
  v_mfma_f32_16x16x32_bf16 v[84:87], v[44:47], v[168:171], v[84:87]
  ds_read_b64_tr_b16 v[60:61], v21 offset:41984
  v_mfma_f32_16x16x32_bf16 v[92:95], v[44:47], v[172:175], v[92:95]
  ds_read_b64_tr_b16 v[62:63], v21 offset:44032
  buffer_load_dwordx4 v[232:235], v13, s[8:11], s34 offen offset:2048
  s_waitcnt lgkmcnt(6)
  v_mfma_f32_16x16x32_bf16 v[96:99], v[48:51], v[168:171], v[96:99]
  ds_read_b64_tr_b16 v[32:33], v18 offset:49152
  v_mfma_f32_16x16x32_bf16 v[104:107], v[48:51], v[172:175], v[104:107]
  ds_read_b64_tr_b16 v[34:35], v18 offset:51200
  s_waitcnt lgkmcnt(6)
  v_mfma_f32_16x16x32_bf16 v[100:103], v[52:55], v[168:171], v[100:103]
  ds_read_b64_tr_b16 v[36:37], v19 offset:49152
  v_mfma_f32_16x16x32_bf16 v[108:111], v[52:55], v[172:175], v[108:111]
  ds_read_b64_tr_b16 v[38:39], v19 offset:51200
  s_waitcnt lgkmcnt(6)
  v_mfma_f32_16x16x32_bf16 v[112:115], v[56:59], v[168:171], v[112:115]
  ds_read_b64_tr_b16 v[40:41], v20 offset:49152
  v_mfma_f32_16x16x32_bf16 v[120:123], v[56:59], v[172:175], v[120:123]
  ds_read_b64_tr_b16 v[42:43], v20 offset:51200
  s_waitcnt lgkmcnt(6)
  v_mfma_f32_16x16x32_bf16 v[116:119], v[60:63], v[168:171], v[116:119]
  ds_read_b64_tr_b16 v[44:45], v21 offset:49152
  v_mfma_f32_16x16x32_bf16 v[124:127], v[60:63], v[172:175], v[124:127]
  ds_read_b64_tr_b16 v[46:47], v21 offset:51200
  buffer_load_dwordx4 v[236:239], v13, s[8:11], s34 offen offset:2304
  s_waitcnt lgkmcnt(6)
  s_waitcnt vmcnt(15)
  v_mfma_f32_16x16x32_bf16 v[64:67], v[32:35], v[176:179], v[64:67]
  ds_read_b64_tr_b16 v[48:49], v18 offset:50176
  s_waitcnt vmcnt(14)
  v_mfma_f32_16x16x32_bf16 v[72:75], v[32:35], v[180:183], v[72:75]
  ds_read_b64_tr_b16 v[50:51], v18 offset:52224
  s_waitcnt lgkmcnt(6)
  v_mfma_f32_16x16x32_bf16 v[68:71], v[36:39], v[176:179], v[68:71]
  ds_read_b64_tr_b16 v[52:53], v19 offset:50176
  v_mfma_f32_16x16x32_bf16 v[76:79], v[36:39], v[180:183], v[76:79]
  ds_read_b64_tr_b16 v[54:55], v19 offset:52224
  s_waitcnt lgkmcnt(6)
  v_mfma_f32_16x16x32_bf16 v[80:83], v[40:43], v[176:179], v[80:83]
  ds_read_b64_tr_b16 v[56:57], v20 offset:50176
  v_mfma_f32_16x16x32_bf16 v[88:91], v[40:43], v[180:183], v[88:91]
  ds_read_b64_tr_b16 v[58:59], v20 offset:52224
  s_waitcnt lgkmcnt(6)
  v_mfma_f32_16x16x32_bf16 v[84:87], v[44:47], v[176:179], v[84:87]
  ds_read_b64_tr_b16 v[60:61], v21 offset:50176
  v_mfma_f32_16x16x32_bf16 v[92:95], v[44:47], v[180:183], v[92:95]
  ds_read_b64_tr_b16 v[62:63], v21 offset:52224
  s_add_u32 s34, s29, 53248
  buffer_load_dwordx4 v[240:243], v13, s[8:11], s34 offen offset:0
  s_waitcnt lgkmcnt(6)
  v_mfma_f32_16x16x32_bf16 v[96:99], v[48:51], v[176:179], v[96:99]
  ds_read_b64_tr_b16 v[32:33], v18 offset:57344
  v_mfma_f32_16x16x32_bf16 v[104:107], v[48:51], v[180:183], v[104:107]
  ds_read_b64_tr_b16 v[34:35], v18 offset:59392
  s_waitcnt lgkmcnt(6)
  v_mfma_f32_16x16x32_bf16 v[100:103], v[52:55], v[176:179], v[100:103]
  ds_read_b64_tr_b16 v[36:37], v19 offset:57344
  v_mfma_f32_16x16x32_bf16 v[108:111], v[52:55], v[180:183], v[108:111]
  ds_read_b64_tr_b16 v[38:39], v19 offset:59392
  s_waitcnt lgkmcnt(6)
  v_mfma_f32_16x16x32_bf16 v[112:115], v[56:59], v[176:179], v[112:115]
  ds_read_b64_tr_b16 v[40:41], v20 offset:57344
  v_mfma_f32_16x16x32_bf16 v[120:123], v[56:59], v[180:183], v[120:123]
  ds_read_b64_tr_b16 v[42:43], v20 offset:59392
  s_waitcnt lgkmcnt(6)
  v_mfma_f32_16x16x32_bf16 v[116:119], v[60:63], v[176:179], v[116:119]
  ds_read_b64_tr_b16 v[44:45], v21 offset:57344
  v_mfma_f32_16x16x32_bf16 v[124:127], v[60:63], v[180:183], v[124:127]
  ds_read_b64_tr_b16 v[46:47], v21 offset:59392
  buffer_load_dwordx4 v[244:247], v13, s[8:11], s34 offen offset:256
  s_waitcnt lgkmcnt(6)
  s_waitcnt vmcnt(15)
  v_mfma_f32_16x16x32_bf16 v[64:67], v[32:35], v[184:187], v[64:67]
  ds_read_b64_tr_b16 v[48:49], v18 offset:58368
  buffer_load_dwordx4 v[248:251], v13, s[8:11], s34 offen offset:2048
  s_waitcnt vmcnt(15)
  v_mfma_f32_16x16x32_bf16 v[72:75], v[32:35], v[188:191], v[72:75]
  ds_read_b64_tr_b16 v[50:51], v18 offset:60416
  buffer_load_dwordx2 v[128:129], v12, s[8:11], s30 offen offset:0
  s_waitcnt lgkmcnt(6)
  v_mfma_f32_16x16x32_bf16 v[68:71], v[36:39], v[184:187], v[68:71]
  ds_read_b64_tr_b16 v[52:53], v19 offset:58368
  buffer_load_dwordx2 v[130:131], v12, s[8:11], s30 offen offset:256
  v_mfma_f32_16x16x32_bf16 v[76:79], v[36:39], v[188:191], v[76:79]
  ds_read_b64_tr_b16 v[54:55], v19 offset:60416
  buffer_load_dwordx2 v[132:133], v12, s[8:11], s30 offen offset:512
  s_waitcnt lgkmcnt(6)
  v_mfma_f32_16x16x32_bf16 v[80:83], v[40:43], v[184:187], v[80:83]
  ds_read_b64_tr_b16 v[56:57], v20 offset:58368
  buffer_load_dwordx2 v[134:135], v12, s[8:11], s30 offen offset:768
  v_mfma_f32_16x16x32_bf16 v[88:91], v[40:43], v[188:191], v[88:91]
  ds_read_b64_tr_b16 v[58:59], v20 offset:60416
  buffer_load_dwordx2 v[136:137], v12, s[8:11], s30 offen offset:1024
  s_waitcnt lgkmcnt(6)
  v_mfma_f32_16x16x32_bf16 v[84:87], v[44:47], v[184:187], v[84:87]
  ds_read_b64_tr_b16 v[60:61], v21 offset:58368
  buffer_load_dwordx2 v[138:139], v12, s[8:11], s30 offen offset:1280
  v_mfma_f32_16x16x32_bf16 v[92:95], v[44:47], v[188:191], v[92:95]
  ds_read_b64_tr_b16 v[62:63], v21 offset:60416
  buffer_load_dwordx2 v[140:141], v12, s[8:11], s30 offen offset:1536
  buffer_load_dwordx2 v[142:143], v12, s[8:11], s30 offen offset:1792
  v_add_u32 v18, 65536, v18
  v_add_u32 v19, 65536, v19
  v_add_u32 v20, 65536, v20
  v_add_u32 v21, 65536, v21
  s_waitcnt lgkmcnt(6)
  v_mfma_f32_16x16x32_bf16 v[96:99], v[48:51], v[184:187], v[96:99]
  ds_read_b64_tr_b16 v[32:33], v18 offset:0
  v_mfma_f32_16x16x32_bf16 v[104:107], v[48:51], v[188:191], v[104:107]
  ds_read_b64_tr_b16 v[34:35], v18 offset:2048
  s_waitcnt lgkmcnt(6)
  v_mfma_f32_16x16x32_bf16 v[100:103], v[52:55], v[184:187], v[100:103]
  ds_read_b64_tr_b16 v[36:37], v19 offset:0
  buffer_load_dwordx4 v[252:255], v13, s[8:11], s34 offen offset:2304
  v_mfma_f32_16x16x32_bf16 v[108:111], v[52:55], v[188:191], v[108:111]
  ds_read_b64_tr_b16 v[38:39], v19 offset:2048
  s_waitcnt lgkmcnt(6)
  v_mfma_f32_16x16x32_bf16 v[112:115], v[56:59], v[184:187], v[112:115]
  ds_read_b64_tr_b16 v[40:41], v20 offset:0
  v_mfma_f32_16x16x32_bf16 v[120:123], v[56:59], v[188:191], v[120:123]
  ds_read_b64_tr_b16 v[42:43], v20 offset:2048
  s_add_u32 s35, s32, 12288
  buffer_load_dwordx4 v[176:179], v14, s[8:11], s35 offen offset:0
  s_waitcnt lgkmcnt(6)
  v_mfma_f32_16x16x32_bf16 v[116:119], v[60:63], v[184:187], v[116:119]
  ds_read_b64_tr_b16 v[44:45], v21 offset:0
  v_mfma_f32_16x16x32_bf16 v[124:127], v[60:63], v[188:191], v[124:127]
  ds_read_b64_tr_b16 v[46:47], v21 offset:2048
  buffer_load_dwordx4 v[180:183], v15, s[8:11], s35 offen offset:0
  s_waitcnt lgkmcnt(6)
  s_waitcnt vmcnt(25)
  v_mfma_f32_16x16x32_bf16 v[64:67], v[32:35], v[192:195], v[64:67]
  ds_read_b64_tr_b16 v[48:49], v18 offset:1024
  s_waitcnt vmcnt(24)
  v_mfma_f32_16x16x32_bf16 v[72:75], v[32:35], v[196:199], v[72:75]
  ds_read_b64_tr_b16 v[50:51], v18 offset:3072
  s_waitcnt lgkmcnt(6)
  v_mfma_f32_16x16x32_bf16 v[68:71], v[36:39], v[192:195], v[68:71]
  ds_read_b64_tr_b16 v[52:53], v19 offset:1024
  v_mfma_f32_16x16x32_bf16 v[76:79], v[36:39], v[196:199], v[76:79]
  ds_read_b64_tr_b16 v[54:55], v19 offset:3072
  buffer_load_dwordx4 v[184:187], v14, s[8:11], s35 offen offset:2048
  s_waitcnt lgkmcnt(6)
  v_mfma_f32_16x16x32_bf16 v[80:83], v[40:43], v[192:195], v[80:83]
  ds_read_b64_tr_b16 v[56:57], v20 offset:1024
  v_mfma_f32_16x16x32_bf16 v[88:91], v[40:43], v[196:199], v[88:91]
  ds_read_b64_tr_b16 v[58:59], v20 offset:3072
  s_waitcnt lgkmcnt(6)
  v_mfma_f32_16x16x32_bf16 v[84:87], v[44:47], v[192:195], v[84:87]
  ds_read_b64_tr_b16 v[60:61], v21 offset:1024
  v_mfma_f32_16x16x32_bf16 v[92:95], v[44:47], v[196:199], v[92:95]
  ds_read_b64_tr_b16 v[62:63], v21 offset:3072
  buffer_load_dwordx4 v[188:191], v15, s[8:11], s35 offen offset:2048
  s_waitcnt lgkmcnt(6)
  v_mfma_f32_16x16x32_bf16 v[96:99], v[48:51], v[192:195], v[96:99]
  ds_read_b64_tr_b16 v[32:33], v18 offset:8192
  v_mfma_f32_16x16x32_bf16 v[104:107], v[48:51], v[196:199], v[104:107]
  ds_read_b64_tr_b16 v[34:35], v18 offset:10240
  s_waitcnt lgkmcnt(6)
  v_mfma_f32_16x16x32_bf16 v[100:103], v[52:55], v[192:195], v[100:103]
  ds_read_b64_tr_b16 v[36:37], v19 offset:8192
  v_mfma_f32_16x16x32_bf16 v[108:111], v[52:55], v[196:199], v[108:111]
  ds_read_b64_tr_b16 v[38:39], v19 offset:10240
  s_waitcnt lgkmcnt(6)
  v_mfma_f32_16x16x32_bf16 v[112:115], v[56:59], v[192:195], v[112:115]
  ds_read_b64_tr_b16 v[40:41], v20 offset:8192
  v_mfma_f32_16x16x32_bf16 v[120:123], v[56:59], v[196:199], v[120:123]
  ds_read_b64_tr_b16 v[42:43], v20 offset:10240
  s_waitcnt lgkmcnt(6)
  v_mfma_f32_16x16x32_bf16 v[116:119], v[60:63], v[192:195], v[116:119]
  ds_read_b64_tr_b16 v[44:45], v21 offset:8192
  v_mfma_f32_16x16x32_bf16 v[124:127], v[60:63], v[196:199], v[124:127]
  ds_read_b64_tr_b16 v[46:47], v21 offset:10240
  s_waitcnt lgkmcnt(6)
  s_waitcnt vmcnt(25)
  v_mfma_f32_16x16x32_bf16 v[64:67], v[32:35], v[200:203], v[64:67]
  ds_read_b64_tr_b16 v[48:49], v18 offset:9216
  s_waitcnt vmcnt(24)
  v_mfma_f32_16x16x32_bf16 v[72:75], v[32:35], v[204:207], v[72:75]
  ds_read_b64_tr_b16 v[50:51], v18 offset:11264
  s_waitcnt lgkmcnt(6)
  v_mfma_f32_16x16x32_bf16 v[68:71], v[36:39], v[200:203], v[68:71]
  ds_read_b64_tr_b16 v[52:53], v19 offset:9216
  v_mfma_f32_16x16x32_bf16 v[76:79], v[36:39], v[204:207], v[76:79]
  ds_read_b64_tr_b16 v[54:55], v19 offset:11264
  s_add_u32 s35, s32, 16384
  buffer_load_dwordx4 v[192:195], v14, s[8:11], s35 offen offset:0
  s_waitcnt lgkmcnt(6)
  v_mfma_f32_16x16x32_bf16 v[80:83], v[40:43], v[200:203], v[80:83]
  ds_read_b64_tr_b16 v[56:57], v20 offset:9216
  v_mfma_f32_16x16x32_bf16 v[88:91], v[40:43], v[204:207], v[88:91]
  ds_read_b64_tr_b16 v[58:59], v20 offset:11264
  s_waitcnt lgkmcnt(6)
  v_mfma_f32_16x16x32_bf16 v[84:87], v[44:47], v[200:203], v[84:87]
  ds_read_b64_tr_b16 v[60:61], v21 offset:9216
  v_mfma_f32_16x16x32_bf16 v[92:95], v[44:47], v[204:207], v[92:95]
  ds_read_b64_tr_b16 v[62:63], v21 offset:11264
  buffer_load_dwordx4 v[196:199], v15, s[8:11], s35 offen offset:0
  s_waitcnt lgkmcnt(6)
  v_mfma_f32_16x16x32_bf16 v[96:99], v[48:51], v[200:203], v[96:99]
  ds_read_b64_tr_b16 v[32:33], v18 offset:16384
  v_mfma_f32_16x16x32_bf16 v[104:107], v[48:51], v[204:207], v[104:107]
  ds_read_b64_tr_b16 v[34:35], v18 offset:18432
  s_waitcnt lgkmcnt(6)
  v_mfma_f32_16x16x32_bf16 v[100:103], v[52:55], v[200:203], v[100:103]
  ds_read_b64_tr_b16 v[36:37], v19 offset:16384
  v_mfma_f32_16x16x32_bf16 v[108:111], v[52:55], v[204:207], v[108:111]
  ds_read_b64_tr_b16 v[38:39], v19 offset:18432
  s_waitcnt lgkmcnt(6)
  v_mfma_f32_16x16x32_bf16 v[112:115], v[56:59], v[200:203], v[112:115]
  ds_read_b64_tr_b16 v[40:41], v20 offset:16384
  v_mfma_f32_16x16x32_bf16 v[120:123], v[56:59], v[204:207], v[120:123]
  ds_read_b64_tr_b16 v[42:43], v20 offset:18432
  s_waitcnt lgkmcnt(6)
  v_mfma_f32_16x16x32_bf16 v[116:119], v[60:63], v[200:203], v[116:119]
  ds_read_b64_tr_b16 v[44:45], v21 offset:16384
  v_mfma_f32_16x16x32_bf16 v[124:127], v[60:63], v[204:207], v[124:127]
  ds_read_b64_tr_b16 v[46:47], v21 offset:18432
  s_waitcnt lgkmcnt(6)
  s_waitcnt vmcnt(25)
  v_mfma_f32_16x16x32_bf16 v[64:67], v[32:35], v[208:211], v[64:67]
  ds_read_b64_tr_b16 v[48:49], v18 offset:17408
  s_waitcnt vmcnt(24)
  v_mfma_f32_16x16x32_bf16 v[72:75], v[32:35], v[212:215], v[72:75]
  ds_read_b64_tr_b16 v[50:51], v18 offset:19456
  s_waitcnt lgkmcnt(6)
  v_mfma_f32_16x16x32_bf16 v[68:71], v[36:39], v[208:211], v[68:71]
  ds_read_b64_tr_b16 v[52:53], v19 offset:17408
  v_mfma_f32_16x16x32_bf16 v[76:79], v[36:39], v[212:215], v[76:79]
  ds_read_b64_tr_b16 v[54:55], v19 offset:19456
  buffer_load_dwordx4 v[200:203], v14, s[8:11], s35 offen offset:2048
  s_waitcnt lgkmcnt(6)
  v_mfma_f32_16x16x32_bf16 v[80:83], v[40:43], v[208:211], v[80:83]
  ds_read_b64_tr_b16 v[56:57], v20 offset:17408
  v_mfma_f32_16x16x32_bf16 v[88:91], v[40:43], v[212:215], v[88:91]
  ds_read_b64_tr_b16 v[58:59], v20 offset:19456
  s_waitcnt lgkmcnt(6)
  v_mfma_f32_16x16x32_bf16 v[84:87], v[44:47], v[208:211], v[84:87]
  ds_read_b64_tr_b16 v[60:61], v21 offset:17408
  v_mfma_f32_16x16x32_bf16 v[92:95], v[44:47], v[212:215], v[92:95]
  ds_read_b64_tr_b16 v[62:63], v21 offset:19456
  buffer_load_dwordx4 v[204:207], v15, s[8:11], s35 offen offset:2048
  s_waitcnt lgkmcnt(6)
  v_mfma_f32_16x16x32_bf16 v[96:99], v[48:51], v[208:211], v[96:99]
  ds_read_b64_tr_b16 v[32:33], v18 offset:24576
  v_mfma_f32_16x16x32_bf16 v[104:107], v[48:51], v[212:215], v[104:107]
  ds_read_b64_tr_b16 v[34:35], v18 offset:26624
  s_waitcnt lgkmcnt(6)
  v_mfma_f32_16x16x32_bf16 v[100:103], v[52:55], v[208:211], v[100:103]
  ds_read_b64_tr_b16 v[36:37], v19 offset:24576
  v_mfma_f32_16x16x32_bf16 v[108:111], v[52:55], v[212:215], v[108:111]
  ds_read_b64_tr_b16 v[38:39], v19 offset:26624
  s_waitcnt lgkmcnt(6)
  v_mfma_f32_16x16x32_bf16 v[112:115], v[56:59], v[208:211], v[112:115]
  ds_read_b64_tr_b16 v[40:41], v20 offset:24576
  v_mfma_f32_16x16x32_bf16 v[120:123], v[56:59], v[212:215], v[120:123]
  ds_read_b64_tr_b16 v[42:43], v20 offset:26624
  s_waitcnt lgkmcnt(6)
  v_mfma_f32_16x16x32_bf16 v[116:119], v[60:63], v[208:211], v[116:119]
  ds_read_b64_tr_b16 v[44:45], v21 offset:24576
  v_mfma_f32_16x16x32_bf16 v[124:127], v[60:63], v[212:215], v[124:127]
  ds_read_b64_tr_b16 v[46:47], v21 offset:26624
  s_waitcnt lgkmcnt(6)
  s_waitcnt vmcnt(25)
  v_mfma_f32_16x16x32_bf16 v[64:67], v[32:35], v[216:219], v[64:67]
  ds_read_b64_tr_b16 v[48:49], v18 offset:25600
  s_waitcnt vmcnt(24)
  v_mfma_f32_16x16x32_bf16 v[72:75], v[32:35], v[220:223], v[72:75]
  ds_read_b64_tr_b16 v[50:51], v18 offset:27648
  s_waitcnt lgkmcnt(6)
  v_mfma_f32_16x16x32_bf16 v[68:71], v[36:39], v[216:219], v[68:71]
  ds_read_b64_tr_b16 v[52:53], v19 offset:25600
  v_mfma_f32_16x16x32_bf16 v[76:79], v[36:39], v[220:223], v[76:79]
  ds_read_b64_tr_b16 v[54:55], v19 offset:27648
  s_add_u32 s35, s32, 20480
  buffer_load_dwordx4 v[208:211], v14, s[8:11], s35 offen offset:0
  s_waitcnt lgkmcnt(6)
  v_mfma_f32_16x16x32_bf16 v[80:83], v[40:43], v[216:219], v[80:83]
  ds_read_b64_tr_b16 v[56:57], v20 offset:25600
  v_mfma_f32_16x16x32_bf16 v[88:91], v[40:43], v[220:223], v[88:91]
  ds_read_b64_tr_b16 v[58:59], v20 offset:27648
  s_waitcnt lgkmcnt(6)
  v_mfma_f32_16x16x32_bf16 v[84:87], v[44:47], v[216:219], v[84:87]
  ds_read_b64_tr_b16 v[60:61], v21 offset:25600
  v_mfma_f32_16x16x32_bf16 v[92:95], v[44:47], v[220:223], v[92:95]
  ds_read_b64_tr_b16 v[62:63], v21 offset:27648
  buffer_load_dwordx4 v[212:215], v15, s[8:11], s35 offen offset:0
  s_waitcnt lgkmcnt(6)
  v_mfma_f32_16x16x32_bf16 v[96:99], v[48:51], v[216:219], v[96:99]
  ds_read_b64_tr_b16 v[32:33], v18 offset:32768
  v_mfma_f32_16x16x32_bf16 v[104:107], v[48:51], v[220:223], v[104:107]
  ds_read_b64_tr_b16 v[34:35], v18 offset:34816
  s_waitcnt lgkmcnt(6)
  v_mfma_f32_16x16x32_bf16 v[100:103], v[52:55], v[216:219], v[100:103]
  ds_read_b64_tr_b16 v[36:37], v19 offset:32768
  v_mfma_f32_16x16x32_bf16 v[108:111], v[52:55], v[220:223], v[108:111]
  ds_read_b64_tr_b16 v[38:39], v19 offset:34816
  s_waitcnt lgkmcnt(6)
  v_mfma_f32_16x16x32_bf16 v[112:115], v[56:59], v[216:219], v[112:115]
  ds_read_b64_tr_b16 v[40:41], v20 offset:32768
  v_mfma_f32_16x16x32_bf16 v[120:123], v[56:59], v[220:223], v[120:123]
  ds_read_b64_tr_b16 v[42:43], v20 offset:34816
  s_waitcnt lgkmcnt(6)
  v_mfma_f32_16x16x32_bf16 v[116:119], v[60:63], v[216:219], v[116:119]
  ds_read_b64_tr_b16 v[44:45], v21 offset:32768
  v_mfma_f32_16x16x32_bf16 v[124:127], v[60:63], v[220:223], v[124:127]
  ds_read_b64_tr_b16 v[46:47], v21 offset:34816
  s_waitcnt lgkmcnt(6)
  s_waitcnt vmcnt(25)
  v_mfma_f32_16x16x32_bf16 v[64:67], v[32:35], v[224:227], v[64:67]
  ds_read_b64_tr_b16 v[48:49], v18 offset:33792
  buffer_load_dwordx4 v[216:219], v14, s[8:11], s35 offen offset:2048
  s_waitcnt vmcnt(25)
  v_mfma_f32_16x16x32_bf16 v[72:75], v[32:35], v[228:231], v[72:75]
  ds_read_b64_tr_b16 v[50:51], v18 offset:35840
  buffer_load_dwordx4 v[220:223], v15, s[8:11], s35 offen offset:2048
  s_waitcnt vmcnt(13)
  s_waitcnt lgkmcnt(6)
  v_mfma_f32_16x16x32_bf16 v[68:71], v[36:39], v[224:227], v[68:71]
  ds_read_b64_tr_b16 v[52:53], v19 offset:33792
  ds_read_b64 v[144:145], v8 offset:0
  ds_read_b64 v[146:147], v8 offset:64
  v_mfma_f32_16x16x32_bf16 v[76:79], v[36:39], v[228:231], v[76:79]
  ds_read_b64_tr_b16 v[54:55], v19 offset:35840
  ds_read_b64 v[148:149], v8 offset:256
  ds_read_b64 v[150:151], v8 offset:320
  s_waitcnt lgkmcnt(10)
  v_mfma_f32_16x16x32_bf16 v[80:83], v[40:43], v[224:227], v[80:83]
  ds_read_b64_tr_b16 v[56:57], v20 offset:33792
  ds_read_b64 v[152:153], v8 offset:512
  ds_read_b64 v[154:155], v8 offset:576
  v_mfma_f32_16x16x32_bf16 v[88:91], v[40:43], v[228:231], v[88:91]
  ds_read_b64_tr_b16 v[58:59], v20 offset:35840
  ds_read_b64 v[156:157], v8 offset:768
  ds_read_b64 v[158:159], v8 offset:832
  s_waitcnt lgkmcnt(14)
  v_mfma_f32_16x16x32_bf16 v[84:87], v[44:47], v[224:227], v[84:87]
  ds_read_b64_tr_b16 v[60:61], v21 offset:33792
  v_add_f32 v2, v128, v130
  v_add_f32 v4, v132, v134
  v_mfma_f32_16x16x32_bf16 v[92:95], v[44:47], v[228:231], v[92:95]
  ds_read_b64_tr_b16 v[62:63], v21 offset:35840
  v_add_f32 v3, v129, v131
  v_add_f32 v5, v133, v135
  s_waitcnt lgkmcnt(14)
  v_mfma_f32_16x16x32_bf16 v[96:99], v[48:51], v[224:227], v[96:99]
  ds_read_b64_tr_b16 v[32:33], v18 offset:40960
  v_add_f32 v2, v2, v136
  v_mfma_f32_16x16x32_bf16 v[104:107], v[48:51], v[228:231], v[104:107]
  ds_read_b64_tr_b16 v[34:35], v18 offset:43008
  v_add_f32 v3, v3, v137
  v_add_f32 v4, v4, v138
  s_waitcnt lgkmcnt(12)
  v_mfma_f32_16x16x32_bf16 v[100:103], v[52:55], v[224:227], v[100:103]
  ds_read_b64_tr_b16 v[36:37], v19 offset:40960
  v_add_f32 v5, v5, v139
  v_mfma_f32_16x16x32_bf16 v[108:111], v[52:55], v[228:231], v[108:111]
  ds_read_b64_tr_b16 v[38:39], v19 offset:43008
  v_add_f32 v2, v2, v140
  v_add_f32 v3, v3, v141
  s_waitcnt lgkmcnt(8)
  v_mfma_f32_16x16x32_bf16 v[112:115], v[56:59], v[224:227], v[112:115]
  ds_read_b64_tr_b16 v[40:41], v20 offset:40960
  v_add_f32 v4, v4, v142
  v_mfma_f32_16x16x32_bf16 v[120:123], v[56:59], v[228:231], v[120:123]
  ds_read_b64_tr_b16 v[42:43], v20 offset:43008
  v_add_f32 v5, v5, v143
  v_add_f32 v2, v2, v4
  s_waitcnt lgkmcnt(6)
  v_mfma_f32_16x16x32_bf16 v[116:119], v[60:63], v[224:227], v[116:119]
  ds_read_b64_tr_b16 v[44:45], v21 offset:40960
  v_add_f32 v3, v3, v5
  v_mfma_f32_16x16x32_bf16 v[124:127], v[60:63], v[228:231], v[124:127]
  ds_read_b64_tr_b16 v[46:47], v21 offset:43008
  v_mov_b32 v4, v2
  v_mov_b32 v5, v3
  s_waitcnt lgkmcnt(6)
  v_mfma_f32_16x16x32_bf16 v[64:67], v[32:35], v[232:235], v[64:67]
  ds_read_b64_tr_b16 v[48:49], v18 offset:41984
  s_add_u32 s35, s32, 24576
  buffer_load_dwordx4 v[224:227], v14, s[8:11], s35 offen offset:0
  v_mfma_f32_16x16x32_bf16 v[72:75], v[32:35], v[236:239], v[72:75]
  ds_read_b64_tr_b16 v[50:51], v18 offset:44032
  buffer_load_dwordx4 v[228:231], v15, s[8:11], s35 offen offset:0
  s_nop 1
  s_waitcnt lgkmcnt(6)
  v_mfma_f32_16x16x32_bf16 v[68:71], v[36:39], v[232:235], v[68:71]
  ds_read_b64_tr_b16 v[52:53], v19 offset:41984
  v_permlane32_swap_b32 v2, v4
  v_permlane32_swap_b32 v3, v5
  v_mfma_f32_16x16x32_bf16 v[76:79], v[36:39], v[236:239], v[76:79]
  ds_read_b64_tr_b16 v[54:55], v19 offset:44032
  s_nop 1
  v_add_f32 v2, v2, v4
  s_waitcnt lgkmcnt(6)
  v_mfma_f32_16x16x32_bf16 v[80:83], v[40:43], v[232:235], v[80:83]
  ds_read_b64_tr_b16 v[56:57], v20 offset:41984
  v_add_f32 v3, v3, v5
  v_mfma_f32_16x16x32_bf16 v[88:91], v[40:43], v[236:239], v[88:91]
  ds_read_b64_tr_b16 v[58:59], v20 offset:44032
  v_mul_f32 v2, 0xbb000000, v2
  v_mul_f32 v3, 0x3b000000, v3
  s_waitcnt lgkmcnt(6)
  v_mfma_f32_16x16x32_bf16 v[84:87], v[44:47], v[232:235], v[84:87]
  ds_read_b64_tr_b16 v[60:61], v21 offset:41984
  v_fma_f32 v3, -v2, v2, v3
  v_max_f32 v3, 0, v3
  v_mfma_f32_16x16x32_bf16 v[92:95], v[44:47], v[236:239], v[92:95]
  ds_read_b64_tr_b16 v[62:63], v21 offset:44032
  v_add_f32 v26, 0x3727c5ac, v3
  v_rsq_f32 v6, v26
  s_waitcnt lgkmcnt(6)
  v_mfma_f32_16x16x32_bf16 v[96:99], v[48:51], v[232:235], v[96:99]
  ds_read_b64_tr_b16 v[32:33], v18 offset:49152
  v_cvt_pk_bf16_f32 v4, v2, v2
  v_mfma_f32_16x16x32_bf16 v[104:107], v[48:51], v[236:239], v[104:107]
  ds_read_b64_tr_b16 v[34:35], v18 offset:51200
  v_and_b32 v4, 0xffff0000, v4
  v_sub_f32 v4, v2, v4
  s_waitcnt lgkmcnt(6)
  v_mfma_f32_16x16x32_bf16 v[100:103], v[52:55], v[232:235], v[100:103]
  ds_read_b64_tr_b16 v[36:37], v19 offset:49152
  v_cvt_pk_bf16_f32 v4, v2, v4
  v_mfma_f32_16x16x32_bf16 v[108:111], v[52:55], v[236:239], v[108:111]
  ds_read_b64_tr_b16 v[38:39], v19 offset:51200
  v_mov_b32 v5, v4
  v_mov_b32 v27, v26
  s_waitcnt lgkmcnt(6)
  v_mfma_f32_16x16x32_bf16 v[112:115], v[56:59], v[232:235], v[112:115]
  ds_read_b64_tr_b16 v[40:41], v20 offset:49152
  s_nop 0
  v_mfma_f32_16x16x32_bf16 v[120:123], v[56:59], v[236:239], v[120:123]
  ds_read_b64_tr_b16 v[42:43], v20 offset:51200
  v_permlane16_swap_b32 v4, v5
  v_permlane16_swap_b32 v26, v27
  s_waitcnt lgkmcnt(6)
  v_mfma_f32_16x16x32_bf16 v[116:119], v[60:63], v[232:235], v[116:119]
  ds_read_b64_tr_b16 v[44:45], v21 offset:49152
  s_nop 0
  v_mfma_f32_16x16x32_bf16 v[124:127], v[60:63], v[236:239], v[124:127]
  ds_read_b64_tr_b16 v[46:47], v21 offset:51200
  v_cndmask_b32_e64 v164, 0, v5, s[90:91]
  v_cndmask_b32_e64 v165, 0, v5, s[90:91]
  s_waitcnt lgkmcnt(6)
  v_mfma_f32_16x16x32_bf16 v[64:67], v[32:35], v[240:243], v[64:67]
  ds_read_b64_tr_b16 v[48:49], v18 offset:50176
  buffer_load_dwordx4 v[232:235], v14, s[8:11], s35 offen offset:2048
  v_mfma_f32_16x16x32_bf16 v[72:75], v[32:35], v[244:247], v[72:75]
  ds_read_b64_tr_b16 v[50:51], v18 offset:52224
  buffer_load_dwordx4 v[236:239], v15, s[8:11], s35 offen offset:2048
  v_mov_b32 v166, 0
  s_waitcnt lgkmcnt(6)
  v_mfma_f32_16x16x32_bf16 v[68:71], v[36:39], v[240:243], v[68:71]
  ds_read_b64_tr_b16 v[52:53], v19 offset:50176
  v_mov_b32 v167, 0
  v_cndmask_b32_e64 v28, 0, v4, s[90:91]
  v_mfma_f32_16x16x32_bf16 v[76:79], v[36:39], v[244:247], v[76:79]
  ds_read_b64_tr_b16 v[54:55], v19 offset:52224
  v_cndmask_b32_e64 v29, 0, v4, s[90:91]
  v_mov_b32 v30, 0
  s_waitcnt lgkmcnt(6)
  v_mfma_f32_16x16x32_bf16 v[80:83], v[40:43], v[240:243], v[80:83]
  ds_read_b64_tr_b16 v[56:57], v20 offset:50176
  v_mov_b32 v31, 0
  v_mfma_f32_16x16x32_bf16 v[88:91], v[40:43], v[244:247], v[88:91]
  ds_read_b64_tr_b16 v[58:59], v20 offset:52224
  v_mul_f32 v22, 0xc0135761, v6
  v_mul_f32 v4, v6, v6
  s_waitcnt lgkmcnt(6)
  v_mfma_f32_16x16x32_bf16 v[84:87], v[44:47], v[240:243], v[84:87]
  ds_read_b64_tr_b16 v[60:61], v21 offset:50176
  v_mul_f32 v4, v4, v6
  v_mul_f32 v24, 0xbdd2d3e8, v4
  v_mfma_f32_16x16x32_bf16 v[92:95], v[44:47], v[244:247], v[92:95]
  ds_read_b64_tr_b16 v[62:63], v21 offset:52224
  v_mov_b32 v23, v22
  v_mov_b32 v25, v24
  s_waitcnt lgkmcnt(6)
  v_mfma_f32_16x16x32_bf16 v[96:99], v[48:51], v[240:243], v[96:99]
  ds_read_b64_tr_b16 v[32:33], v18 offset:57344
  v_mfma_f32_16x16x32_bf16 v[104:107], v[48:51], v[244:247], v[104:107]
  ds_read_b64_tr_b16 v[34:35], v18 offset:59392
  s_waitcnt lgkmcnt(6)
  v_mfma_f32_16x16x32_bf16 v[100:103], v[52:55], v[240:243], v[100:103]
  ds_read_b64_tr_b16 v[36:37], v19 offset:57344
  s_nop 1
  v_mfma_f32_16x16x32_bf16 v[108:111], v[52:55], v[244:247], v[108:111]
  ds_read_b64_tr_b16 v[38:39], v19 offset:59392
  s_waitcnt lgkmcnt(6)
  v_mfma_f32_16x16x32_bf16 v[112:115], v[56:59], v[240:243], v[112:115]
  ds_read_b64_tr_b16 v[40:41], v20 offset:57344
  v_mfma_f32_16x16x32_bf16 v[120:123], v[56:59], v[244:247], v[120:123]
  ds_read_b64_tr_b16 v[42:43], v20 offset:59392
  v_permlane16_swap_b32 v22, v23
  s_waitcnt lgkmcnt(6)
  v_mfma_f32_16x16x32_bf16 v[116:119], v[60:63], v[240:243], v[116:119]
  ds_read_b64_tr_b16 v[44:45], v21 offset:57344
  v_mfma_f32_16x16x32_bf16 v[124:127], v[60:63], v[244:247], v[124:127]
  ds_read_b64_tr_b16 v[46:47], v21 offset:59392
  v_permlane16_swap_b32 v24, v25
  s_waitcnt lgkmcnt(6)
  v_mfma_f32_16x16x32_bf16 v[64:67], v[32:35], v[248:251], v[64:67]
  ds_read_b64_tr_b16 v[48:49], v18 offset:58368
  s_waitcnt vmcnt(16)
  v_mfma_f32_16x16x32_bf16 v[72:75], v[32:35], v[252:255], v[72:75]
  ds_read_b64_tr_b16 v[50:51], v18 offset:60416
  s_waitcnt lgkmcnt(6)
  v_mfma_f32_16x16x32_bf16 v[68:71], v[36:39], v[248:251], v[68:71]
  ds_read_b64_tr_b16 v[52:53], v19 offset:58368
  v_mfma_f32_16x16x32_bf16 v[76:79], v[36:39], v[252:255], v[76:79]
  ds_read_b64_tr_b16 v[54:55], v19 offset:60416
  s_waitcnt lgkmcnt(6)
  v_mfma_f32_16x16x32_bf16 v[80:83], v[40:43], v[248:251], v[80:83]
  ds_read_b64_tr_b16 v[56:57], v20 offset:58368
  v_mfma_f32_16x16x32_bf16 v[88:91], v[40:43], v[252:255], v[88:91]
  ds_read_b64_tr_b16 v[58:59], v20 offset:60416
  s_waitcnt lgkmcnt(6)
  v_mfma_f32_16x16x32_bf16 v[84:87], v[44:47], v[248:251], v[84:87]
  ds_read_b64_tr_b16 v[60:61], v21 offset:58368
  v_mfma_f32_16x16x32_bf16 v[92:95], v[44:47], v[252:255], v[92:95]
  ds_read_b64_tr_b16 v[62:63], v21 offset:60416
  v_mfma_f32_16x16x32_bf16 v[96:99], v[152:155], v[28:31], v[96:99]
  v_mfma_f32_16x16x32_bf16 v[104:107], v[152:155], v[164:167], v[104:107]
  v_mfma_f32_16x16x32_bf16 v[100:103], v[154:157], v[28:31], v[100:103]
  v_mfma_f32_16x16x32_bf16 v[108:111], v[154:157], v[164:167], v[108:111]
  v_mfma_f32_16x16x32_bf16 v[112:115], v[156:159], v[28:31], v[112:115]
  v_mfma_f32_16x16x32_bf16 v[120:123], v[156:159], v[164:167], v[120:123]
  v_mfma_f32_16x16x32_bf16 v[116:119], v[158:161], v[28:31], v[116:119]
  v_mfma_f32_16x16x32_bf16 v[124:127], v[158:161], v[164:167], v[124:127]
  v_mfma_f32_16x16x32_bf16 v[64:67], v[144:147], v[28:31], v[64:67]
  v_mfma_f32_16x16x32_bf16 v[72:75], v[144:147], v[164:167], v[72:75]
  v_mfma_f32_16x16x32_bf16 v[68:71], v[146:149], v[28:31], v[68:71]
  v_mfma_f32_16x16x32_bf16 v[76:79], v[146:149], v[164:167], v[76:79]
  v_mfma_f32_16x16x32_bf16 v[80:83], v[148:151], v[28:31], v[80:83]
  v_mfma_f32_16x16x32_bf16 v[88:91], v[148:151], v[164:167], v[88:91]
  v_mfma_f32_16x16x32_bf16 v[84:87], v[150:153], v[28:31], v[84:87]
  v_mfma_f32_16x16x32_bf16 v[92:95], v[150:153], v[164:167], v[92:95]
  s_waitcnt lgkmcnt(6)
  v_mfma_f32_16x16x32_bf16 v[96:99], v[48:51], v[248:251], v[96:99]
  v_mfma_f32_16x16x32_bf16 v[104:107], v[48:51], v[252:255], v[104:107]
  s_waitcnt lgkmcnt(4)
  v_mfma_f32_16x16x32_bf16 v[100:103], v[52:55], v[248:251], v[100:103]
  v_mfma_f32_16x16x32_bf16 v[108:111], v[52:55], v[252:255], v[108:111]
  s_waitcnt lgkmcnt(2)
  v_mfma_f32_16x16x32_bf16 v[112:115], v[56:59], v[248:251], v[112:115]
  v_mfma_f32_16x16x32_bf16 v[120:123], v[56:59], v[252:255], v[120:123]
  s_waitcnt lgkmcnt(0)
  v_mfma_f32_16x16x32_bf16 v[116:119], v[60:63], v[248:251], v[116:119]
  v_mfma_f32_16x16x32_bf16 v[124:127], v[60:63], v[252:255], v[124:127]
  s_add_u32 s35, s32, 0
  buffer_load_dwordx4 v[128:131], v14, s[8:11], s35 offen offset:0
  buffer_load_dwordx4 v[132:135], v15, s[8:11], s35 offen offset:0
  buffer_load_dwordx4 v[136:139], v14, s[8:11], s35 offen offset:2048
  buffer_load_dwordx4 v[140:143], v15, s[8:11], s35 offen offset:2048
  s_add_u32 s35, s32, 4096
  buffer_load_dwordx4 v[144:147], v14, s[8:11], s35 offen offset:0
  buffer_load_dwordx4 v[148:151], v15, s[8:11], s35 offen offset:0
  buffer_load_dwordx4 v[152:155], v14, s[8:11], s35 offen offset:2048
  buffer_load_dwordx4 v[156:159], v15, s[8:11], s35 offen offset:2048
  s_add_u32 s35, s32, 8192
  buffer_load_dwordx4 v[160:163], v14, s[8:11], s35 offen offset:0
  buffer_load_dwordx4 v[164:167], v15, s[8:11], s35 offen offset:0
  buffer_load_dwordx4 v[168:171], v14, s[8:11], s35 offen offset:2048
  buffer_load_dwordx4 v[172:175], v15, s[8:11], s35 offen offset:2048
  s_waitcnt lgkmcnt(0)
  s_nop 0
  s_setprio 0
  s_lshr_b32 s24, s7, 3
  s_lshl_b32 s30, s6, 3
  s_add_u32 s30, s30, s24
  s_lshl_b32 s26, s6, 2
  s_add_u32 s24, s24, s26
  s_and_b32 s25, s7, 7
  s_and_b32 s26, s5, 3
  v_lshlrev_b32 v17, 4, v1
  s_mul_i32 s27, s5, 7
  s_lshr_b32 s27, s27, 1
  s_and_b32 s29, s30, 31
  s_lshl_b32 s28, s29, 5
  s_add_u32 s28, s27, s28
  s_and_b32 s27, s28, 63
  s_lshl_b32 s27, s27, 7
  s_lshr_b32 s56, s28, 6
  s_lshl_b32 s56, s56, 14
  s_add_u32 s27, s27, s56
  s_xor_b32 s56, s94, 0x2000
  s_add_u32 s27, s27, s56
  s_add_u32 s27, s27, s95
  s_add_u32 s27, s27, 262144
  s_add_u32 s0, s54, s27
  s_addc_u32 s1, s55, 0
  s_lshr_b32 s56, s29, 3
  s_lshl_b32 s56, s56, 22
  s_and_b32 s27, s29, 7
  s_lshl_b32 s27, s27, 18
  s_add_u32 s56, s56, s27
  s_xor_b32 s27, s94, 0x2000
  s_add_u32 s56, s56, s27
  s_add_u32 s56, s56, s3
  s_add_u32 s56, s56, 2097152
  s_lshl_b32 s27, s5, 15
  s_add_u32 s56, s56, s27
  s_mul_i32 s87, s26, 6144
  s_add_u32 s87, s87, 135168
  s_lshl_b32 s88, s26, 14
  s_lshl_b32 s27, s26, 2
  s_add_u32 s27, s27, 132112
  v_mov_b32 v31, s27
  v_mov_b32 v2, 132096
  v_mov_b32 v3, 132128
  v_mov_b32 v8, 132144
  ds_write_b32 v31, v31 offset:32
  v_mul_f32 v240, v64, v64
  v_mul_f32 v241, v65, v65
  v_mul_f32 v242, v66, v66
  v_mul_f32 v243, v67, v67
  v_mul_f32 v244, v68, v68
  v_mul_f32 v245, v69, v69
  v_mul_f32 v246, v70, v70
  v_mul_f32 v247, v71, v71
  v_fma_f32 v240, v240, v24, v22
  v_fma_f32 v241, v241, v24, v22
  v_fma_f32 v242, v242, v24, v22
  v_fma_f32 v243, v243, v24, v22
  v_fma_f32 v244, v244, v24, v22
  v_fma_f32 v245, v245, v24, v22
  v_fma_f32 v246, v246, v24, v22
  v_fma_f32 v247, v247, v24, v22
  v_mul_f32 v240, v240, v64
  v_mul_f32 v241, v241, v65
  v_mul_f32 v242, v242, v66
  v_mul_f32 v243, v243, v67
  v_mul_f32 v244, v244, v68
  v_mul_f32 v245, v245, v69
  v_mul_f32 v246, v246, v70
  v_mul_f32 v247, v247, v71
  v_exp_f32 v240, v240
  v_exp_f32 v241, v241
  v_exp_f32 v242, v242
  v_exp_f32 v243, v243
  v_exp_f32 v244, v244
  v_exp_f32 v245, v245
  v_exp_f32 v246, v246
  v_exp_f32 v247, v247
  v_mul_f32 v64, v64, v96
  v_mul_f32 v65, v65, v97
  v_mul_f32 v66, v66, v98
  v_mul_f32 v67, v67, v99
  v_mul_f32 v68, v68, v100
  v_mul_f32 v69, v69, v101
  v_mul_f32 v70, v70, v102
  v_mul_f32 v71, v71, v103
  v_fma_f32 v240, v240, v26, v26
  v_fma_f32 v241, v241, v26, v26
  v_fma_f32 v242, v242, v26, v26
  v_fma_f32 v243, v243, v26, v26
  v_fma_f32 v244, v244, v26, v26
  v_fma_f32 v245, v245, v26, v26
  v_fma_f32 v246, v246, v26, v26
  v_fma_f32 v247, v247, v26, v26
  v_rcp_f32 v240, v240
  v_rcp_f32 v241, v241
  v_rcp_f32 v242, v242
  v_rcp_f32 v243, v243
  v_rcp_f32 v244, v244
  v_rcp_f32 v245, v245
  v_rcp_f32 v246, v246
  v_rcp_f32 v247, v247
  s_nop 0
  v_mul_f32 v64, v64, v240
  v_mul_f32 v65, v65, v241
  v_mul_f32 v66, v66, v242
  v_mul_f32 v67, v67, v243
  v_mul_f32 v68, v68, v244
  v_mul_f32 v69, v69, v245
  v_mul_f32 v70, v70, v246
  v_mul_f32 v71, v71, v247
  v_cvt_pk_bf16_f32 v32, v64, v65
  v_cvt_pk_bf16_f32 v33, v66, v67
  v_cvt_pk_bf16_f32 v34, v68, v69
  v_cvt_pk_bf16_f32 v35, v70, v71
  buffer_store_dwordx4 v[32:35], v16, s[8:11], s84 offen offset:0 sc1
  v_mul_f32 v248, v72, v72
  v_mul_f32 v249, v73, v73
  v_mul_f32 v250, v74, v74
  v_mul_f32 v251, v75, v75
  v_mul_f32 v252, v76, v76
  v_mul_f32 v253, v77, v77
  v_mul_f32 v254, v78, v78
  v_mul_f32 v255, v79, v79
  v_fma_f32 v248, v248, v25, v23
  v_fma_f32 v249, v249, v25, v23
  v_fma_f32 v250, v250, v25, v23
  v_fma_f32 v251, v251, v25, v23
  v_fma_f32 v252, v252, v25, v23
  v_fma_f32 v253, v253, v25, v23
  v_fma_f32 v254, v254, v25, v23
  v_fma_f32 v255, v255, v25, v23
  v_mul_f32 v248, v248, v72
  v_mul_f32 v249, v249, v73
  v_mul_f32 v250, v250, v74
  v_mul_f32 v251, v251, v75
  v_mul_f32 v252, v252, v76
  v_mul_f32 v253, v253, v77
  v_mul_f32 v254, v254, v78
  v_mul_f32 v255, v255, v79
  v_exp_f32 v248, v248
  v_exp_f32 v249, v249
  v_exp_f32 v250, v250
  v_exp_f32 v251, v251
  v_exp_f32 v252, v252
  v_exp_f32 v253, v253
  v_exp_f32 v254, v254
  v_exp_f32 v255, v255
  v_mul_f32 v72, v72, v104
  v_mul_f32 v73, v73, v105
  v_mul_f32 v74, v74, v106
  v_mul_f32 v75, v75, v107
  v_mul_f32 v76, v76, v108
  v_mul_f32 v77, v77, v109
  v_mul_f32 v78, v78, v110
  v_mul_f32 v79, v79, v111
  v_fma_f32 v248, v248, v27, v27
  v_fma_f32 v249, v249, v27, v27
  v_fma_f32 v250, v250, v27, v27
  v_fma_f32 v251, v251, v27, v27
  v_fma_f32 v252, v252, v27, v27
  v_fma_f32 v253, v253, v27, v27
  v_fma_f32 v254, v254, v27, v27
  v_fma_f32 v255, v255, v27, v27
  v_rcp_f32 v248, v248
  v_rcp_f32 v249, v249
  v_rcp_f32 v250, v250
  v_rcp_f32 v251, v251
  v_rcp_f32 v252, v252
  v_rcp_f32 v253, v253
  v_rcp_f32 v254, v254
  v_rcp_f32 v255, v255
  s_nop 0
  v_mul_f32 v72, v72, v248
  v_mul_f32 v73, v73, v249
  v_mul_f32 v74, v74, v250
  v_mul_f32 v75, v75, v251
  v_mul_f32 v76, v76, v252
  v_mul_f32 v77, v77, v253
  v_mul_f32 v78, v78, v254
  v_mul_f32 v79, v79, v255
  v_cvt_pk_bf16_f32 v36, v72, v73
  v_cvt_pk_bf16_f32 v37, v74, v75
  v_cvt_pk_bf16_f32 v38, v76, v77
  v_cvt_pk_bf16_f32 v39, v78, v79
  buffer_store_dwordx4 v[36:39], v16, s[8:11], s84 offen offset:256 sc1
  v_mul_f32 v240, v80, v80
  v_mul_f32 v241, v81, v81
  v_mul_f32 v242, v82, v82
  v_mul_f32 v243, v83, v83
  v_mul_f32 v244, v84, v84
  v_mul_f32 v245, v85, v85
  v_mul_f32 v246, v86, v86
  v_mul_f32 v247, v87, v87
  v_fma_f32 v240, v240, v24, v22
  v_fma_f32 v241, v241, v24, v22
  v_fma_f32 v242, v242, v24, v22
  v_fma_f32 v243, v243, v24, v22
  v_fma_f32 v244, v244, v24, v22
  v_fma_f32 v245, v245, v24, v22
  v_fma_f32 v246, v246, v24, v22
  v_fma_f32 v247, v247, v24, v22
  v_mul_f32 v240, v240, v80
  v_mul_f32 v241, v241, v81
  v_mul_f32 v242, v242, v82
  v_mul_f32 v243, v243, v83
  v_mul_f32 v244, v244, v84
  v_mul_f32 v245, v245, v85
  v_mul_f32 v246, v246, v86
  v_mul_f32 v247, v247, v87
  v_exp_f32 v240, v240
  v_exp_f32 v241, v241
  v_exp_f32 v242, v242
  v_exp_f32 v243, v243
  v_exp_f32 v244, v244
  v_exp_f32 v245, v245
  v_exp_f32 v246, v246
  v_exp_f32 v247, v247
  v_mul_f32 v80, v80, v112
  v_mul_f32 v81, v81, v113
  v_mul_f32 v82, v82, v114
  v_mul_f32 v83, v83, v115
  v_mul_f32 v84, v84, v116
  v_mul_f32 v85, v85, v117
  v_mul_f32 v86, v86, v118
  v_mul_f32 v87, v87, v119
  v_fma_f32 v240, v240, v26, v26
  v_fma_f32 v241, v241, v26, v26
  v_fma_f32 v242, v242, v26, v26
  v_fma_f32 v243, v243, v26, v26
  v_fma_f32 v244, v244, v26, v26
  v_fma_f32 v245, v245, v26, v26
  v_fma_f32 v246, v246, v26, v26
  v_fma_f32 v247, v247, v26, v26
  v_rcp_f32 v240, v240
  v_rcp_f32 v241, v241
  v_rcp_f32 v242, v242
  v_rcp_f32 v243, v243
  v_rcp_f32 v244, v244
  v_rcp_f32 v245, v245
  v_rcp_f32 v246, v246
  v_rcp_f32 v247, v247
  s_nop 0
  v_mul_f32 v80, v80, v240
  v_mul_f32 v81, v81, v241
  v_mul_f32 v82, v82, v242
  v_mul_f32 v83, v83, v243
  v_mul_f32 v84, v84, v244
  v_mul_f32 v85, v85, v245
  v_mul_f32 v86, v86, v246
  v_mul_f32 v87, v87, v247
  v_cvt_pk_bf16_f32 v40, v80, v81
  v_cvt_pk_bf16_f32 v41, v82, v83
  v_cvt_pk_bf16_f32 v42, v84, v85
  v_cvt_pk_bf16_f32 v43, v86, v87
  buffer_store_dwordx4 v[40:43], v11, s[8:11], s92 offen offset:0 sc1
  v_mul_f32 v248, v88, v88
  v_mul_f32 v249, v89, v89
  v_mul_f32 v250, v90, v90
  v_mul_f32 v251, v91, v91
  v_mul_f32 v252, v92, v92
  v_mul_f32 v253, v93, v93
  v_mul_f32 v254, v94, v94
  v_mul_f32 v255, v95, v95
  v_fma_f32 v248, v248, v25, v23
  v_fma_f32 v249, v249, v25, v23
  v_fma_f32 v250, v250, v25, v23
  v_fma_f32 v251, v251, v25, v23
  v_fma_f32 v252, v252, v25, v23
  v_fma_f32 v253, v253, v25, v23
  v_fma_f32 v254, v254, v25, v23
  v_fma_f32 v255, v255, v25, v23
  v_mul_f32 v248, v248, v88
  v_mul_f32 v249, v249, v89
  v_mul_f32 v250, v250, v90
  v_mul_f32 v251, v251, v91
  v_mul_f32 v252, v252, v92
  v_mul_f32 v253, v253, v93
  v_mul_f32 v254, v254, v94
  v_mul_f32 v255, v255, v95
  v_exp_f32 v248, v248
  v_exp_f32 v249, v249
  v_exp_f32 v250, v250
  v_exp_f32 v251, v251
  v_exp_f32 v252, v252
  v_exp_f32 v253, v253
  v_exp_f32 v254, v254
  v_exp_f32 v255, v255
  v_mul_f32 v88, v88, v120
  v_mul_f32 v89, v89, v121
  v_mul_f32 v90, v90, v122
  v_mul_f32 v91, v91, v123
  v_mul_f32 v92, v92, v124
  v_mul_f32 v93, v93, v125
  v_mul_f32 v94, v94, v126
  v_mul_f32 v95, v95, v127
  v_fma_f32 v248, v248, v27, v27
  v_fma_f32 v249, v249, v27, v27
  v_fma_f32 v250, v250, v27, v27
  v_fma_f32 v251, v251, v27, v27
  v_fma_f32 v252, v252, v27, v27
  v_fma_f32 v253, v253, v27, v27
  v_fma_f32 v254, v254, v27, v27
  v_fma_f32 v255, v255, v27, v27
  v_rcp_f32 v248, v248
  v_rcp_f32 v249, v249
  v_rcp_f32 v250, v250
  v_rcp_f32 v251, v251
  v_rcp_f32 v252, v252
  v_rcp_f32 v253, v253
  v_rcp_f32 v254, v254
  v_rcp_f32 v255, v255
  s_nop 0
  v_mul_f32 v88, v88, v248
  v_mul_f32 v89, v89, v249
  v_mul_f32 v90, v90, v250
  v_mul_f32 v91, v91, v251
  v_mul_f32 v92, v92, v252
  v_mul_f32 v93, v93, v253
  v_mul_f32 v94, v94, v254
  v_mul_f32 v95, v95, v255
  v_cvt_pk_bf16_f32 v44, v88, v89
  v_cvt_pk_bf16_f32 v45, v90, v91
  v_cvt_pk_bf16_f32 v46, v92, v93
  v_cvt_pk_bf16_f32 v47, v94, v95
  buffer_store_dwordx4 v[44:47], v11, s[8:11], s92 offen offset:256 sc1
  s_setprio 0
  s_add_u32 m0, s87, 0
  s_add_u32 s31, s32, 114688
  buffer_load_dwordx4 v17, s[8:11], s31 offen lds
  buffer_load_dwordx4 v17, s[8:11], s31 offen offset:1024 lds
  s_add_u32 m0, s87, 2048
  s_add_u32 s31, s32, 116736
  buffer_load_dwordx4 v17, s[8:11], s31 offen lds
  buffer_load_dwordx4 v17, s[8:11], s31 offen offset:1024 lds
  s_add_u32 m0, s87, 4096
  s_add_u32 s31, s32, 118784
  buffer_load_dwordx4 v17, s[8:11], s31 offen lds
  buffer_load_dwordx4 v17, s[8:11], s31 offen offset:1024 lds
  s_mov_b32 s33, 0
L_dnr_lp:
  ds_read_b128 v[4:7], v8 offset:0
  s_add_u32 s33, s33, 1
  s_waitcnt lgkmcnt(0)
  v_min_u32 v4, v4, v5
  v_min3_u32 v4, v4, v6, v7
  s_nop 0
  v_readfirstlane_b32 s34, v4
  s_cmp_lg_u32 s34, 0
  s_cbranch_scc1 L_dnr_ld
  s_sleep 1
  s_cmp_lt_u32 s33, 262144
  s_cbranch_scc1 L_dnr_lp
L_dnr_ld:
  s_mov_b32 s33, 0
L_dnq_lp:
  ds_read_b128 v[4:7], v3 offset:0
  s_add_u32 s33, s33, 1
  s_waitcnt lgkmcnt(0)
  v_min_u32 v4, v4, v5
  v_min3_u32 v4, v4, v6, v7
  s_nop 0
  v_readfirstlane_b32 s34, v4
  s_cmp_lg_u32 s34, 0
  s_cbranch_scc1 L_dnq_ld
  s_sleep 1
  s_cmp_lt_u32 s33, 262144
  s_cbranch_scc1 L_dnq_lp
L_dnq_ld:
  s_add_u32 m0, s88, 0
  s_add_u32 s31, s32, 120832
  buffer_load_dwordx4 v17, s[8:11], s31 offen lds
  buffer_load_dwordx4 v17, s[8:11], s31 offen offset:1024 lds
  v_mov_b32 v4, s76
  v_mov_b32 v5, s77
  s_mov_b64 exec, 1
  s_waitcnt vmcnt(8)
  buffer_store_dwordx2 v[4:5], off, s[8:11], s83 sc1
  s_mov_b64 exec, -1
  s_add_u32 m0, s88, 2048
  s_add_u32 s31, s32, 122880
  buffer_load_dwordx4 v17, s[8:11], s31 offen lds
  buffer_load_dwordx4 v17, s[8:11], s31 offen offset:1024 lds
  s_add_u32 m0, s88, 4096
  s_add_u32 s31, s32, 124928
  buffer_load_dwordx4 v17, s[8:11], s31 offen lds
  buffer_load_dwordx4 v17, s[8:11], s31 offen offset:1024 lds
  s_add_u32 m0, s88, 6144
  s_add_u32 s31, s32, 126976
  buffer_load_dwordx4 v17, s[8:11], s31 offen lds
  buffer_load_dwordx4 v17, s[8:11], s31 offen offset:1024 lds
  s_add_u32 m0, s88, 8192
  s_add_u32 s31, s32, 129024
  buffer_load_dwordx4 v17, s[8:11], s31 offen lds
  buffer_load_dwordx4 v17, s[8:11], s31 offen offset:1024 lds
  s_add_u32 m0, s88, 10240
  s_add_u32 s31, s32, 131072
  buffer_load_dwordx4 v17, s[8:11], s31 offen lds
  buffer_load_dwordx4 v17, s[8:11], s31 offen offset:1024 lds
  s_add_u32 m0, s88, 12288
  s_add_u32 s31, s32, 133120
  buffer_load_dwordx4 v17, s[8:11], s31 offen lds
  buffer_load_dwordx4 v17, s[8:11], s31 offen offset:1024 lds
  s_add_u32 m0, s88, 14336
  s_add_u32 s31, s32, 135168
  buffer_load_dwordx4 v17, s[8:11], s31 offen lds
  buffer_load_dwordx4 v17, s[8:11], s31 offen offset:1024 lds
  s_mov_b32 s33, 0
L_dnp_lp:
  ds_read_b128 v[4:7], v2 offset:0
  s_add_u32 s33, s33, 1
  s_waitcnt lgkmcnt(0)
  v_min_u32 v4, v4, v5
  v_min3_u32 v4, v4, v6, v7
  s_nop 0
  v_readfirstlane_b32 s34, v4
  s_cmp_lg_u32 s34, 0
  s_cbranch_scc1 L_dnp_ld
  s_sleep 1
  s_cmp_lt_u32 s33, 262144
  s_cbranch_scc1 L_dnp_lp
L_dnp_ld:
  s_sub_u32 m0, s87, 69632
  s_add_u32 s31, s32, 137216
  buffer_load_dwordx4 v17, s[8:11], s31 offen lds
  buffer_load_dwordx4 v17, s[8:11], s31 offen offset:1024 lds
  s_sub_u32 m0, s87, 67584
  s_add_u32 s31, s32, 139264
  buffer_load_dwordx4 v17, s[8:11], s31 offen lds
  buffer_load_dwordx4 v17, s[8:11], s31 offen offset:1024 lds
  s_sub_u32 m0, s87, 65536
  s_add_u32 s31, s32, 141312
  buffer_load_dwordx4 v17, s[8:11], s31 offen lds
  buffer_load_dwordx4 v17, s[8:11], s31 offen offset:1024 lds
  s_branch L_dn_A2
L_mffn_skip:
  v_mov_b32 v4, s76
  v_mov_b32 v5, s77
  s_cmp_lg_u32 s5, 0
  s_mov_b64 exec, 1
  s_waitcnt vmcnt(0) lgkmcnt(0)
  s_barrier
  s_cbranch_scc1 L_pub_32
  buffer_store_dwordx2 v[4:5], off, s[8:11], s78 sc1
L_pub_32:
  s_mov_b64 exec, -1
  s_sleep 16
  s_sleep 16
  s_sub_u32 s24, s7, 28
  s_lshl_b32 s24, s24, 3
  s_add_u32 s24, s24, s5
  s_mul_i32 s24, s24, 28672
  s_add_u32 s24, s24, 24117248
  v_lshlrev_b32 v3, 7, v1
  buffer_load_dword v64, v3, s[8:11], s24 offen
  s_add_u32 s24, s24, 8192
  buffer_load_dword v65, v3, s[8:11], s24 offen
  s_add_u32 s24, s24, 8192
  buffer_load_dword v66, v3, s[8:11], s24 offen
  s_add_u32 s24, s24, 8192
  s_mov_b32 exec_hi, 0
  buffer_load_dword v67, v3, s[8:11], s24 offen
  s_add_u32 s24, s24, 8192
  s_mov_b64 exec, -1
  s_mov_b32 s12, s38
  s_and_b32 s13, s39, 0xffff
  s_mov_b32 s14, 1572864
  s_mov_b32 s15, 0x20000
  s_sub_u32 s24, s7, 28
  s_lshl_b32 s24, s24, 3
  s_add_u32 s24, s24, s5
  s_mul_i32 s92, s24, 49152
  s_and_b32 s25, s6, 1
  s_mul_i32 s25, s25, 1536
  s_add_u32 s92, s92, s25
  v_add_u32 v3, 0, v1
  v_mul_u32_u24 v8, 171, v3
  v_lshrrev_b32 v8, 11, v8
  v_mul_u32_u24 v9, 12, v8
  v_sub_u32 v9, v3, v9
  v_lshlrev_b32 v9, 7, v9
  v_mul_u32_u24 v8, 3072, v8
  v_add_u32 v10, v8, v9
  v_add_u32 v3, 64, v1
  v_mul_u32_u24 v8, 171, v3
  v_lshrrev_b32 v8, 11, v8
  v_mul_u32_u24 v9, 12, v8
  v_sub_u32 v9, v3, v9
  v_lshlrev_b32 v9, 7, v9
  v_mul_u32_u24 v8, 3072, v8
  v_add_u32 v11, v8, v9
  v_add_u32 v3, 128, v1
  v_mul_u32_u24 v8, 171, v3
  v_lshrrev_b32 v8, 11, v8
  v_mul_u32_u24 v9, 12, v8
  v_sub_u32 v9, v3, v9
  v_lshlrev_b32 v9, 7, v9
  v_mul_u32_u24 v8, 3072, v8
  v_add_u32 v12, v8, v9
  s_sleep 16
  s_sleep 16
  s_sleep 16
  s_sleep 16
  buffer_load_dword v68, v10, s[12:15], s92 offen
  buffer_load_dword v69, v11, s[12:15], s92 offen
  buffer_load_dword v70, v12, s[12:15], s92 offen
  s_and_b32 s28, s5, 1
  s_lshl_b32 s28, s28, 8
  s_bfe_u32 s31, s5, 0x10001
  s_lshl_b32 s31, s31, 10
  s_add_u32 s28, s28, s31
  v_lshlrev_b32 v14, 4, v1
  v_xor_b32 v14, s28, v14
  v_xor_b32 v15, 1024, v14
  s_mul_i32 s28, s5, 14
  s_and_b32 s32, s7, 7
  s_mul_i32 s32, s32, 112
  s_add_u32 s32, s32, s28
  s_lshl_b32 s32, s32, 11
  s_add_u32 s32, s32, 24117248
  s_lshr_b32 s24, s7, 3
  s_lshl_b32 s30, s6, 3
  s_add_u32 s30, s30, s24
  s_lshl_b32 s26, s6, 2
  s_add_u32 s24, s24, s26
  s_and_b32 s25, s7, 7
  s_and_b32 s26, s5, 3
  v_lshlrev_b32 v17, 4, v1
  s_mul_i32 s27, s5, 7
  s_lshr_b32 s27, s27, 1
  s_and_b32 s29, s30, 31
  s_lshl_b32 s28, s29, 5
  s_add_u32 s28, s27, s28
  s_and_b32 s27, s28, 63
  s_lshl_b32 s27, s27, 7
  s_lshr_b32 s56, s28, 6
  s_lshl_b32 s56, s56, 14
  s_add_u32 s27, s27, s56
  s_xor_b32 s56, s94, 0x2000
  s_add_u32 s27, s27, s56
  s_add_u32 s27, s27, s95
  s_add_u32 s27, s27, 262144
  s_add_u32 s0, s54, s27
  s_addc_u32 s1, s55, 0
  s_lshr_b32 s56, s29, 3
  s_lshl_b32 s56, s56, 22
  s_and_b32 s27, s29, 7
  s_lshl_b32 s27, s27, 18
  s_add_u32 s56, s56, s27
  s_xor_b32 s27, s94, 0x2000
  s_add_u32 s56, s56, s27
  s_add_u32 s56, s56, s3
  s_add_u32 s56, s56, 2097152
  s_lshl_b32 s27, s5, 15
  s_add_u32 s56, s56, s27
  s_mul_i32 s87, s26, 6144
  s_add_u32 s87, s87, 135168
  s_lshl_b32 s88, s26, 14
  s_lshl_b32 s27, s26, 2
  s_add_u32 s27, s27, 132112
  v_mov_b32 v31, s27
  v_mov_b32 v5, 0
  v_lshlrev_b32 v6, 2, v1
  v_add_u32 v6, 132096, v6
  ds_write_b32 v6, v5
  s_waitcnt lgkmcnt(0)
  s_barrier
  s_cmp_ge_u32 s5, 4
  s_cbranch_scc1 L_dn_B
  s_add_u32 s35, s32, 0
  buffer_load_dwordx4 v[128:131], v14, s[8:11], s35 offen offset:0
  buffer_load_dwordx4 v[132:135], v15, s[8:11], s35 offen offset:0
  buffer_load_dwordx4 v[136:139], v14, s[8:11], s35 offen offset:2048
  buffer_load_dwordx4 v[140:143], v15, s[8:11], s35 offen offset:2048
  s_add_u32 s35, s32, 4096
  buffer_load_dwordx4 v[144:147], v14, s[8:11], s35 offen offset:0
  buffer_load_dwordx4 v[148:151], v15, s[8:11], s35 offen offset:0
  buffer_load_dwordx4 v[152:155], v14, s[8:11], s35 offen offset:2048
  buffer_load_dwordx4 v[156:159], v15, s[8:11], s35 offen offset:2048
  s_add_u32 s35, s32, 8192
  buffer_load_dwordx4 v[160:163], v14, s[8:11], s35 offen offset:0
  buffer_load_dwordx4 v[164:167], v15, s[8:11], s35 offen offset:0
  buffer_load_dwordx4 v[168:171], v14, s[8:11], s35 offen offset:2048
  buffer_load_dwordx4 v[172:175], v15, s[8:11], s35 offen offset:2048
  s_add_u32 s35, s32, 12288
  buffer_load_dwordx4 v[176:179], v14, s[8:11], s35 offen offset:0
  buffer_load_dwordx4 v[180:183], v15, s[8:11], s35 offen offset:0
  buffer_load_dwordx4 v[184:187], v14, s[8:11], s35 offen offset:2048
  buffer_load_dwordx4 v[188:191], v15, s[8:11], s35 offen offset:2048
  s_add_u32 s35, s32, 16384
  buffer_load_dwordx4 v[192:195], v14, s[8:11], s35 offen offset:0
  buffer_load_dwordx4 v[196:199], v15, s[8:11], s35 offen offset:0
  buffer_load_dwordx4 v[200:203], v14, s[8:11], s35 offen offset:2048
  buffer_load_dwordx4 v[204:207], v15, s[8:11], s35 offen offset:2048
  s_add_u32 s35, s32, 20480
  buffer_load_dwordx4 v[208:211], v14, s[8:11], s35 offen offset:0
  buffer_load_dwordx4 v[212:215], v15, s[8:11], s35 offen offset:0
  buffer_load_dwordx4 v[216:219], v14, s[8:11], s35 offen offset:2048
  buffer_load_dwordx4 v[220:223], v15, s[8:11], s35 offen offset:2048
  s_add_u32 s35, s32, 24576
  buffer_load_dwordx4 v[224:227], v14, s[8:11], s35 offen offset:0
  buffer_load_dwordx4 v[228:231], v15, s[8:11], s35 offen offset:0
  buffer_load_dwordx4 v[232:235], v14, s[8:11], s35 offen offset:2048
  buffer_load_dwordx4 v[236:239], v15, s[8:11], s35 offen offset:2048
  s_branch L_dn_A
L_mffn_epiB:
  s_xor_b32 s63, s94, 0x2000
  s_add_u32 s30, s30, s63
  s_add_u32 s30, s30, s3
  s_add_u32 s30, s30, 18874368
  v_and_b32 v11, 31, v1
  v_lshlrev_b32 v12, 3, v11
  v_lshl_add_u32 v12, v7, 11, v12
  v_lshlrev_b32 v10, 4, v11
  s_mov_b32 s91, 0
  v_lshlrev_b32 v10, 3, v11
  v_add_u32 v10, 131072, v10
  s_lshr_b32 s85, s27, 3
  s_lshl_b32 s85, s85, 22
  s_and_b32 s84, s27, 7
  s_lshl_b32 s84, s84, 18
  s_add_u32 s85, s85, s84
  s_xor_b32 s84, s94, 0x2000
  s_add_u32 s85, s85, s84
  s_add_u32 s85, s85, s3
  s_add_u32 s85, s85, 2097152
  s_lshl_b32 s62, s25, 2
  s_add_u32 s62, s62, 0
  s_mul_i32 s63, s62, 147
  s_lshr_b32 s63, s63, 10
  s_mul_i32 s63, s63, 9
  s_add_u32 s62, s62, s63
  s_lshl_b32 s62, s62, 10
  s_add_u32 s84, s62, s85
  s_lshl_b32 s62, s25, 2
  s_add_u32 s62, s62, 1
  s_mul_i32 s63, s62, 147
  s_lshr_b32 s63, s63, 10
  s_mul_i32 s63, s63, 9
  s_add_u32 s62, s62, s63
  s_lshl_b32 s62, s62, 10
  s_add_u32 s89, s62, s85
  s_lshl_b32 s62, s25, 2
  s_add_u32 s62, s62, 2
  s_mul_i32 s63, s62, 147
  s_lshr_b32 s63, s63, 10
  s_mul_i32 s63, s63, 9
  s_add_u32 s62, s62, s63
  s_lshl_b32 s62, s62, 10
  s_add_u32 s92, s62, s85
  s_lshl_b32 s62, s25, 2
  s_add_u32 s62, s62, 3
  s_mul_i32 s63, s62, 147
  s_lshr_b32 s63, s63, 10
  s_mul_i32 s63, s63, 9
  s_add_u32 s62, s62, s63
  s_lshl_b32 s62, s62, 10
  s_add_u32 s93, s62, s85
  s_sub_u32 s62, s89, s84
  s_sub_u32 s62, s62, 1024
  v_mad_u32_u24 v16, v7, s62, v13
  s_sub_u32 s62, s93, s92
  s_sub_u32 s62, s62, 1024
  v_mad_u32_u24 v11, v7, s62, v13
  s_lshl_b32 s28, s24, 5
  s_and_b32 s62, s28, 127
  s_and_b32 s33, s62, 63
  s_lshl_b32 s33, s33, 7
  s_lshr_b32 s63, s62, 6
  s_lshl_b32 s63, s63, 14
  s_add_u32 s33, s33, s63
  s_xor_b32 s63, s94, 0x2000
  s_add_u32 s33, s33, s63
  s_add_u32 s33, s33, s95
  s_add_u32 s33, s33, 65536
  v_lshl_add_u32 v2, v1, 7, s33
  s_and_b32 s28, s5, 1
  s_lshl_b32 s28, s28, 8
  s_bfe_u32 s31, s5, 0x10001
  s_lshl_b32 s31, s31, 10
  s_add_u32 s28, s28, s31
  v_lshlrev_b32 v14, 4, v1
  v_xor_b32 v14, s28, v14
  v_xor_b32 v15, 1024, v14
  s_mul_i32 s28, s5, 14
  s_and_b32 s32, s7, 7
  s_mul_i32 s32, s32, 112
  s_add_u32 s32, s32, s28
  s_lshl_b32 s32, s32, 11
  s_add_u32 s32, s32, 24117248
  s_waitcnt vmcnt(0) lgkmcnt(0)
  s_barrier
  s_mov_b64 exec, -1
  ds_write_b128 v226, v[192:195] offset:0
  ds_write_b128 v226, v[196:199] offset:1024
  ds_write_b128 v226, v[200:203] offset:8192
  ds_write_b128 v226, v[204:207] offset:9216
  s_cmp_lg_u32 s5, 7
  s_cbranch_scc1 L_mffn_wait
  s_mov_b32 exec_hi, 0
  s_mov_b32 s33, 0
  s_sleep 2
L_mffn_poll:
  buffer_load_dwordx2 v[4:5], v2, s[8:11], 0 offen sc1
  s_waitcnt vmcnt(0)
  v_cmp_ne_u64 vcc, s[76:77], v[4:5]
  s_add_u32 s33, s33, 1
  s_cbranch_vccz L_mffn_polled
  s_sleep 1
  s_cmp_lt_u32 s33, 16384
  s_cbranch_scc1 L_mffn_poll
L_mffn_polled:
  s_mov_b64 exec, -1
L_mffn_wait:
  s_waitcnt lgkmcnt(0)
  s_barrier
  s_setprio 1
  ds_read_b64_tr_b16 v[228:229], v225 offset:49152
  ds_read_b64_tr_b16 v[230:231], v225 offset:51200
  ds_read_b64_tr_b16 v[232:233], v225 offset:53248
  ds_read_b64_tr_b16 v[234:235], v225 offset:55296
  ds_read_b64_tr_b16 v[236:237], v225 offset:57344
  ds_read_b64_tr_b16 v[238:239], v225 offset:59392
  ds_read_b64_tr_b16 v[240:241], v225 offset:61440
  ds_read_b64_tr_b16 v[242:243], v225 offset:63488
  s_waitcnt lgkmcnt(6)
  v_mfma_f32_16x16x32_bf16 v[212:215], v[208:211], v[228:231], v[212:215]
  s_waitcnt lgkmcnt(4)
  v_mfma_f32_16x16x32_bf16 v[212:215], v[208:211], v[232:235], v[212:215]
  s_waitcnt lgkmcnt(2)
  v_mfma_f32_16x16x32_bf16 v[212:215], v[208:211], v[236:239], v[212:215]
  s_waitcnt lgkmcnt(0)
  v_mfma_f32_16x16x32_bf16 v[212:215], v[208:211], v[240:243], v[212:215]
  s_nop 15
  v_cvt_pk_bf16_f32 v2, v212, v212
  v_and_b32 v3, 0xffff0000, v2
  v_sub_f32 v3, v212, v3
  v_cvt_pk_bf16_f32 v3, v3, v3
  s_and_b32 s28, s5, 3
  s_lshl_b32 s28, s28, 8
  v_add_u32 v4, s28, v10
  ds_write_b64 v4, v[2:3]
  v_mov_b32 v5, 0
  v_lshlrev_b32 v6, 2, v1
  v_add_u32 v6, 132096, v6
  ds_write_b32 v6, v5
  s_lshl_b32 s28, s5, 2
  s_add_u32 s28, s28, 132080
  v_mov_b32 v9, s28
  s_add_u32 s34, s29, 0
  buffer_load_dwordx4 v[128:131], v13, s[8:11], s34 offen offset:0
  buffer_load_dwordx4 v[132:135], v13, s[8:11], s34 offen offset:256
  buffer_load_dwordx4 v[136:139], v13, s[8:11], s34 offen offset:2048
  buffer_load_dwordx4 v[140:143], v13, s[8:11], s34 offen offset:2304
  s_add_u32 s34, s29, 4096
  buffer_load_dwordx4 v[144:147], v13, s[8:11], s34 offen offset:0
  buffer_load_dwordx4 v[148:151], v13, s[8:11], s34 offen offset:256
  s_waitcnt lgkmcnt(0)
  s_barrier
  ds_read_b64_tr_b16 v[32:33], v18 offset:0
  ds_read_b64_tr_b16 v[34:35], v18 offset:2048
  ds_read_b64_tr_b16 v[36:37], v19 offset:0
  ds_read_b64_tr_b16 v[38:39], v19 offset:2048
  ds_read_b64_tr_b16 v[40:41], v20 offset:0
  ds_read_b64_tr_b16 v[42:43], v20 offset:2048
  ds_read_b64_tr_b16 v[44:45], v21 offset:0
  ds_read_b64_tr_b16 v[46:47], v21 offset:2048
  s_waitcnt vmcnt(5)
  s_waitcnt lgkmcnt(6)
  v_mfma_f32_16x16x32_bf16 v[64:67], v[32:35], v[128:131], 0
  ds_read_b64_tr_b16 v[48:49], v18 offset:1024
  s_waitcnt vmcnt(4)
  v_mfma_f32_16x16x32_bf16 v[72:75], v[32:35], v[132:135], 0
  ds_read_b64_tr_b16 v[50:51], v18 offset:3072
  s_waitcnt lgkmcnt(6)
  v_mfma_f32_16x16x32_bf16 v[68:71], v[36:39], v[128:131], 0
  ds_read_b64_tr_b16 v[52:53], v19 offset:1024
  v_mfma_f32_16x16x32_bf16 v[76:79], v[36:39], v[132:135], 0
  ds_read_b64_tr_b16 v[54:55], v19 offset:3072
  buffer_load_dwordx4 v[152:155], v13, s[8:11], s34 offen offset:2048
  s_waitcnt lgkmcnt(6)
  v_mfma_f32_16x16x32_bf16 v[80:83], v[40:43], v[128:131], 0
  ds_read_b64_tr_b16 v[56:57], v20 offset:1024
  v_mfma_f32_16x16x32_bf16 v[88:91], v[40:43], v[132:135], 0
  ds_read_b64_tr_b16 v[58:59], v20 offset:3072
  s_waitcnt lgkmcnt(6)
  v_mfma_f32_16x16x32_bf16 v[84:87], v[44:47], v[128:131], 0
  ds_read_b64_tr_b16 v[60:61], v21 offset:1024
  v_mfma_f32_16x16x32_bf16 v[92:95], v[44:47], v[132:135], 0
  ds_read_b64_tr_b16 v[62:63], v21 offset:3072
  buffer_load_dwordx4 v[156:159], v13, s[8:11], s34 offen offset:2304
  s_waitcnt lgkmcnt(6)
  v_mfma_f32_16x16x32_bf16 v[96:99], v[48:51], v[128:131], 0
  ds_read_b64_tr_b16 v[32:33], v18 offset:8192
  v_mfma_f32_16x16x32_bf16 v[104:107], v[48:51], v[132:135], 0
  ds_read_b64_tr_b16 v[34:35], v18 offset:10240
  s_waitcnt lgkmcnt(6)
  v_mfma_f32_16x16x32_bf16 v[100:103], v[52:55], v[128:131], 0
  ds_read_b64_tr_b16 v[36:37], v19 offset:8192
  v_mfma_f32_16x16x32_bf16 v[108:111], v[52:55], v[132:135], 0
  ds_read_b64_tr_b16 v[38:39], v19 offset:10240
  s_add_u32 s34, s29, 16384
  buffer_load_dwordx4 v[160:163], v13, s[8:11], s34 offen offset:0
  s_waitcnt lgkmcnt(6)
  v_mfma_f32_16x16x32_bf16 v[112:115], v[56:59], v[128:131], 0
  ds_read_b64_tr_b16 v[40:41], v20 offset:8192
  v_mfma_f32_16x16x32_bf16 v[120:123], v[56:59], v[132:135], 0
  ds_read_b64_tr_b16 v[42:43], v20 offset:10240
  s_waitcnt lgkmcnt(6)
  v_mfma_f32_16x16x32_bf16 v[116:119], v[60:63], v[128:131], 0
  ds_read_b64_tr_b16 v[44:45], v21 offset:8192
  v_mfma_f32_16x16x32_bf16 v[124:127], v[60:63], v[132:135], 0
  ds_read_b64_tr_b16 v[46:47], v21 offset:10240
  buffer_load_dwordx4 v[164:167], v13, s[8:11], s34 offen offset:256
  s_waitcnt lgkmcnt(6)
  s_waitcnt vmcnt(7)
  v_mfma_f32_16x16x32_bf16 v[64:67], v[32:35], v[136:139], v[64:67]
  ds_read_b64_tr_b16 v[48:49], v18 offset:9216
  s_waitcnt vmcnt(6)
  v_mfma_f32_16x16x32_bf16 v[72:75], v[32:35], v[140:143], v[72:75]
  ds_read_b64_tr_b16 v[50:51], v18 offset:11264
  s_waitcnt lgkmcnt(6)
  v_mfma_f32_16x16x32_bf16 v[68:71], v[36:39], v[136:139], v[68:71]
  ds_read_b64_tr_b16 v[52:53], v19 offset:9216
  v_mfma_f32_16x16x32_bf16 v[76:79], v[36:39], v[140:143], v[76:79]
  ds_read_b64_tr_b16 v[54:55], v19 offset:11264
  buffer_load_dwordx4 v[168:171], v13, s[8:11], s34 offen offset:2048
  s_waitcnt lgkmcnt(6)
  v_mfma_f32_16x16x32_bf16 v[80:83], v[40:43], v[136:139], v[80:83]
  ds_read_b64_tr_b16 v[56:57], v20 offset:9216
  v_mfma_f32_16x16x32_bf16 v[88:91], v[40:43], v[140:143], v[88:91]
  ds_read_b64_tr_b16 v[58:59], v20 offset:11264
  s_waitcnt lgkmcnt(6)
  v_mfma_f32_16x16x32_bf16 v[84:87], v[44:47], v[136:139], v[84:87]
  ds_read_b64_tr_b16 v[60:61], v21 offset:9216
  v_mfma_f32_16x16x32_bf16 v[92:95], v[44:47], v[140:143], v[92:95]
  ds_read_b64_tr_b16 v[62:63], v21 offset:11264
  buffer_load_dwordx4 v[172:175], v13, s[8:11], s34 offen offset:2304
  s_waitcnt lgkmcnt(6)
  v_mfma_f32_16x16x32_bf16 v[96:99], v[48:51], v[136:139], v[96:99]
  ds_read_b64_tr_b16 v[32:33], v18 offset:16384
  v_mfma_f32_16x16x32_bf16 v[104:107], v[48:51], v[140:143], v[104:107]
  ds_read_b64_tr_b16 v[34:35], v18 offset:18432
  s_waitcnt lgkmcnt(6)
  v_mfma_f32_16x16x32_bf16 v[100:103], v[52:55], v[136:139], v[100:103]
  ds_read_b64_tr_b16 v[36:37], v19 offset:16384
  v_mfma_f32_16x16x32_bf16 v[108:111], v[52:55], v[140:143], v[108:111]
  ds_read_b64_tr_b16 v[38:39], v19 offset:18432
  s_add_u32 s34, s29, 20480
  buffer_load_dwordx4 v[176:179], v13, s[8:11], s34 offen offset:0
  s_waitcnt lgkmcnt(6)
  v_mfma_f32_16x16x32_bf16 v[112:115], v[56:59], v[136:139], v[112:115]
  ds_read_b64_tr_b16 v[40:41], v20 offset:16384
  v_mfma_f32_16x16x32_bf16 v[120:123], v[56:59], v[140:143], v[120:123]
  ds_read_b64_tr_b16 v[42:43], v20 offset:18432
  s_waitcnt lgkmcnt(6)
  v_mfma_f32_16x16x32_bf16 v[116:119], v[60:63], v[136:139], v[116:119]
  ds_read_b64_tr_b16 v[44:45], v21 offset:16384
  v_mfma_f32_16x16x32_bf16 v[124:127], v[60:63], v[140:143], v[124:127]
  ds_read_b64_tr_b16 v[46:47], v21 offset:18432
  buffer_load_dwordx4 v[180:183], v13, s[8:11], s34 offen offset:256
  s_waitcnt lgkmcnt(6)
  s_waitcnt vmcnt(9)
  v_mfma_f32_16x16x32_bf16 v[64:67], v[32:35], v[144:147], v[64:67]
  ds_read_b64_tr_b16 v[48:49], v18 offset:17408
  s_waitcnt vmcnt(8)
  v_mfma_f32_16x16x32_bf16 v[72:75], v[32:35], v[148:151], v[72:75]
  ds_read_b64_tr_b16 v[50:51], v18 offset:19456
  s_waitcnt lgkmcnt(6)
  v_mfma_f32_16x16x32_bf16 v[68:71], v[36:39], v[144:147], v[68:71]
  ds_read_b64_tr_b16 v[52:53], v19 offset:17408
  v_mfma_f32_16x16x32_bf16 v[76:79], v[36:39], v[148:151], v[76:79]
  ds_read_b64_tr_b16 v[54:55], v19 offset:19456
  s_waitcnt lgkmcnt(6)
  v_mfma_f32_16x16x32_bf16 v[80:83], v[40:43], v[144:147], v[80:83]
  ds_read_b64_tr_b16 v[56:57], v20 offset:17408
  v_mfma_f32_16x16x32_bf16 v[88:91], v[40:43], v[148:151], v[88:91]
  ds_read_b64_tr_b16 v[58:59], v20 offset:19456
  s_waitcnt lgkmcnt(6)
  v_mfma_f32_16x16x32_bf16 v[84:87], v[44:47], v[144:147], v[84:87]
  ds_read_b64_tr_b16 v[60:61], v21 offset:17408
  v_mfma_f32_16x16x32_bf16 v[92:95], v[44:47], v[148:151], v[92:95]
  ds_read_b64_tr_b16 v[62:63], v21 offset:19456
  buffer_load_dwordx4 v[184:187], v13, s[8:11], s34 offen offset:2048
  s_waitcnt lgkmcnt(6)
  v_mfma_f32_16x16x32_bf16 v[96:99], v[48:51], v[144:147], v[96:99]
  ds_read_b64_tr_b16 v[32:33], v18 offset:24576
  v_mfma_f32_16x16x32_bf16 v[104:107], v[48:51], v[148:151], v[104:107]
  ds_read_b64_tr_b16 v[34:35], v18 offset:26624
  s_waitcnt lgkmcnt(6)
  v_mfma_f32_16x16x32_bf16 v[100:103], v[52:55], v[144:147], v[100:103]
  ds_read_b64_tr_b16 v[36:37], v19 offset:24576
  v_mfma_f32_16x16x32_bf16 v[108:111], v[52:55], v[148:151], v[108:111]
  ds_read_b64_tr_b16 v[38:39], v19 offset:26624
  s_waitcnt lgkmcnt(6)
  v_mfma_f32_16x16x32_bf16 v[112:115], v[56:59], v[144:147], v[112:115]
  ds_read_b64_tr_b16 v[40:41], v20 offset:24576
  v_mfma_f32_16x16x32_bf16 v[120:123], v[56:59], v[148:151], v[120:123]
  ds_read_b64_tr_b16 v[42:43], v20 offset:26624
  s_waitcnt lgkmcnt(6)
  v_mfma_f32_16x16x32_bf16 v[116:119], v[60:63], v[144:147], v[116:119]
  ds_read_b64_tr_b16 v[44:45], v21 offset:24576
  v_mfma_f32_16x16x32_bf16 v[124:127], v[60:63], v[148:151], v[124:127]
  ds_read_b64_tr_b16 v[46:47], v21 offset:26624
  buffer_load_dwordx4 v[188:191], v13, s[8:11], s34 offen offset:2304
  s_waitcnt lgkmcnt(6)
  s_waitcnt vmcnt(9)
  v_mfma_f32_16x16x32_bf16 v[64:67], v[32:35], v[152:155], v[64:67]
  ds_read_b64_tr_b16 v[48:49], v18 offset:25600
  s_waitcnt vmcnt(8)
  v_mfma_f32_16x16x32_bf16 v[72:75], v[32:35], v[156:159], v[72:75]
  ds_read_b64_tr_b16 v[50:51], v18 offset:27648
  s_waitcnt lgkmcnt(6)
  v_mfma_f32_16x16x32_bf16 v[68:71], v[36:39], v[152:155], v[68:71]
  ds_read_b64_tr_b16 v[52:53], v19 offset:25600
  v_mfma_f32_16x16x32_bf16 v[76:79], v[36:39], v[156:159], v[76:79]
  ds_read_b64_tr_b16 v[54:55], v19 offset:27648
  s_waitcnt lgkmcnt(6)
  v_mfma_f32_16x16x32_bf16 v[80:83], v[40:43], v[152:155], v[80:83]
  ds_read_b64_tr_b16 v[56:57], v20 offset:25600
  v_mfma_f32_16x16x32_bf16 v[88:91], v[40:43], v[156:159], v[88:91]
  ds_read_b64_tr_b16 v[58:59], v20 offset:27648
  s_waitcnt lgkmcnt(6)
  v_mfma_f32_16x16x32_bf16 v[84:87], v[44:47], v[152:155], v[84:87]
  ds_read_b64_tr_b16 v[60:61], v21 offset:25600
  v_mfma_f32_16x16x32_bf16 v[92:95], v[44:47], v[156:159], v[92:95]
  ds_read_b64_tr_b16 v[62:63], v21 offset:27648
  s_add_u32 s34, s29, 32768
  buffer_load_dwordx4 v[192:195], v13, s[8:11], s34 offen offset:0
  s_waitcnt lgkmcnt(6)
  v_mfma_f32_16x16x32_bf16 v[96:99], v[48:51], v[152:155], v[96:99]
  ds_read_b64_tr_b16 v[32:33], v18 offset:32768
  v_mfma_f32_16x16x32_bf16 v[104:107], v[48:51], v[156:159], v[104:107]
  ds_read_b64_tr_b16 v[34:35], v18 offset:34816
  s_waitcnt lgkmcnt(6)
  v_mfma_f32_16x16x32_bf16 v[100:103], v[52:55], v[152:155], v[100:103]
  ds_read_b64_tr_b16 v[36:37], v19 offset:32768
  v_mfma_f32_16x16x32_bf16 v[108:111], v[52:55], v[156:159], v[108:111]
  ds_read_b64_tr_b16 v[38:39], v19 offset:34816
  s_waitcnt lgkmcnt(6)
  v_mfma_f32_16x16x32_bf16 v[112:115], v[56:59], v[152:155], v[112:115]
  ds_read_b64_tr_b16 v[40:41], v20 offset:32768
  v_mfma_f32_16x16x32_bf16 v[120:123], v[56:59], v[156:159], v[120:123]
  ds_read_b64_tr_b16 v[42:43], v20 offset:34816
  s_waitcnt lgkmcnt(6)
  v_mfma_f32_16x16x32_bf16 v[116:119], v[60:63], v[152:155], v[116:119]
  ds_read_b64_tr_b16 v[44:45], v21 offset:32768
  v_mfma_f32_16x16x32_bf16 v[124:127], v[60:63], v[156:159], v[124:127]
  ds_read_b64_tr_b16 v[46:47], v21 offset:34816
  buffer_load_dwordx4 v[196:199], v13, s[8:11], s34 offen offset:256
  s_waitcnt lgkmcnt(6)
  s_waitcnt vmcnt(9)
  v_mfma_f32_16x16x32_bf16 v[64:67], v[32:35], v[160:163], v[64:67]
  ds_read_b64_tr_b16 v[48:49], v18 offset:33792
  s_waitcnt vmcnt(8)
  v_mfma_f32_16x16x32_bf16 v[72:75], v[32:35], v[164:167], v[72:75]
  ds_read_b64_tr_b16 v[50:51], v18 offset:35840
  s_waitcnt lgkmcnt(6)
  v_mfma_f32_16x16x32_bf16 v[68:71], v[36:39], v[160:163], v[68:71]
  ds_read_b64_tr_b16 v[52:53], v19 offset:33792
  v_mfma_f32_16x16x32_bf16 v[76:79], v[36:39], v[164:167], v[76:79]
  ds_read_b64_tr_b16 v[54:55], v19 offset:35840
  s_waitcnt lgkmcnt(6)
  v_mfma_f32_16x16x32_bf16 v[80:83], v[40:43], v[160:163], v[80:83]
  ds_read_b64_tr_b16 v[56:57], v20 offset:33792
  v_mfma_f32_16x16x32_bf16 v[88:91], v[40:43], v[164:167], v[88:91]
  ds_read_b64_tr_b16 v[58:59], v20 offset:35840
  s_waitcnt lgkmcnt(6)
  v_mfma_f32_16x16x32_bf16 v[84:87], v[44:47], v[160:163], v[84:87]
  ds_read_b64_tr_b16 v[60:61], v21 offset:33792
  v_mfma_f32_16x16x32_bf16 v[92:95], v[44:47], v[164:167], v[92:95]
  ds_read_b64_tr_b16 v[62:63], v21 offset:35840
  buffer_load_dwordx4 v[200:203], v13, s[8:11], s34 offen offset:2048
  s_waitcnt lgkmcnt(6)
  v_mfma_f32_16x16x32_bf16 v[96:99], v[48:51], v[160:163], v[96:99]
  ds_read_b64_tr_b16 v[32:33], v18 offset:40960
  v_mfma_f32_16x16x32_bf16 v[104:107], v[48:51], v[164:167], v[104:107]
  ds_read_b64_tr_b16 v[34:35], v18 offset:43008
  s_waitcnt lgkmcnt(6)
  v_mfma_f32_16x16x32_bf16 v[100:103], v[52:55], v[160:163], v[100:103]
  ds_read_b64_tr_b16 v[36:37], v19 offset:40960
  v_mfma_f32_16x16x32_bf16 v[108:111], v[52:55], v[164:167], v[108:111]
  ds_read_b64_tr_b16 v[38:39], v19 offset:43008
  s_waitcnt lgkmcnt(6)
  v_mfma_f32_16x16x32_bf16 v[112:115], v[56:59], v[160:163], v[112:115]
  ds_read_b64_tr_b16 v[40:41], v20 offset:40960
  v_mfma_f32_16x16x32_bf16 v[120:123], v[56:59], v[164:167], v[120:123]
  ds_read_b64_tr_b16 v[42:43], v20 offset:43008
  s_waitcnt lgkmcnt(6)
  v_mfma_f32_16x16x32_bf16 v[116:119], v[60:63], v[160:163], v[116:119]
  ds_read_b64_tr_b16 v[44:45], v21 offset:40960
  v_mfma_f32_16x16x32_bf16 v[124:127], v[60:63], v[164:167], v[124:127]
  ds_read_b64_tr_b16 v[46:47], v21 offset:43008
  buffer_load_dwordx4 v[204:207], v13, s[8:11], s34 offen offset:2304
  s_waitcnt lgkmcnt(6)
  s_waitcnt vmcnt(9)
  v_mfma_f32_16x16x32_bf16 v[64:67], v[32:35], v[168:171], v[64:67]
  ds_read_b64_tr_b16 v[48:49], v18 offset:41984
  s_waitcnt vmcnt(8)
  v_mfma_f32_16x16x32_bf16 v[72:75], v[32:35], v[172:175], v[72:75]
  ds_read_b64_tr_b16 v[50:51], v18 offset:44032
  s_waitcnt lgkmcnt(6)
  v_mfma_f32_16x16x32_bf16 v[68:71], v[36:39], v[168:171], v[68:71]
  ds_read_b64_tr_b16 v[52:53], v19 offset:41984
  v_mfma_f32_16x16x32_bf16 v[76:79], v[36:39], v[172:175], v[76:79]
  ds_read_b64_tr_b16 v[54:55], v19 offset:44032
  s_waitcnt lgkmcnt(6)
  v_mfma_f32_16x16x32_bf16 v[80:83], v[40:43], v[168:171], v[80:83]
  ds_read_b64_tr_b16 v[56:57], v20 offset:41984
  v_mfma_f32_16x16x32_bf16 v[88:91], v[40:43], v[172:175], v[88:91]
  ds_read_b64_tr_b16 v[58:59], v20 offset:44032
  s_waitcnt lgkmcnt(6)
  v_mfma_f32_16x16x32_bf16 v[84:87], v[44:47], v[168:171], v[84:87]
  ds_read_b64_tr_b16 v[60:61], v21 offset:41984
  v_mfma_f32_16x16x32_bf16 v[92:95], v[44:47], v[172:175], v[92:95]
  ds_read_b64_tr_b16 v[62:63], v21 offset:44032
  s_add_u32 s34, s29, 36864
  buffer_load_dwordx4 v[208:211], v13, s[8:11], s34 offen offset:0
  s_waitcnt lgkmcnt(6)
  v_mfma_f32_16x16x32_bf16 v[96:99], v[48:51], v[168:171], v[96:99]
  ds_read_b64_tr_b16 v[32:33], v18 offset:49152
  v_mfma_f32_16x16x32_bf16 v[104:107], v[48:51], v[172:175], v[104:107]
  ds_read_b64_tr_b16 v[34:35], v18 offset:51200
  s_waitcnt lgkmcnt(6)
  v_mfma_f32_16x16x32_bf16 v[100:103], v[52:55], v[168:171], v[100:103]
  ds_read_b64_tr_b16 v[36:37], v19 offset:49152
  v_mfma_f32_16x16x32_bf16 v[108:111], v[52:55], v[172:175], v[108:111]
  ds_read_b64_tr_b16 v[38:39], v19 offset:51200
  s_waitcnt lgkmcnt(6)
  v_mfma_f32_16x16x32_bf16 v[112:115], v[56:59], v[168:171], v[112:115]
  ds_read_b64_tr_b16 v[40:41], v20 offset:49152
  v_mfma_f32_16x16x32_bf16 v[120:123], v[56:59], v[172:175], v[120:123]
  ds_read_b64_tr_b16 v[42:43], v20 offset:51200
  s_waitcnt lgkmcnt(6)
  v_mfma_f32_16x16x32_bf16 v[116:119], v[60:63], v[168:171], v[116:119]
  ds_read_b64_tr_b16 v[44:45], v21 offset:49152
  v_mfma_f32_16x16x32_bf16 v[124:127], v[60:63], v[172:175], v[124:127]
  ds_read_b64_tr_b16 v[46:47], v21 offset:51200
  buffer_load_dwordx4 v[212:215], v13, s[8:11], s34 offen offset:256
  s_waitcnt lgkmcnt(6)
  s_waitcnt vmcnt(9)
  v_mfma_f32_16x16x32_bf16 v[64:67], v[32:35], v[176:179], v[64:67]
  ds_read_b64_tr_b16 v[48:49], v18 offset:50176
  s_waitcnt vmcnt(8)
  v_mfma_f32_16x16x32_bf16 v[72:75], v[32:35], v[180:183], v[72:75]
  ds_read_b64_tr_b16 v[50:51], v18 offset:52224
  s_waitcnt lgkmcnt(6)
  v_mfma_f32_16x16x32_bf16 v[68:71], v[36:39], v[176:179], v[68:71]
  ds_read_b64_tr_b16 v[52:53], v19 offset:50176
  v_mfma_f32_16x16x32_bf16 v[76:79], v[36:39], v[180:183], v[76:79]
  ds_read_b64_tr_b16 v[54:55], v19 offset:52224
  s_waitcnt lgkmcnt(6)
  v_mfma_f32_16x16x32_bf16 v[80:83], v[40:43], v[176:179], v[80:83]
  ds_read_b64_tr_b16 v[56:57], v20 offset:50176
  v_mfma_f32_16x16x32_bf16 v[88:91], v[40:43], v[180:183], v[88:91]
  ds_read_b64_tr_b16 v[58:59], v20 offset:52224
  s_waitcnt lgkmcnt(6)
  v_mfma_f32_16x16x32_bf16 v[84:87], v[44:47], v[176:179], v[84:87]
  ds_read_b64_tr_b16 v[60:61], v21 offset:50176
  v_mfma_f32_16x16x32_bf16 v[92:95], v[44:47], v[180:183], v[92:95]
  ds_read_b64_tr_b16 v[62:63], v21 offset:52224
  buffer_load_dwordx4 v[216:219], v13, s[8:11], s34 offen offset:2048
  s_waitcnt lgkmcnt(6)
  v_mfma_f32_16x16x32_bf16 v[96:99], v[48:51], v[176:179], v[96:99]
  ds_read_b64_tr_b16 v[32:33], v18 offset:57344
  v_mfma_f32_16x16x32_bf16 v[104:107], v[48:51], v[180:183], v[104:107]
  ds_read_b64_tr_b16 v[34:35], v18 offset:59392
  s_waitcnt lgkmcnt(6)
  v_mfma_f32_16x16x32_bf16 v[100:103], v[52:55], v[176:179], v[100:103]
  ds_read_b64_tr_b16 v[36:37], v19 offset:57344
  v_mfma_f32_16x16x32_bf16 v[108:111], v[52:55], v[180:183], v[108:111]
  ds_read_b64_tr_b16 v[38:39], v19 offset:59392
  s_waitcnt lgkmcnt(6)
  v_mfma_f32_16x16x32_bf16 v[112:115], v[56:59], v[176:179], v[112:115]
  ds_read_b64_tr_b16 v[40:41], v20 offset:57344
  v_mfma_f32_16x16x32_bf16 v[120:123], v[56:59], v[180:183], v[120:123]
  ds_read_b64_tr_b16 v[42:43], v20 offset:59392
  s_waitcnt lgkmcnt(6)
  v_mfma_f32_16x16x32_bf16 v[116:119], v[60:63], v[176:179], v[116:119]
  ds_read_b64_tr_b16 v[44:45], v21 offset:57344
  v_mfma_f32_16x16x32_bf16 v[124:127], v[60:63], v[180:183], v[124:127]
  ds_read_b64_tr_b16 v[46:47], v21 offset:59392
  buffer_load_dwordx4 v[220:223], v13, s[8:11], s34 offen offset:2304
  s_waitcnt lgkmcnt(6)
  s_waitcnt vmcnt(9)
  v_mfma_f32_16x16x32_bf16 v[64:67], v[32:35], v[184:187], v[64:67]
  ds_read_b64_tr_b16 v[48:49], v18 offset:58368
  s_add_u32 s34, s29, 49152
  buffer_load_dwordx4 v[224:227], v13, s[8:11], s34 offen offset:0
  s_waitcnt vmcnt(9)
  v_mfma_f32_16x16x32_bf16 v[72:75], v[32:35], v[188:191], v[72:75]
  ds_read_b64_tr_b16 v[50:51], v18 offset:60416
  buffer_load_dwordx2 v[128:129], v12, s[8:11], s30 offen offset:0
  s_waitcnt lgkmcnt(6)
  v_mfma_f32_16x16x32_bf16 v[68:71], v[36:39], v[184:187], v[68:71]
  ds_read_b64_tr_b16 v[52:53], v19 offset:58368
  buffer_load_dwordx2 v[130:131], v12, s[8:11], s30 offen offset:256
  v_mfma_f32_16x16x32_bf16 v[76:79], v[36:39], v[188:191], v[76:79]
  ds_read_b64_tr_b16 v[54:55], v19 offset:60416
  buffer_load_dwordx2 v[132:133], v12, s[8:11], s30 offen offset:512
  s_waitcnt lgkmcnt(6)
  v_mfma_f32_16x16x32_bf16 v[80:83], v[40:43], v[184:187], v[80:83]
  ds_read_b64_tr_b16 v[56:57], v20 offset:58368
  buffer_load_dwordx2 v[134:135], v12, s[8:11], s30 offen offset:768
  v_mfma_f32_16x16x32_bf16 v[88:91], v[40:43], v[188:191], v[88:91]
  ds_read_b64_tr_b16 v[58:59], v20 offset:60416
  buffer_load_dwordx2 v[136:137], v12, s[8:11], s30 offen offset:1024
  s_waitcnt lgkmcnt(6)
  v_mfma_f32_16x16x32_bf16 v[84:87], v[44:47], v[184:187], v[84:87]
  ds_read_b64_tr_b16 v[60:61], v21 offset:58368
  buffer_load_dwordx2 v[138:139], v12, s[8:11], s30 offen offset:1280
  v_mfma_f32_16x16x32_bf16 v[92:95], v[44:47], v[188:191], v[92:95]
  ds_read_b64_tr_b16 v[62:63], v21 offset:60416
  buffer_load_dwordx2 v[140:141], v12, s[8:11], s30 offen offset:1536
  buffer_load_dwordx2 v[142:143], v12, s[8:11], s30 offen offset:1792
  v_add_u32 v18, 65536, v18
  v_add_u32 v19, 65536, v19
  v_add_u32 v20, 65536, v20
  v_add_u32 v21, 65536, v21
  s_waitcnt lgkmcnt(6)
  v_mfma_f32_16x16x32_bf16 v[96:99], v[48:51], v[184:187], v[96:99]
  ds_read_b64_tr_b16 v[32:33], v18 offset:0
  v_mfma_f32_16x16x32_bf16 v[104:107], v[48:51], v[188:191], v[104:107]
  ds_read_b64_tr_b16 v[34:35], v18 offset:2048
  s_waitcnt lgkmcnt(6)
  v_mfma_f32_16x16x32_bf16 v[100:103], v[52:55], v[184:187], v[100:103]
  ds_read_b64_tr_b16 v[36:37], v19 offset:0
  v_mfma_f32_16x16x32_bf16 v[108:111], v[52:55], v[188:191], v[108:111]
  ds_read_b64_tr_b16 v[38:39], v19 offset:2048
  s_waitcnt lgkmcnt(6)
  v_mfma_f32_16x16x32_bf16 v[112:115], v[56:59], v[184:187], v[112:115]
  ds_read_b64_tr_b16 v[40:41], v20 offset:0
  v_mfma_f32_16x16x32_bf16 v[120:123], v[56:59], v[188:191], v[120:123]
  ds_read_b64_tr_b16 v[42:43], v20 offset:2048
  s_waitcnt lgkmcnt(6)
  v_mfma_f32_16x16x32_bf16 v[116:119], v[60:63], v[184:187], v[116:119]
  ds_read_b64_tr_b16 v[44:45], v21 offset:0
  v_mfma_f32_16x16x32_bf16 v[124:127], v[60:63], v[188:191], v[124:127]
  ds_read_b64_tr_b16 v[46:47], v21 offset:2048
  buffer_load_dwordx4 v[228:231], v13, s[8:11], s34 offen offset:256
  ds_write_b32 v9, v9 offset:32
  s_waitcnt lgkmcnt(7)
  s_waitcnt vmcnt(17)
  v_mfma_f32_16x16x32_bf16 v[64:67], v[32:35], v[192:195], v[64:67]
  ds_read_b64_tr_b16 v[48:49], v18 offset:1024
  s_waitcnt vmcnt(16)
  v_mfma_f32_16x16x32_bf16 v[72:75], v[32:35], v[196:199], v[72:75]
  ds_read_b64_tr_b16 v[50:51], v18 offset:3072
  s_waitcnt lgkmcnt(7)
  v_mfma_f32_16x16x32_bf16 v[68:71], v[36:39], v[192:195], v[68:71]
  ds_read_b64_tr_b16 v[52:53], v19 offset:1024
  v_mfma_f32_16x16x32_bf16 v[76:79], v[36:39], v[196:199], v[76:79]
  ds_read_b64_tr_b16 v[54:55], v19 offset:3072
  s_waitcnt lgkmcnt(7)
  v_mfma_f32_16x16x32_bf16 v[80:83], v[40:43], v[192:195], v[80:83]
  ds_read_b64_tr_b16 v[56:57], v20 offset:1024
  v_mfma_f32_16x16x32_bf16 v[88:91], v[40:43], v[196:199], v[88:91]
  ds_read_b64_tr_b16 v[58:59], v20 offset:3072
  s_waitcnt lgkmcnt(7)
  v_mfma_f32_16x16x32_bf16 v[84:87], v[44:47], v[192:195], v[84:87]
  ds_read_b64_tr_b16 v[60:61], v21 offset:1024
  v_mfma_f32_16x16x32_bf16 v[92:95], v[44:47], v[196:199], v[92:95]
  ds_read_b64_tr_b16 v[62:63], v21 offset:3072
  buffer_load_dwordx4 v[232:235], v13, s[8:11], s34 offen offset:2048
  s_waitcnt lgkmcnt(6)
  v_mfma_f32_16x16x32_bf16 v[96:99], v[48:51], v[192:195], v[96:99]
  ds_read_b64_tr_b16 v[32:33], v18 offset:8192
  v_mfma_f32_16x16x32_bf16 v[104:107], v[48:51], v[196:199], v[104:107]
  ds_read_b64_tr_b16 v[34:35], v18 offset:10240
  s_waitcnt lgkmcnt(6)
  v_mfma_f32_16x16x32_bf16 v[100:103], v[52:55], v[192:195], v[100:103]
  ds_read_b64_tr_b16 v[36:37], v19 offset:8192
  v_mfma_f32_16x16x32_bf16 v[108:111], v[52:55], v[196:199], v[108:111]
  ds_read_b64_tr_b16 v[38:39], v19 offset:10240
  s_waitcnt lgkmcnt(6)
  v_mfma_f32_16x16x32_bf16 v[112:115], v[56:59], v[192:195], v[112:115]
  ds_read_b64_tr_b16 v[40:41], v20 offset:8192
  v_mfma_f32_16x16x32_bf16 v[120:123], v[56:59], v[196:199], v[120:123]
  ds_read_b64_tr_b16 v[42:43], v20 offset:10240
  s_waitcnt lgkmcnt(6)
  v_mfma_f32_16x16x32_bf16 v[116:119], v[60:63], v[192:195], v[116:119]
  ds_read_b64_tr_b16 v[44:45], v21 offset:8192
  v_mfma_f32_16x16x32_bf16 v[124:127], v[60:63], v[196:199], v[124:127]
  ds_read_b64_tr_b16 v[46:47], v21 offset:10240
  buffer_load_dwordx4 v[236:239], v13, s[8:11], s34 offen offset:2304
  s_waitcnt lgkmcnt(6)
  s_waitcnt vmcnt(17)
  v_mfma_f32_16x16x32_bf16 v[64:67], v[32:35], v[200:203], v[64:67]
  ds_read_b64_tr_b16 v[48:49], v18 offset:9216
  s_waitcnt vmcnt(16)
  v_mfma_f32_16x16x32_bf16 v[72:75], v[32:35], v[204:207], v[72:75]
  ds_read_b64_tr_b16 v[50:51], v18 offset:11264
  s_waitcnt lgkmcnt(6)
  v_mfma_f32_16x16x32_bf16 v[68:71], v[36:39], v[200:203], v[68:71]
  ds_read_b64_tr_b16 v[52:53], v19 offset:9216
  v_mfma_f32_16x16x32_bf16 v[76:79], v[36:39], v[204:207], v[76:79]
  ds_read_b64_tr_b16 v[54:55], v19 offset:11264
  s_waitcnt lgkmcnt(6)
  v_mfma_f32_16x16x32_bf16 v[80:83], v[40:43], v[200:203], v[80:83]
  ds_read_b64_tr_b16 v[56:57], v20 offset:9216
  v_mfma_f32_16x16x32_bf16 v[88:91], v[40:43], v[204:207], v[88:91]
  ds_read_b64_tr_b16 v[58:59], v20 offset:11264
  s_waitcnt lgkmcnt(6)
  v_mfma_f32_16x16x32_bf16 v[84:87], v[44:47], v[200:203], v[84:87]
  ds_read_b64_tr_b16 v[60:61], v21 offset:9216
  v_mfma_f32_16x16x32_bf16 v[92:95], v[44:47], v[204:207], v[92:95]
  ds_read_b64_tr_b16 v[62:63], v21 offset:11264
  s_add_u32 s34, s29, 53248
  buffer_load_dwordx4 v[240:243], v13, s[8:11], s34 offen offset:0
  s_waitcnt lgkmcnt(6)
  v_mfma_f32_16x16x32_bf16 v[96:99], v[48:51], v[200:203], v[96:99]
  ds_read_b64_tr_b16 v[32:33], v18 offset:16384
  v_mfma_f32_16x16x32_bf16 v[104:107], v[48:51], v[204:207], v[104:107]
  ds_read_b64_tr_b16 v[34:35], v18 offset:18432
  s_waitcnt lgkmcnt(6)
  v_mfma_f32_16x16x32_bf16 v[100:103], v[52:55], v[200:203], v[100:103]
  ds_read_b64_tr_b16 v[36:37], v19 offset:16384
  v_mfma_f32_16x16x32_bf16 v[108:111], v[52:55], v[204:207], v[108:111]
  ds_read_b64_tr_b16 v[38:39], v19 offset:18432
  s_waitcnt lgkmcnt(6)
  v_mfma_f32_16x16x32_bf16 v[112:115], v[56:59], v[200:203], v[112:115]
  ds_read_b64_tr_b16 v[40:41], v20 offset:16384
  v_mfma_f32_16x16x32_bf16 v[120:123], v[56:59], v[204:207], v[120:123]
  ds_read_b64_tr_b16 v[42:43], v20 offset:18432
  s_waitcnt lgkmcnt(6)
  v_mfma_f32_16x16x32_bf16 v[116:119], v[60:63], v[200:203], v[116:119]
  ds_read_b64_tr_b16 v[44:45], v21 offset:16384
  v_mfma_f32_16x16x32_bf16 v[124:127], v[60:63], v[204:207], v[124:127]
  ds_read_b64_tr_b16 v[46:47], v21 offset:18432
  buffer_load_dwordx4 v[244:247], v13, s[8:11], s34 offen offset:256
  s_waitcnt lgkmcnt(6)
  s_waitcnt vmcnt(17)
  v_mfma_f32_16x16x32_bf16 v[64:67], v[32:35], v[208:211], v[64:67]
  ds_read_b64_tr_b16 v[48:49], v18 offset:17408
  s_waitcnt vmcnt(16)
  v_mfma_f32_16x16x32_bf16 v[72:75], v[32:35], v[212:215], v[72:75]
  ds_read_b64_tr_b16 v[50:51], v18 offset:19456
  s_waitcnt lgkmcnt(6)
  v_mfma_f32_16x16x32_bf16 v[68:71], v[36:39], v[208:211], v[68:71]
  ds_read_b64_tr_b16 v[52:53], v19 offset:17408
  v_mfma_f32_16x16x32_bf16 v[76:79], v[36:39], v[212:215], v[76:79]
  ds_read_b64_tr_b16 v[54:55], v19 offset:19456
  s_waitcnt lgkmcnt(6)
  v_mfma_f32_16x16x32_bf16 v[80:83], v[40:43], v[208:211], v[80:83]
  ds_read_b64_tr_b16 v[56:57], v20 offset:17408
  v_mfma_f32_16x16x32_bf16 v[88:91], v[40:43], v[212:215], v[88:91]
  ds_read_b64_tr_b16 v[58:59], v20 offset:19456
  s_waitcnt lgkmcnt(6)
  v_mfma_f32_16x16x32_bf16 v[84:87], v[44:47], v[208:211], v[84:87]
  ds_read_b64_tr_b16 v[60:61], v21 offset:17408
  v_mfma_f32_16x16x32_bf16 v[92:95], v[44:47], v[212:215], v[92:95]
  ds_read_b64_tr_b16 v[62:63], v21 offset:19456
  buffer_load_dwordx4 v[248:251], v13, s[8:11], s34 offen offset:2048
  s_waitcnt lgkmcnt(6)
  v_mfma_f32_16x16x32_bf16 v[96:99], v[48:51], v[208:211], v[96:99]
  ds_read_b64_tr_b16 v[32:33], v18 offset:24576
  v_mfma_f32_16x16x32_bf16 v[104:107], v[48:51], v[212:215], v[104:107]
  ds_read_b64_tr_b16 v[34:35], v18 offset:26624
  s_waitcnt lgkmcnt(6)
  v_mfma_f32_16x16x32_bf16 v[100:103], v[52:55], v[208:211], v[100:103]
  ds_read_b64_tr_b16 v[36:37], v19 offset:24576
  v_mfma_f32_16x16x32_bf16 v[108:111], v[52:55], v[212:215], v[108:111]
  ds_read_b64_tr_b16 v[38:39], v19 offset:26624
  s_waitcnt lgkmcnt(6)
  v_mfma_f32_16x16x32_bf16 v[112:115], v[56:59], v[208:211], v[112:115]
  ds_read_b64_tr_b16 v[40:41], v20 offset:24576
  v_mfma_f32_16x16x32_bf16 v[120:123], v[56:59], v[212:215], v[120:123]
  ds_read_b64_tr_b16 v[42:43], v20 offset:26624
  s_waitcnt lgkmcnt(6)
  v_mfma_f32_16x16x32_bf16 v[116:119], v[60:63], v[208:211], v[116:119]
  ds_read_b64_tr_b16 v[44:45], v21 offset:24576
  v_mfma_f32_16x16x32_bf16 v[124:127], v[60:63], v[212:215], v[124:127]
  ds_read_b64_tr_b16 v[46:47], v21 offset:26624
  buffer_load_dwordx4 v[252:255], v13, s[8:11], s34 offen offset:2304
  ds_write_b32 v9, v9
  s_waitcnt lgkmcnt(7)
  s_waitcnt vmcnt(17)
  v_mfma_f32_16x16x32_bf16 v[64:67], v[32:35], v[216:219], v[64:67]
  ds_read_b64_tr_b16 v[48:49], v18 offset:25600
  s_waitcnt vmcnt(16)
  v_mfma_f32_16x16x32_bf16 v[72:75], v[32:35], v[220:223], v[72:75]
  ds_read_b64_tr_b16 v[50:51], v18 offset:27648
  s_waitcnt lgkmcnt(7)
  v_mfma_f32_16x16x32_bf16 v[68:71], v[36:39], v[216:219], v[68:71]
  ds_read_b64_tr_b16 v[52:53], v19 offset:25600
  v_mfma_f32_16x16x32_bf16 v[76:79], v[36:39], v[220:223], v[76:79]
  ds_read_b64_tr_b16 v[54:55], v19 offset:27648
  s_waitcnt lgkmcnt(7)
  v_mfma_f32_16x16x32_bf16 v[80:83], v[40:43], v[216:219], v[80:83]
  ds_read_b64_tr_b16 v[56:57], v20 offset:25600
  v_mfma_f32_16x16x32_bf16 v[88:91], v[40:43], v[220:223], v[88:91]
  ds_read_b64_tr_b16 v[58:59], v20 offset:27648
  s_waitcnt lgkmcnt(7)
  v_mfma_f32_16x16x32_bf16 v[84:87], v[44:47], v[216:219], v[84:87]
  ds_read_b64_tr_b16 v[60:61], v21 offset:25600
  v_mfma_f32_16x16x32_bf16 v[92:95], v[44:47], v[220:223], v[92:95]
  ds_read_b64_tr_b16 v[62:63], v21 offset:27648
  s_waitcnt lgkmcnt(6)
  v_mfma_f32_16x16x32_bf16 v[96:99], v[48:51], v[216:219], v[96:99]
  ds_read_b64_tr_b16 v[32:33], v18 offset:32768
  v_mfma_f32_16x16x32_bf16 v[104:107], v[48:51], v[220:223], v[104:107]
  ds_read_b64_tr_b16 v[34:35], v18 offset:34816
  s_waitcnt lgkmcnt(6)
  v_mfma_f32_16x16x32_bf16 v[100:103], v[52:55], v[216:219], v[100:103]
  ds_read_b64_tr_b16 v[36:37], v19 offset:32768
  v_mfma_f32_16x16x32_bf16 v[108:111], v[52:55], v[220:223], v[108:111]
  ds_read_b64_tr_b16 v[38:39], v19 offset:34816
  s_waitcnt lgkmcnt(6)
  v_mfma_f32_16x16x32_bf16 v[112:115], v[56:59], v[216:219], v[112:115]
  ds_read_b64_tr_b16 v[40:41], v20 offset:32768
  v_mfma_f32_16x16x32_bf16 v[120:123], v[56:59], v[220:223], v[120:123]
  ds_read_b64_tr_b16 v[42:43], v20 offset:34816
  s_waitcnt lgkmcnt(6)
  v_mfma_f32_16x16x32_bf16 v[116:119], v[60:63], v[216:219], v[116:119]
  ds_read_b64_tr_b16 v[44:45], v21 offset:32768
  v_mfma_f32_16x16x32_bf16 v[124:127], v[60:63], v[220:223], v[124:127]
  ds_read_b64_tr_b16 v[46:47], v21 offset:34816
  s_waitcnt lgkmcnt(6)
  s_waitcnt vmcnt(15)
  v_mfma_f32_16x16x32_bf16 v[64:67], v[32:35], v[224:227], v[64:67]
  ds_read_b64_tr_b16 v[48:49], v18 offset:33792
  s_waitcnt vmcnt(7)
  s_waitcnt vmcnt(6)
  v_mfma_f32_16x16x32_bf16 v[72:75], v[32:35], v[228:231], v[72:75]
  ds_read_b64_tr_b16 v[50:51], v18 offset:35840
  ds_read_b64 v[144:145], v8 offset:0
  ds_read_b64 v[146:147], v8 offset:64
  s_waitcnt lgkmcnt(8)
  v_mfma_f32_16x16x32_bf16 v[68:71], v[36:39], v[224:227], v[68:71]
  ds_read_b64_tr_b16 v[52:53], v19 offset:33792
  ds_read_b64 v[148:149], v8 offset:256
  v_mfma_f32_16x16x32_bf16 v[76:79], v[36:39], v[228:231], v[76:79]
  ds_read_b64_tr_b16 v[54:55], v19 offset:35840
  ds_read_b64 v[150:151], v8 offset:320
  ds_read_b64 v[152:153], v8 offset:512
  s_waitcnt lgkmcnt(11)
  v_mfma_f32_16x16x32_bf16 v[80:83], v[40:43], v[224:227], v[80:83]
  ds_read_b64_tr_b16 v[56:57], v20 offset:33792
  ds_read_b64 v[154:155], v8 offset:576
  ds_read_b64 v[156:157], v8 offset:768
  v_mfma_f32_16x16x32_bf16 v[88:91], v[40:43], v[228:231], v[88:91]
  ds_read_b64_tr_b16 v[58:59], v20 offset:35840
  ds_read_b64 v[158:159], v8 offset:832
  s_waitcnt lgkmcnt(14)
  v_mfma_f32_16x16x32_bf16 v[84:87], v[44:47], v[224:227], v[84:87]
  ds_read_b64_tr_b16 v[60:61], v21 offset:33792
  v_add_f32 v2, v128, v130
  v_add_f32 v4, v132, v134
  v_mfma_f32_16x16x32_bf16 v[92:95], v[44:47], v[228:231], v[92:95]
  ds_read_b64_tr_b16 v[62:63], v21 offset:35840
  v_add_f32 v3, v129, v131
  v_add_f32 v5, v133, v135
  s_waitcnt lgkmcnt(14)
  v_mfma_f32_16x16x32_bf16 v[96:99], v[48:51], v[224:227], v[96:99]
  ds_read_b64_tr_b16 v[32:33], v18 offset:40960
  v_add_f32 v2, v2, v136
  v_mfma_f32_16x16x32_bf16 v[104:107], v[48:51], v[228:231], v[104:107]
  ds_read_b64_tr_b16 v[34:35], v18 offset:43008
  v_add_f32 v3, v3, v137
  v_add_f32 v4, v4, v138
  s_waitcnt lgkmcnt(11)
  v_mfma_f32_16x16x32_bf16 v[100:103], v[52:55], v[224:227], v[100:103]
  ds_read_b64_tr_b16 v[36:37], v19 offset:40960
  v_add_f32 v5, v5, v139
  v_mfma_f32_16x16x32_bf16 v[108:111], v[52:55], v[228:231], v[108:111]
  ds_read_b64_tr_b16 v[38:39], v19 offset:43008
  v_add_f32 v2, v2, v140
  v_add_f32 v3, v3, v141
  s_waitcnt lgkmcnt(7)
  v_mfma_f32_16x16x32_bf16 v[112:115], v[56:59], v[224:227], v[112:115]
  ds_read_b64_tr_b16 v[40:41], v20 offset:40960
  v_add_f32 v4, v4, v142
  v_mfma_f32_16x16x32_bf16 v[120:123], v[56:59], v[228:231], v[120:123]
  ds_read_b64_tr_b16 v[42:43], v20 offset:43008
  v_add_f32 v5, v5, v143
  v_add_f32 v2, v2, v4
  s_waitcnt lgkmcnt(6)
  v_mfma_f32_16x16x32_bf16 v[116:119], v[60:63], v[224:227], v[116:119]
  ds_read_b64_tr_b16 v[44:45], v21 offset:40960
  v_add_f32 v3, v3, v5
  v_mfma_f32_16x16x32_bf16 v[124:127], v[60:63], v[228:231], v[124:127]
  ds_read_b64_tr_b16 v[46:47], v21 offset:43008
  v_mov_b32 v4, v2
  v_mov_b32 v5, v3
  s_waitcnt lgkmcnt(6)
  s_waitcnt vmcnt(5)
  v_mfma_f32_16x16x32_bf16 v[64:67], v[32:35], v[232:235], v[64:67]
  ds_read_b64_tr_b16 v[48:49], v18 offset:41984
  s_nop 1
  s_waitcnt vmcnt(4)
  v_mfma_f32_16x16x32_bf16 v[72:75], v[32:35], v[236:239], v[72:75]
  ds_read_b64_tr_b16 v[50:51], v18 offset:44032
  v_permlane32_swap_b32 v2, v4
  v_permlane32_swap_b32 v3, v5
  s_waitcnt lgkmcnt(6)
  v_mfma_f32_16x16x32_bf16 v[68:71], v[36:39], v[232:235], v[68:71]
  ds_read_b64_tr_b16 v[52:53], v19 offset:41984
  s_nop 1
  v_mfma_f32_16x16x32_bf16 v[76:79], v[36:39], v[236:239], v[76:79]
  ds_read_b64_tr_b16 v[54:55], v19 offset:44032
  v_add_f32 v2, v2, v4
  v_add_f32 v3, v3, v5
  s_waitcnt lgkmcnt(6)
  v_mfma_f32_16x16x32_bf16 v[80:83], v[40:43], v[232:235], v[80:83]
  ds_read_b64_tr_b16 v[56:57], v20 offset:41984
  v_mul_f32 v2, 0xbb000000, v2
  v_mfma_f32_16x16x32_bf16 v[88:91], v[40:43], v[236:239], v[88:91]
  ds_read_b64_tr_b16 v[58:59], v20 offset:44032
  v_mul_f32 v3, 0x3b000000, v3
  v_fma_f32 v3, -v2, v2, v3
  s_waitcnt lgkmcnt(6)
  v_mfma_f32_16x16x32_bf16 v[84:87], v[44:47], v[232:235], v[84:87]
  ds_read_b64_tr_b16 v[60:61], v21 offset:41984
  v_max_f32 v3, 0, v3
  v_mfma_f32_16x16x32_bf16 v[92:95], v[44:47], v[236:239], v[92:95]
  ds_read_b64_tr_b16 v[62:63], v21 offset:44032
  v_add_f32 v26, 0x3727c5ac, v3
  v_rsq_f32 v6, v26
  s_waitcnt lgkmcnt(6)
  v_mfma_f32_16x16x32_bf16 v[96:99], v[48:51], v[232:235], v[96:99]
  ds_read_b64_tr_b16 v[32:33], v18 offset:49152
  v_cvt_pk_bf16_f32 v4, v2, v2
  v_mfma_f32_16x16x32_bf16 v[104:107], v[48:51], v[236:239], v[104:107]
  ds_read_b64_tr_b16 v[34:35], v18 offset:51200
  v_and_b32 v4, 0xffff0000, v4
  v_sub_f32 v4, v2, v4
  s_waitcnt lgkmcnt(6)
  v_mfma_f32_16x16x32_bf16 v[100:103], v[52:55], v[232:235], v[100:103]
  ds_read_b64_tr_b16 v[36:37], v19 offset:49152
  v_cvt_pk_bf16_f32 v4, v2, v4
  v_mfma_f32_16x16x32_bf16 v[108:111], v[52:55], v[236:239], v[108:111]
  ds_read_b64_tr_b16 v[38:39], v19 offset:51200
  v_mov_b32 v5, v4
  v_mov_b32 v27, v26
  s_waitcnt lgkmcnt(6)
  v_mfma_f32_16x16x32_bf16 v[112:115], v[56:59], v[232:235], v[112:115]
  ds_read_b64_tr_b16 v[40:41], v20 offset:49152
  s_nop 0
  v_mfma_f32_16x16x32_bf16 v[120:123], v[56:59], v[236:239], v[120:123]
  ds_read_b64_tr_b16 v[42:43], v20 offset:51200
  v_permlane16_swap_b32 v4, v5
  v_permlane16_swap_b32 v26, v27
  s_waitcnt lgkmcnt(6)
  v_mfma_f32_16x16x32_bf16 v[116:119], v[60:63], v[232:235], v[116:119]
  ds_read_b64_tr_b16 v[44:45], v21 offset:49152
  s_nop 0
  v_mfma_f32_16x16x32_bf16 v[124:127], v[60:63], v[236:239], v[124:127]
  ds_read_b64_tr_b16 v[46:47], v21 offset:51200
  v_cndmask_b32_e64 v164, 0, v5, s[90:91]
  v_cndmask_b32_e64 v165, 0, v5, s[90:91]
  s_waitcnt lgkmcnt(6)
  s_waitcnt vmcnt(3)
  v_mfma_f32_16x16x32_bf16 v[64:67], v[32:35], v[240:243], v[64:67]
  ds_read_b64_tr_b16 v[48:49], v18 offset:50176
  v_mov_b32 v166, 0
  s_waitcnt vmcnt(2)
  v_mfma_f32_16x16x32_bf16 v[72:75], v[32:35], v[244:247], v[72:75]
  ds_read_b64_tr_b16 v[50:51], v18 offset:52224
  v_mov_b32 v167, 0
  v_cndmask_b32_e64 v28, 0, v4, s[90:91]
  s_waitcnt lgkmcnt(6)
  v_mfma_f32_16x16x32_bf16 v[68:71], v[36:39], v[240:243], v[68:71]
  ds_read_b64_tr_b16 v[52:53], v19 offset:50176
  v_cndmask_b32_e64 v29, 0, v4, s[90:91]
  v_mfma_f32_16x16x32_bf16 v[76:79], v[36:39], v[244:247], v[76:79]
  ds_read_b64_tr_b16 v[54:55], v19 offset:52224
  v_mov_b32 v30, 0
  v_mov_b32 v31, 0
  s_waitcnt lgkmcnt(6)
  v_mfma_f32_16x16x32_bf16 v[80:83], v[40:43], v[240:243], v[80:83]
  ds_read_b64_tr_b16 v[56:57], v20 offset:50176
  v_mul_f32 v22, 0xc0135761, v6
  v_mfma_f32_16x16x32_bf16 v[88:91], v[40:43], v[244:247], v[88:91]
  ds_read_b64_tr_b16 v[58:59], v20 offset:52224
  v_mul_f32 v4, v6, v6
  v_mul_f32 v4, v4, v6
  s_waitcnt lgkmcnt(6)
  v_mfma_f32_16x16x32_bf16 v[84:87], v[44:47], v[240:243], v[84:87]
  ds_read_b64_tr_b16 v[60:61], v21 offset:50176
  v_mul_f32 v24, 0xbdd2d3e8, v4
  v_mfma_f32_16x16x32_bf16 v[92:95], v[44:47], v[244:247], v[92:95]
  ds_read_b64_tr_b16 v[62:63], v21 offset:52224
  v_mov_b32 v23, v22
  v_mov_b32 v25, v24
  s_waitcnt lgkmcnt(6)
  v_mfma_f32_16x16x32_bf16 v[96:99], v[48:51], v[240:243], v[96:99]
  ds_read_b64_tr_b16 v[32:33], v18 offset:57344
  v_mfma_f32_16x16x32_bf16 v[104:107], v[48:51], v[244:247], v[104:107]
  ds_read_b64_tr_b16 v[34:35], v18 offset:59392
  s_waitcnt lgkmcnt(6)
  v_mfma_f32_16x16x32_bf16 v[100:103], v[52:55], v[240:243], v[100:103]
  ds_read_b64_tr_b16 v[36:37], v19 offset:57344
  s_nop 1
  v_mfma_f32_16x16x32_bf16 v[108:111], v[52:55], v[244:247], v[108:111]
  ds_read_b64_tr_b16 v[38:39], v19 offset:59392
  s_waitcnt lgkmcnt(6)
  v_mfma_f32_16x16x32_bf16 v[112:115], v[56:59], v[240:243], v[112:115]
  ds_read_b64_tr_b16 v[40:41], v20 offset:57344
  v_mfma_f32_16x16x32_bf16 v[120:123], v[56:59], v[244:247], v[120:123]
  ds_read_b64_tr_b16 v[42:43], v20 offset:59392
  v_permlane16_swap_b32 v22, v23
  s_waitcnt lgkmcnt(6)
  v_mfma_f32_16x16x32_bf16 v[116:119], v[60:63], v[240:243], v[116:119]
  ds_read_b64_tr_b16 v[44:45], v21 offset:57344
  v_mfma_f32_16x16x32_bf16 v[124:127], v[60:63], v[244:247], v[124:127]
  ds_read_b64_tr_b16 v[46:47], v21 offset:59392
  v_permlane16_swap_b32 v24, v25
  s_waitcnt lgkmcnt(6)
  s_waitcnt vmcnt(1)
  v_mfma_f32_16x16x32_bf16 v[64:67], v[32:35], v[248:251], v[64:67]
  ds_read_b64_tr_b16 v[48:49], v18 offset:58368
  s_waitcnt vmcnt(0)
  v_mfma_f32_16x16x32_bf16 v[72:75], v[32:35], v[252:255], v[72:75]
  ds_read_b64_tr_b16 v[50:51], v18 offset:60416
  s_waitcnt lgkmcnt(6)
  v_mfma_f32_16x16x32_bf16 v[68:71], v[36:39], v[248:251], v[68:71]
  ds_read_b64_tr_b16 v[52:53], v19 offset:58368
  v_mfma_f32_16x16x32_bf16 v[76:79], v[36:39], v[252:255], v[76:79]
  ds_read_b64_tr_b16 v[54:55], v19 offset:60416
  s_waitcnt lgkmcnt(6)
  v_mfma_f32_16x16x32_bf16 v[80:83], v[40:43], v[248:251], v[80:83]
  ds_read_b64_tr_b16 v[56:57], v20 offset:58368
  v_mfma_f32_16x16x32_bf16 v[88:91], v[40:43], v[252:255], v[88:91]
  ds_read_b64_tr_b16 v[58:59], v20 offset:60416
  s_waitcnt lgkmcnt(6)
  v_mfma_f32_16x16x32_bf16 v[84:87], v[44:47], v[248:251], v[84:87]
  ds_read_b64_tr_b16 v[60:61], v21 offset:58368
  v_mfma_f32_16x16x32_bf16 v[92:95], v[44:47], v[252:255], v[92:95]
  ds_read_b64_tr_b16 v[62:63], v21 offset:60416
  v_mfma_f32_16x16x32_bf16 v[96:99], v[152:155], v[28:31], v[96:99]
  v_mfma_f32_16x16x32_bf16 v[104:107], v[152:155], v[164:167], v[104:107]
  v_mfma_f32_16x16x32_bf16 v[100:103], v[154:157], v[28:31], v[100:103]
  v_mfma_f32_16x16x32_bf16 v[108:111], v[154:157], v[164:167], v[108:111]
  v_mfma_f32_16x16x32_bf16 v[112:115], v[156:159], v[28:31], v[112:115]
  v_mfma_f32_16x16x32_bf16 v[120:123], v[156:159], v[164:167], v[120:123]
  v_mfma_f32_16x16x32_bf16 v[116:119], v[158:161], v[28:31], v[116:119]
  v_mfma_f32_16x16x32_bf16 v[124:127], v[158:161], v[164:167], v[124:127]
  v_mfma_f32_16x16x32_bf16 v[64:67], v[144:147], v[28:31], v[64:67]
  v_mfma_f32_16x16x32_bf16 v[72:75], v[144:147], v[164:167], v[72:75]
  v_mfma_f32_16x16x32_bf16 v[68:71], v[146:149], v[28:31], v[68:71]
  v_mfma_f32_16x16x32_bf16 v[76:79], v[146:149], v[164:167], v[76:79]
  v_mfma_f32_16x16x32_bf16 v[80:83], v[148:151], v[28:31], v[80:83]
  v_mfma_f32_16x16x32_bf16 v[88:91], v[148:151], v[164:167], v[88:91]
  v_mfma_f32_16x16x32_bf16 v[84:87], v[150:153], v[28:31], v[84:87]
  v_mfma_f32_16x16x32_bf16 v[92:95], v[150:153], v[164:167], v[92:95]
  s_waitcnt lgkmcnt(6)
  v_mfma_f32_16x16x32_bf16 v[96:99], v[48:51], v[248:251], v[96:99]
  v_mfma_f32_16x16x32_bf16 v[104:107], v[48:51], v[252:255], v[104:107]
  s_waitcnt lgkmcnt(4)
  v_mfma_f32_16x16x32_bf16 v[100:103], v[52:55], v[248:251], v[100:103]
  v_mfma_f32_16x16x32_bf16 v[108:111], v[52:55], v[252:255], v[108:111]
  s_waitcnt lgkmcnt(2)
  v_mfma_f32_16x16x32_bf16 v[112:115], v[56:59], v[248:251], v[112:115]
  v_mfma_f32_16x16x32_bf16 v[120:123], v[56:59], v[252:255], v[120:123]
  s_waitcnt lgkmcnt(0)
  v_mfma_f32_16x16x32_bf16 v[116:119], v[60:63], v[248:251], v[116:119]
  v_mfma_f32_16x16x32_bf16 v[124:127], v[60:63], v[252:255], v[124:127]
  s_waitcnt lgkmcnt(0)
  s_nop 15
  s_lshr_b32 s24, s7, 3
  s_lshl_b32 s30, s6, 3
  s_add_u32 s30, s30, s24
  s_lshl_b32 s26, s6, 2
  s_add_u32 s24, s24, s26
  s_and_b32 s25, s7, 7
  s_and_b32 s26, s5, 3
  v_lshlrev_b32 v17, 4, v1
  s_mul_i32 s27, s5, 7
  s_lshr_b32 s27, s27, 1
  s_and_b32 s29, s30, 31
  s_lshl_b32 s28, s29, 5
  s_add_u32 s28, s27, s28
  s_and_b32 s27, s28, 63
  s_lshl_b32 s27, s27, 7
  s_lshr_b32 s56, s28, 6
  s_lshl_b32 s56, s56, 14
  s_add_u32 s27, s27, s56
  s_xor_b32 s56, s94, 0x2000
  s_add_u32 s27, s27, s56
  s_add_u32 s27, s27, s95
  s_add_u32 s27, s27, 262144
  s_add_u32 s0, s54, s27
  s_addc_u32 s1, s55, 0
  s_lshr_b32 s56, s29, 3
  s_lshl_b32 s56, s56, 22
  s_and_b32 s27, s29, 7
  s_lshl_b32 s27, s27, 18
  s_add_u32 s56, s56, s27
  s_xor_b32 s27, s94, 0x2000
  s_add_u32 s56, s56, s27
  s_add_u32 s56, s56, s3
  s_add_u32 s56, s56, 2097152
  s_lshl_b32 s27, s5, 15
  s_add_u32 s56, s56, s27
  s_mul_i32 s87, s26, 6144
  s_add_u32 s87, s87, 135168
  s_lshl_b32 s88, s26, 14
  s_lshl_b32 s27, s26, 2
  s_add_u32 s27, s27, 132112
  v_mov_b32 v31, s27
  v_mov_b32 v18, v23
  v_mov_b32 v20, v25
  v_mov_b32 v28, v27
  v_pk_mul_f32 v[240:241], v[64:65], v[64:65]
  v_pk_mul_f32 v[242:243], v[66:67], v[66:67]
  v_pk_mul_f32 v[244:245], v[68:69], v[68:69]
  v_pk_mul_f32 v[246:247], v[70:71], v[70:71]
  v_pk_fma_f32 v[240:241], v[240:241], v[24:25], v[22:23] op_sel_hi:[1,0,0]
  v_pk_fma_f32 v[242:243], v[242:243], v[24:25], v[22:23] op_sel_hi:[1,0,0]
  v_pk_fma_f32 v[244:245], v[244:245], v[24:25], v[22:23] op_sel_hi:[1,0,0]
  v_pk_fma_f32 v[246:247], v[246:247], v[24:25], v[22:23] op_sel_hi:[1,0,0]
  v_pk_mul_f32 v[240:241], v[240:241], v[64:65]
  v_pk_mul_f32 v[242:243], v[242:243], v[66:67]
  v_pk_mul_f32 v[244:245], v[244:245], v[68:69]
  v_pk_mul_f32 v[246:247], v[246:247], v[70:71]
  v_exp_f32 v240, v240
  v_exp_f32 v241, v241
  v_exp_f32 v242, v242
  v_exp_f32 v243, v243
  v_exp_f32 v244, v244
  v_exp_f32 v245, v245
  v_exp_f32 v246, v246
  v_exp_f32 v247, v247
  v_pk_mul_f32 v[64:65], v[64:65], v[96:97]
  v_pk_mul_f32 v[66:67], v[66:67], v[98:99]
  v_pk_mul_f32 v[68:69], v[68:69], v[100:101]
  v_pk_mul_f32 v[70:71], v[70:71], v[102:103]
  v_pk_fma_f32 v[240:241], v[240:241], v[26:27], v[26:27] op_sel_hi:[1,0,0]
  v_pk_fma_f32 v[242:243], v[242:243], v[26:27], v[26:27] op_sel_hi:[1,0,0]
  v_pk_fma_f32 v[244:245], v[244:245], v[26:27], v[26:27] op_sel_hi:[1,0,0]
  v_pk_fma_f32 v[246:247], v[246:247], v[26:27], v[26:27] op_sel_hi:[1,0,0]
  v_rcp_f32 v240, v240
  v_rcp_f32 v241, v241
  v_rcp_f32 v242, v242
  v_rcp_f32 v243, v243
  v_rcp_f32 v244, v244
  v_rcp_f32 v245, v245
  v_rcp_f32 v246, v246
  v_rcp_f32 v247, v247
  s_nop 0
  v_pk_mul_f32 v[64:65], v[64:65], v[240:241]
  v_pk_mul_f32 v[66:67], v[66:67], v[242:243]
  v_pk_mul_f32 v[68:69], v[68:69], v[244:245]
  v_pk_mul_f32 v[70:71], v[70:71], v[246:247]
  v_cvt_pk_bf16_f32 v32, v64, v65
  v_cvt_pk_bf16_f32 v33, v66, v67
  v_cvt_pk_bf16_f32 v34, v68, v69
  v_cvt_pk_bf16_f32 v35, v70, v71
  buffer_store_dwordx4 v[32:35], v16, s[8:11], s84 offen offset:0 sc1
  v_pk_mul_f32 v[248:249], v[72:73], v[72:73]
  v_pk_mul_f32 v[250:251], v[74:75], v[74:75]
  v_pk_mul_f32 v[252:253], v[76:77], v[76:77]
  v_pk_mul_f32 v[254:255], v[78:79], v[78:79]
  v_pk_fma_f32 v[248:249], v[248:249], v[20:21], v[18:19] op_sel_hi:[1,0,0]
  v_pk_fma_f32 v[250:251], v[250:251], v[20:21], v[18:19] op_sel_hi:[1,0,0]
  v_pk_fma_f32 v[252:253], v[252:253], v[20:21], v[18:19] op_sel_hi:[1,0,0]
  v_pk_fma_f32 v[254:255], v[254:255], v[20:21], v[18:19] op_sel_hi:[1,0,0]
  v_pk_mul_f32 v[248:249], v[248:249], v[72:73]
  v_pk_mul_f32 v[250:251], v[250:251], v[74:75]
  v_pk_mul_f32 v[252:253], v[252:253], v[76:77]
  v_pk_mul_f32 v[254:255], v[254:255], v[78:79]
  v_exp_f32 v248, v248
  v_exp_f32 v249, v249
  v_exp_f32 v250, v250
  v_exp_f32 v251, v251
  v_exp_f32 v252, v252
  v_exp_f32 v253, v253
  v_exp_f32 v254, v254
  v_exp_f32 v255, v255
  v_pk_mul_f32 v[72:73], v[72:73], v[104:105]
  v_pk_mul_f32 v[74:75], v[74:75], v[106:107]
  v_pk_mul_f32 v[76:77], v[76:77], v[108:109]
  v_pk_mul_f32 v[78:79], v[78:79], v[110:111]
  v_pk_fma_f32 v[248:249], v[248:249], v[28:29], v[28:29] op_sel_hi:[1,0,0]
  v_pk_fma_f32 v[250:251], v[250:251], v[28:29], v[28:29] op_sel_hi:[1,0,0]
  v_pk_fma_f32 v[252:253], v[252:253], v[28:29], v[28:29] op_sel_hi:[1,0,0]
  v_pk_fma_f32 v[254:255], v[254:255], v[28:29], v[28:29] op_sel_hi:[1,0,0]
  v_rcp_f32 v248, v248
  v_rcp_f32 v249, v249
  v_rcp_f32 v250, v250
  v_rcp_f32 v251, v251
  v_rcp_f32 v252, v252
  v_rcp_f32 v253, v253
  v_rcp_f32 v254, v254
  v_rcp_f32 v255, v255
  s_nop 0
  v_pk_mul_f32 v[72:73], v[72:73], v[248:249]
  v_pk_mul_f32 v[74:75], v[74:75], v[250:251]
  v_pk_mul_f32 v[76:77], v[76:77], v[252:253]
  v_pk_mul_f32 v[78:79], v[78:79], v[254:255]
  v_cvt_pk_bf16_f32 v36, v72, v73
  v_cvt_pk_bf16_f32 v37, v74, v75
  v_cvt_pk_bf16_f32 v38, v76, v77
  v_cvt_pk_bf16_f32 v39, v78, v79
  buffer_store_dwordx4 v[36:39], v16, s[8:11], s84 offen offset:256 sc1
  v_pk_mul_f32 v[240:241], v[80:81], v[80:81]
  v_pk_mul_f32 v[242:243], v[82:83], v[82:83]
  v_pk_mul_f32 v[244:245], v[84:85], v[84:85]
  v_pk_mul_f32 v[246:247], v[86:87], v[86:87]
  v_pk_fma_f32 v[240:241], v[240:241], v[24:25], v[22:23] op_sel_hi:[1,0,0]
  v_pk_fma_f32 v[242:243], v[242:243], v[24:25], v[22:23] op_sel_hi:[1,0,0]
  v_pk_fma_f32 v[244:245], v[244:245], v[24:25], v[22:23] op_sel_hi:[1,0,0]
  v_pk_fma_f32 v[246:247], v[246:247], v[24:25], v[22:23] op_sel_hi:[1,0,0]
  v_pk_mul_f32 v[240:241], v[240:241], v[80:81]
  v_pk_mul_f32 v[242:243], v[242:243], v[82:83]
  v_pk_mul_f32 v[244:245], v[244:245], v[84:85]
  v_pk_mul_f32 v[246:247], v[246:247], v[86:87]
  v_exp_f32 v240, v240
  v_exp_f32 v241, v241
  v_exp_f32 v242, v242
  v_exp_f32 v243, v243
  v_exp_f32 v244, v244
  v_exp_f32 v245, v245
  v_exp_f32 v246, v246
  v_exp_f32 v247, v247
  v_pk_mul_f32 v[80:81], v[80:81], v[112:113]
  v_pk_mul_f32 v[82:83], v[82:83], v[114:115]
  v_pk_mul_f32 v[84:85], v[84:85], v[116:117]
  v_pk_mul_f32 v[86:87], v[86:87], v[118:119]
  v_pk_fma_f32 v[240:241], v[240:241], v[26:27], v[26:27] op_sel_hi:[1,0,0]
  v_pk_fma_f32 v[242:243], v[242:243], v[26:27], v[26:27] op_sel_hi:[1,0,0]
  v_pk_fma_f32 v[244:245], v[244:245], v[26:27], v[26:27] op_sel_hi:[1,0,0]
  v_pk_fma_f32 v[246:247], v[246:247], v[26:27], v[26:27] op_sel_hi:[1,0,0]
  v_rcp_f32 v240, v240
  v_rcp_f32 v241, v241
  v_rcp_f32 v242, v242
  v_rcp_f32 v243, v243
  v_rcp_f32 v244, v244
  v_rcp_f32 v245, v245
  v_rcp_f32 v246, v246
  v_rcp_f32 v247, v247
  s_nop 0
  v_pk_mul_f32 v[80:81], v[80:81], v[240:241]
  v_pk_mul_f32 v[82:83], v[82:83], v[242:243]
  v_pk_mul_f32 v[84:85], v[84:85], v[244:245]
  v_pk_mul_f32 v[86:87], v[86:87], v[246:247]
  v_cvt_pk_bf16_f32 v40, v80, v81
  v_cvt_pk_bf16_f32 v41, v82, v83
  v_cvt_pk_bf16_f32 v42, v84, v85
  v_cvt_pk_bf16_f32 v43, v86, v87
  buffer_store_dwordx4 v[40:43], v11, s[8:11], s92 offen offset:0 sc1
  v_pk_mul_f32 v[248:249], v[88:89], v[88:89]
  v_pk_mul_f32 v[250:251], v[90:91], v[90:91]
  v_pk_mul_f32 v[252:253], v[92:93], v[92:93]
  v_pk_mul_f32 v[254:255], v[94:95], v[94:95]
  v_pk_fma_f32 v[248:249], v[248:249], v[20:21], v[18:19] op_sel_hi:[1,0,0]
  v_pk_fma_f32 v[250:251], v[250:251], v[20:21], v[18:19] op_sel_hi:[1,0,0]
  v_pk_fma_f32 v[252:253], v[252:253], v[20:21], v[18:19] op_sel_hi:[1,0,0]
  v_pk_fma_f32 v[254:255], v[254:255], v[20:21], v[18:19] op_sel_hi:[1,0,0]
  v_pk_mul_f32 v[248:249], v[248:249], v[88:89]
  v_pk_mul_f32 v[250:251], v[250:251], v[90:91]
  v_pk_mul_f32 v[252:253], v[252:253], v[92:93]
  v_pk_mul_f32 v[254:255], v[254:255], v[94:95]
  v_exp_f32 v248, v248
  v_exp_f32 v249, v249
  v_exp_f32 v250, v250
  v_exp_f32 v251, v251
  v_exp_f32 v252, v252
  v_exp_f32 v253, v253
  v_exp_f32 v254, v254
  v_exp_f32 v255, v255
  v_pk_mul_f32 v[88:89], v[88:89], v[120:121]
  v_pk_mul_f32 v[90:91], v[90:91], v[122:123]
  v_pk_mul_f32 v[92:93], v[92:93], v[124:125]
  v_pk_mul_f32 v[94:95], v[94:95], v[126:127]
  v_pk_fma_f32 v[248:249], v[248:249], v[28:29], v[28:29] op_sel_hi:[1,0,0]
  v_pk_fma_f32 v[250:251], v[250:251], v[28:29], v[28:29] op_sel_hi:[1,0,0]
  v_pk_fma_f32 v[252:253], v[252:253], v[28:29], v[28:29] op_sel_hi:[1,0,0]
  v_pk_fma_f32 v[254:255], v[254:255], v[28:29], v[28:29] op_sel_hi:[1,0,0]
  v_rcp_f32 v248, v248
  v_rcp_f32 v249, v249
  v_rcp_f32 v250, v250
  v_rcp_f32 v251, v251
  v_rcp_f32 v252, v252
  v_rcp_f32 v253, v253
  v_rcp_f32 v254, v254
  v_rcp_f32 v255, v255
  s_nop 0
  v_pk_mul_f32 v[88:89], v[88:89], v[248:249]
  v_pk_mul_f32 v[90:91], v[90:91], v[250:251]
  v_pk_mul_f32 v[92:93], v[92:93], v[252:253]
  v_pk_mul_f32 v[94:95], v[94:95], v[254:255]
  v_cvt_pk_bf16_f32 v44, v88, v89
  v_cvt_pk_bf16_f32 v45, v90, v91
  v_cvt_pk_bf16_f32 v46, v92, v93
  v_cvt_pk_bf16_f32 v47, v94, v95
  buffer_store_dwordx4 v[44:47], v11, s[8:11], s92 offen offset:256 sc1
  s_setprio 0
  v_mov_b32 v4, s76
  v_mov_b32 v5, s77
  s_mov_b64 exec, 1
  s_waitcnt vmcnt(0)
  buffer_store_dwordx2 v[4:5], off, s[8:11], s83 sc1
  s_mov_b64 exec, -1
  s_branch L_dn_B2
L_dn_B:
  v_subrev_u32 v9, 16, v31
  ds_write_b32 v9, v9
L_dn_B2:
  ds_write_b32 v31, v31 offset:48
  v_add_u32 v18, s87, v14
  v_add_u32 v20, s88, v14
  v_subrev_u32 v22, 69632, v18
  v_add_u32 v19, s87, v15
  v_add_u32 v21, s88, v15
  v_subrev_u32 v23, 69632, v19
  s_mov_b32 s33, 0
L_dnw_lp:
  ds_read_b32 v4, v31 offset:0
  s_add_u32 s33, s33, 1
  s_waitcnt lgkmcnt(0)
  v_readfirstlane_b32 s34, v4
  s_cmp_lg_u32 s34, 0
  s_cbranch_scc1 L_dnw_ld
  s_sleep 1
  s_cmp_lt_u32 s33, 262144
  s_cbranch_scc1 L_dnw_lp
L_dnw_ld:
  ds_read_b128 v[128:131], v18 offset:0
  ds_read_b128 v[132:135], v19 offset:0
  ds_read_b128 v[136:139], v18 offset:2048
  ds_read_b128 v[140:143], v19 offset:2048
  ds_read_b128 v[144:147], v18 offset:4096
  ds_read_b128 v[148:151], v19 offset:4096
  ds_read_b128 v[152:155], v20 offset:0
  ds_read_b128 v[156:159], v21 offset:0
  ds_read_b128 v[160:163], v20 offset:2048
  ds_read_b128 v[164:167], v21 offset:2048
  ds_read_b128 v[168:171], v20 offset:4096
  ds_read_b128 v[172:175], v21 offset:4096
  ds_read_b128 v[176:179], v20 offset:6144
  ds_read_b128 v[180:183], v21 offset:6144
  ds_read_b128 v[184:187], v20 offset:8192
  ds_read_b128 v[188:191], v21 offset:8192
  ds_read_b128 v[192:195], v20 offset:10240
  ds_read_b128 v[196:199], v21 offset:10240
  ds_read_b128 v[200:203], v20 offset:12288
  ds_read_b128 v[204:207], v21 offset:12288
  ds_read_b128 v[208:211], v20 offset:14336
  ds_read_b128 v[212:215], v21 offset:14336
  ds_read_b128 v[216:219], v22 offset:0
  ds_read_b128 v[220:223], v23 offset:0
  ds_read_b128 v[224:227], v22 offset:2048
  ds_read_b128 v[228:231], v23 offset:2048
  ds_read_b128 v[232:235], v22 offset:4096
  ds_read_b128 v[236:239], v23 offset:4096
  s_add_u32 s58, s30, 4
  s_lshl_b32 s59, s25, 2
  s_add_u32 s59, s59, s26
  s_and_b32 s27, s58, 31
  s_lshl_b32 s27, s27, 16
  s_lshr_b32 s28, s59, 3
  s_lshl_b32 s28, s28, 14
  s_add_u32 s27, s27, s28
  s_and_b32 s28, s59, 7
  s_lshl_b32 s28, s28, 10
  s_add_u32 s27, s27, s28
  s_add_u32 s27, s27, s3
  s_add_u32 s27, s27, s94
  s_add_u32 s60, s27, 16777216
  s_add_u32 s84, s27, 20971520
  s_lshl_b32 s86, s58, 15
  s_lshl_b32 s28, s59, 5
  s_add_u32 s86, s86, s28
  s_and_b32 s85, s58, 31
  s_lshl_b32 s85, s85, 14
  s_lshl_b32 s28, s59, 8
  s_add_u32 s85, s85, s28
  s_xor_b32 s28, s94, 0x2000
  s_add_u32 s85, s85, s28
  s_add_u32 s85, s85, s3
  s_add_u32 s85, s85, 19136512
  v_lshrrev_b32 v7, 5, v1
  v_and_b32 v3, 31, v1
  v_lshlrev_b32 v29, 3, v3
  v_lshlrev_b32 v28, 10, v3
  v_lshl_add_u32 v28, v7, 4, v28
  s_mov_b32 s20, s50
  s_and_b32 s21, s51, 0xffff
  s_mov_b32 s22, 2097152
  s_mov_b32 s23, 0x20000
  s_xor_b32 s27, s26, 1
  s_mul_i32 s28, s27, 14336
  s_add_u32 s28, s28, 8192
  v_add_u32 v25, s28, v17
  s_xor_b32 s27, s26, 2
  s_mul_i32 s28, s27, 14336
  s_add_u32 s28, s28, 10240
  v_add_u32 v26, s28, v17
  s_xor_b32 s27, s26, 3
  s_mul_i32 s28, s27, 14336
  s_add_u32 s28, s28, 12288
  v_add_u32 v27, s28, v17
  s_mul_i32 s27, s26, 14336
  v_add_u32 v24, s27, v17
  s_mov_b32 s89, 0x3f803f80
  s_min_u32 s27, s7, 23
  s_mul_i32 s28, s27, 43
  s_lshr_b32 s28, s28, 8
  s_mul_i32 s28, s28, 6
  s_sub_u32 s27, s27, s28
  s_and_b32 s28, s6, 1
  s_mul_i32 s28, s28, 6
  s_add_u32 s27, s27, s28
  s_lshl_b32 s28, s27, 8
  v_lshrrev_b32 v3, 4, v1
  v_and_b32 v4, 15, v1
  v_lshrrev_b32 v5, 2, v4
  v_xor_b32 v5, v5, v3
  v_and_b32 v4, 3, v4
  v_lshl_add_u32 v4, v5, 2, v4
  v_lshlrev_b32 v4, 4, v4
  v_mul_u32_u24 v3, 3072, v3
  v_add3_u32 v16, v3, v4, s28
  s_mul_i32 s91, s5, 12288
  s_lshl_b32 s90, s5, 10
  s_add_u32 s90, s90, 114688
  s_mov_b32 s12, s38
  s_and_b32 s13, s39, 0xffff
  s_mov_b32 s14, 1572864
  s_mov_b32 s15, 0x20000
  buffer_load_dwordx4 v[8:11], v17, s[8:11], s60 offen
  s_waitcnt lgkmcnt(0)
  ds_write_b32 v31, v31 offset:80
  s_load_dwordx2 s[40:41], s[0:1], 32768 glc
  s_load_dwordx2 s[42:43], s[0:1], 32896 glc
  s_load_dwordx2 s[48:49], s[0:1], 33024 glc
  s_load_dwordx2 s[52:53], s[0:1], 33152 glc
  s_mov_b32 s33, 0
  s_branch L_dn1b_sph
L_dn1b_sp:
  s_load_dwordx2 s[40:41], s[0:1], 32768 glc
  s_load_dwordx2 s[42:43], s[0:1], 32896 glc
  s_load_dwordx2 s[48:49], s[0:1], 33024 glc
  s_load_dwordx2 s[52:53], s[0:1], 33152 glc
L_dn1b_sph:
  s_waitcnt lgkmcnt(0)
  s_xor_b64 s[40:41], s[40:41], s[76:77]
  s_xor_b64 s[42:43], s[42:43], s[76:77]
  s_xor_b64 s[48:49], s[48:49], s[76:77]
  s_xor_b64 s[52:53], s[52:53], s[76:77]
  s_or_b64 s[40:41], s[40:41], s[42:43]
  s_or_b64 s[40:41], s[40:41], s[48:49]
  s_or_b64 s[40:41], s[40:41], s[52:53]
  s_cbranch_scc0 L_dn1b_spd
  s_add_u32 s33, s33, 1
  s_sleep 1
  s_cmp_lt_u32 s33, 16384
  s_cbranch_scc1 L_dn1b_sp
L_dn1b_spd:
  s_add_u32 s57, s56, 1048576
  buffer_load_dwordx4 v[32:35], v17, s[8:11], s57 offen offset:0
  buffer_load_dwordx4 v[36:39], v17, s[8:11], s57 offen offset:1024
  buffer_load_dwordx4 v[40:43], v17, s[8:11], s57 offen offset:2048
  buffer_load_dwordx4 v[44:47], v17, s[8:11], s57 offen offset:3072
  s_add_u32 s57, s56, 1052672
  buffer_load_dwordx4 v[48:51], v17, s[8:11], s57 offen offset:0
  buffer_load_dwordx4 v[52:55], v17, s[8:11], s57 offen offset:1024
  buffer_load_dwordx4 v[56:59], v17, s[8:11], s57 offen offset:2048
  s_add_u32 s57, s56, 1064960
  buffer_load_dwordx4 v[60:63], v17, s[8:11], s57 offen offset:0
  buffer_load_dwordx4 v[240:243], v17, s[8:11], s57 offen offset:1024
  buffer_load_dwordx4 v[244:247], v17, s[8:11], s57 offen offset:2048
  buffer_load_dwordx4 v[248:251], v17, s[8:11], s57 offen offset:3072
  s_add_u32 s57, s56, 1069056
  buffer_load_dwordx4 v[252:255], v17, s[8:11], s57 offen offset:0
  s_branch L_dn_p2
L_dn_A:
  s_add_u32 m0, s87, 0
  s_add_u32 s31, s32, 114688
  buffer_load_dwordx4 v17, s[8:11], s31 offen lds
  buffer_load_dwordx4 v17, s[8:11], s31 offen offset:1024 lds
  s_add_u32 m0, s87, 2048
  s_add_u32 s31, s32, 116736
  buffer_load_dwordx4 v17, s[8:11], s31 offen lds
  buffer_load_dwordx4 v17, s[8:11], s31 offen offset:1024 lds
  s_add_u32 m0, s87, 4096
  s_add_u32 s31, s32, 118784
  buffer_load_dwordx4 v17, s[8:11], s31 offen lds
  buffer_load_dwordx4 v17, s[8:11], s31 offen offset:1024 lds
  s_add_u32 m0, s88, 0
  s_add_u32 s31, s32, 120832
  buffer_load_dwordx4 v17, s[8:11], s31 offen lds
  buffer_load_dwordx4 v17, s[8:11], s31 offen offset:1024 lds
  s_add_u32 m0, s88, 2048
  s_add_u32 s31, s32, 122880
  buffer_load_dwordx4 v17, s[8:11], s31 offen lds
  buffer_load_dwordx4 v17, s[8:11], s31 offen offset:1024 lds
  s_add_u32 m0, s88, 4096
  s_add_u32 s31, s32, 124928
  buffer_load_dwordx4 v17, s[8:11], s31 offen lds
  buffer_load_dwordx4 v17, s[8:11], s31 offen offset:1024 lds
  s_add_u32 m0, s88, 6144
  s_add_u32 s31, s32, 126976
  buffer_load_dwordx4 v17, s[8:11], s31 offen lds
  buffer_load_dwordx4 v17, s[8:11], s31 offen offset:1024 lds
  s_add_u32 m0, s88, 8192
  s_add_u32 s31, s32, 129024
  buffer_load_dwordx4 v17, s[8:11], s31 offen lds
  buffer_load_dwordx4 v17, s[8:11], s31 offen offset:1024 lds
  s_add_u32 m0, s88, 10240
  s_add_u32 s31, s32, 131072
  buffer_load_dwordx4 v17, s[8:11], s31 offen lds
  buffer_load_dwordx4 v17, s[8:11], s31 offen offset:1024 lds
  s_add_u32 m0, s88, 12288
  s_add_u32 s31, s32, 133120
  buffer_load_dwordx4 v17, s[8:11], s31 offen lds
  buffer_load_dwordx4 v17, s[8:11], s31 offen offset:1024 lds
  s_add_u32 m0, s88, 14336
  s_add_u32 s31, s32, 135168
  buffer_load_dwordx4 v17, s[8:11], s31 offen lds
  buffer_load_dwordx4 v17, s[8:11], s31 offen offset:1024 lds
  s_sub_u32 m0, s87, 69632
  s_add_u32 s31, s32, 137216
  buffer_load_dwordx4 v17, s[8:11], s31 offen lds
  buffer_load_dwordx4 v17, s[8:11], s31 offen offset:1024 lds
  s_sub_u32 m0, s87, 67584
  s_add_u32 s31, s32, 139264
  buffer_load_dwordx4 v17, s[8:11], s31 offen lds
  buffer_load_dwordx4 v17, s[8:11], s31 offen offset:1024 lds
  s_sub_u32 m0, s87, 65536
  s_add_u32 s31, s32, 141312
  buffer_load_dwordx4 v17, s[8:11], s31 offen lds
  buffer_load_dwordx4 v17, s[8:11], s31 offen offset:1024 lds
L_dn_A2:
  s_mov_b32 s33, 0
L_dn0a_sp:
  s_load_dwordx2 s[40:41], s[0:1], 0 glc
  s_load_dwordx2 s[42:43], s[0:1], 128 glc
  s_load_dwordx2 s[48:49], s[0:1], 256 glc
  s_load_dwordx2 s[52:53], s[0:1], 384 glc
  s_waitcnt lgkmcnt(0)
  s_xor_b64 s[40:41], s[40:41], s[76:77]
  s_xor_b64 s[42:43], s[42:43], s[76:77]
  s_xor_b64 s[48:49], s[48:49], s[76:77]
  s_xor_b64 s[52:53], s[52:53], s[76:77]
  s_or_b64 s[40:41], s[40:41], s[42:43]
  s_or_b64 s[40:41], s[40:41], s[48:49]
  s_or_b64 s[40:41], s[40:41], s[52:53]
  s_cbranch_scc0 L_dn0a_spd
  s_add_u32 s33, s33, 1
  s_sleep 1
  s_cmp_lt_u32 s33, 16384
  s_cbranch_scc1 L_dn0a_sp
L_dn0a_spd:
  s_load_dwordx2 s[40:41], s[0:1], 1792 glc
  s_load_dwordx2 s[42:43], s[0:1], 1920 glc
  s_load_dwordx2 s[48:49], s[0:1], 2048 glc
  s_load_dwordx2 s[52:53], s[0:1], 2176 glc
  s_add_u32 s57, s56, 0
  buffer_load_dwordx4 v[96:99], v17, s[8:11], s57 offen offset:0
  buffer_load_dwordx4 v[100:103], v17, s[8:11], s57 offen offset:1024
  buffer_load_dwordx4 v[104:107], v17, s[8:11], s57 offen offset:2048
  buffer_load_dwordx4 v[108:111], v17, s[8:11], s57 offen offset:3072
  s_add_u32 s57, s56, 4096
  buffer_load_dwordx4 v[32:35], v17, s[8:11], s57 offen offset:0
  buffer_load_dwordx4 v[36:39], v17, s[8:11], s57 offen offset:1024
  buffer_load_dwordx4 v[40:43], v17, s[8:11], s57 offen offset:2048
  s_add_u32 s57, s56, 16384
  buffer_load_dwordx4 v[44:47], v17, s[8:11], s57 offen offset:0
  v_mov_b32 v2, 132096
  s_waitcnt vmcnt(7)
  ds_write_b32 v31, v31
  v_mfma_f32_32x32x16_bf16 v[64:79], v[128:131], v[96:99], 0
  v_mfma_f32_32x32x16_bf16 v[80:95], v[132:135], v[96:99], 0
  buffer_load_dwordx4 v[48:51], v17, s[8:11], s57 offen offset:1024
  buffer_load_dwordx4 v[52:55], v17, s[8:11], s57 offen offset:2048
  s_waitcnt vmcnt(8)
  v_mfma_f32_32x32x16_bf16 v[64:79], v[136:139], v[100:103], v[64:79]
  v_mfma_f32_32x32x16_bf16 v[80:95], v[140:143], v[100:103], v[80:95]
  buffer_load_dwordx4 v[56:59], v17, s[8:11], s57 offen offset:3072
  s_add_u32 s57, s56, 20480
  buffer_load_dwordx4 v[60:63], v17, s[8:11], s57 offen offset:0
  v_add_u32 v18, s87, v14
  v_add_u32 v20, s88, v14
  v_subrev_u32 v22, 69632, v18
  v_add_u32 v19, s87, v15
  v_add_u32 v21, s88, v15
  v_subrev_u32 v23, 69632, v19
  s_waitcnt vmcnt(9)
  v_mfma_f32_32x32x16_bf16 v[64:79], v[144:147], v[104:107], v[64:79]
  v_mfma_f32_32x32x16_bf16 v[80:95], v[148:151], v[104:107], v[80:95]
  buffer_load_dwordx4 v[240:243], v17, s[8:11], s57 offen offset:1024
  buffer_load_dwordx4 v[244:247], v17, s[8:11], s57 offen offset:2048
  s_add_u32 s58, s30, 0
  s_lshl_b32 s59, s25, 2
  s_add_u32 s59, s59, s26
  s_and_b32 s27, s58, 31
  s_lshl_b32 s27, s27, 16
  s_lshr_b32 s28, s59, 3
  s_waitcnt vmcnt(10)
  v_mfma_f32_32x32x16_bf16 v[64:79], v[152:155], v[108:111], v[64:79]
  v_mfma_f32_32x32x16_bf16 v[80:95], v[156:159], v[108:111], v[80:95]
  s_mov_b32 s33, 0
  s_branch L_dn0p_sph
L_dn0p_sp:
  s_load_dwordx2 s[40:41], s[0:1], 1792 glc
  s_load_dwordx2 s[42:43], s[0:1], 1920 glc
  s_load_dwordx2 s[48:49], s[0:1], 2048 glc
  s_load_dwordx2 s[52:53], s[0:1], 2176 glc
L_dn0p_sph:
  s_waitcnt lgkmcnt(0)
  s_xor_b64 s[40:41], s[40:41], s[76:77]
  s_xor_b64 s[42:43], s[42:43], s[76:77]
  s_xor_b64 s[48:49], s[48:49], s[76:77]
  s_xor_b64 s[52:53], s[52:53], s[76:77]
  s_or_b64 s[40:41], s[40:41], s[42:43]
  s_or_b64 s[40:41], s[40:41], s[48:49]
  s_or_b64 s[40:41], s[40:41], s[52:53]
  s_cbranch_scc0 L_dn0p_spd
  s_add_u32 s33, s33, 1
  s_sleep 1
  s_cmp_lt_u32 s33, 16384
  s_cbranch_scc1 L_dn0p_sp
L_dn0p_spd:
  s_add_u32 s57, s56, 131072
  buffer_load_dwordx4 v[248:251], v17, s[8:11], s57 offen offset:0
  buffer_load_dwordx4 v[252:255], v17, s[8:11], s57 offen offset:1024
  s_lshl_b32 s28, s28, 14
  s_add_u32 s27, s27, s28
  s_and_b32 s28, s59, 7
  s_lshl_b32 s28, s28, 10
  s_add_u32 s27, s27, s28
  s_add_u32 s27, s27, s3
  s_waitcnt vmcnt(11)
  v_mfma_f32_32x32x16_bf16 v[64:79], v[160:163], v[32:35], v[64:79]
  v_mfma_f32_32x32x16_bf16 v[80:95], v[164:167], v[32:35], v[80:95]
  s_add_u32 s27, s27, s94
  s_add_u32 s60, s27, 16777216
  s_add_u32 s84, s27, 20971520
  s_lshl_b32 s86, s58, 15
  s_lshl_b32 s28, s59, 5
  s_add_u32 s86, s86, s28
  s_waitcnt vmcnt(10)
  v_mfma_f32_32x32x16_bf16 v[64:79], v[168:171], v[36:39], v[64:79]
  v_mfma_f32_32x32x16_bf16 v[80:95], v[172:175], v[36:39], v[80:95]
  buffer_load_dwordx4 v[32:35], v17, s[8:11], s57 offen offset:2048
  s_and_b32 s85, s58, 31
  s_lshl_b32 s85, s85, 14
  s_lshl_b32 s28, s59, 8
  s_add_u32 s85, s85, s28
  s_xor_b32 s28, s94, 0x2000
  s_add_u32 s85, s85, s28
  s_waitcnt vmcnt(10)
  v_mfma_f32_32x32x16_bf16 v[64:79], v[176:179], v[40:43], v[64:79]
  v_mfma_f32_32x32x16_bf16 v[80:95], v[180:183], v[40:43], v[80:95]
  buffer_load_dwordx4 v[36:39], v17, s[8:11], s57 offen offset:3072
  s_add_u32 s85, s85, s3
  s_add_u32 s85, s85, 19136512
  s_lshl_b32 s83, s24, 3
  s_add_u32 s83, s83, s25
  s_and_b32 s62, s83, 127
  s_and_b32 s83, s62, 63
  buffer_load_dwordx4 v[8:11], v17, s[8:11], s60 offen
  s_waitcnt vmcnt(11)
  v_mfma_f32_32x32x16_bf16 v[64:79], v[184:187], v[44:47], v[64:79]
  v_mfma_f32_32x32x16_bf16 v[80:95], v[188:191], v[44:47], v[80:95]
  s_add_u32 s57, s56, 135168
  buffer_load_dwordx4 v[40:43], v17, s[8:11], s57 offen offset:0
  s_lshl_b32 s83, s83, 7
  s_lshr_b32 s63, s62, 6
  s_lshl_b32 s63, s63, 14
  s_add_u32 s83, s83, s63
  s_xor_b32 s63, s94, 0x2000
  s_add_u32 s83, s83, s63
  s_waitcnt vmcnt(11)
  v_mfma_f32_32x32x16_bf16 v[64:79], v[192:195], v[48:51], v[64:79]
  v_mfma_f32_32x32x16_bf16 v[80:95], v[196:199], v[48:51], v[80:95]
  buffer_load_dwordx4 v[44:47], v17, s[8:11], s57 offen offset:1024
  s_add_u32 s83, s83, s95
  s_add_u32 s83, s83, 131072
  v_lshrrev_b32 v7, 5, v1
  v_and_b32 v3, 31, v1
  v_lshlrev_b32 v29, 3, v3
  v_lshlrev_b32 v28, 10, v3
  s_waitcnt vmcnt(11)
  v_mfma_f32_32x32x16_bf16 v[64:79], v[200:203], v[52:55], v[64:79]
  v_mfma_f32_32x32x16_bf16 v[80:95], v[204:207], v[52:55], v[80:95]
  buffer_load_dwordx4 v[48:51], v17, s[8:11], s57 offen offset:2048
  v_lshl_add_u32 v28, v7, 4, v28
  s_mov_b32 s20, s50
  s_and_b32 s21, s51, 0xffff
  s_mov_b32 s22, 2097152
  s_mov_b32 s23, 0x20000
  s_xor_b32 s27, s26, 0
  s_waitcnt vmcnt(11)
  v_mfma_f32_32x32x16_bf16 v[64:79], v[208:211], v[56:59], v[64:79]
  v_mfma_f32_32x32x16_bf16 v[80:95], v[212:215], v[56:59], v[80:95]
  s_add_u32 s57, s56, 147456
  buffer_load_dwordx4 v[52:55], v17, s[8:11], s57 offen offset:0
  s_mul_i32 s28, s27, 14336
  s_add_u32 s28, s28, 0
  v_add_u32 v24, s28, v17
  s_mul_i32 s28, s27, 6144
  s_add_u32 s28, s28, 90112
  v_add_u32 v12, s28, v17
  s_waitcnt vmcnt(11)
  v_mfma_f32_32x32x16_bf16 v[64:79], v[216:219], v[60:63], v[64:79]
  v_mfma_f32_32x32x16_bf16 v[80:95], v[220:223], v[60:63], v[80:95]
  buffer_load_dwordx4 v[56:59], v17, s[8:11], s57 offen offset:1024
  s_xor_b32 s27, s26, 1
  s_mul_i32 s28, s27, 14336
  s_add_u32 s28, s28, 2048
  v_add_u32 v25, s28, v17
  s_mul_i32 s28, s27, 6144
  s_add_u32 s28, s28, 90112
  ds_read_b128 v[112:115], v18 offset:0
  ds_read_b128 v[116:119], v19 offset:0
  s_waitcnt vmcnt(11)
  v_mfma_f32_32x32x16_bf16 v[64:79], v[224:227], v[240:243], v[64:79]
  v_mfma_f32_32x32x16_bf16 v[80:95], v[228:231], v[240:243], v[80:95]
  buffer_load_dwordx4 v[60:63], v17, s[8:11], s57 offen offset:2048
  v_add_u32 v13, s28, v17
  s_xor_b32 s27, s26, 2
  s_mul_i32 s28, s27, 14336
  s_add_u32 s28, s28, 4096
  v_add_u32 v26, s28, v17
  s_mul_i32 s28, s27, 6144
  ds_read_b128 v[120:123], v18 offset:2048
  ds_read_b128 v[124:127], v19 offset:2048
  s_waitcnt vmcnt(11)
  v_mfma_f32_32x32x16_bf16 v[64:79], v[232:235], v[244:247], v[64:79]
  v_mfma_f32_32x32x16_bf16 v[80:95], v[236:239], v[244:247], v[80:95]
  buffer_load_dwordx4 v[240:243], v17, s[8:11], s57 offen offset:3072
  s_add_u32 s28, s28, 92160
  v_add_u32 v14, s28, v17
  s_xor_b32 s27, s26, 3
  s_mul_i32 s28, s27, 14336
  s_add_u32 s28, s28, 6144
  v_add_u32 v27, s28, v17
  ds_read_b128 v[96:99], v18 offset:4096
  ds_read_b128 v[100:103], v19 offset:4096
  s_waitcnt vmcnt(11)
  s_waitcnt lgkmcnt(4)
  v_mfma_f32_32x32x16_bf16 v[64:79], v[112:115], v[248:251], v[64:79]
  v_mfma_f32_32x32x16_bf16 v[80:95], v[116:119], v[248:251], v[80:95]
  s_add_u32 s57, s56, 151552
  buffer_load_dwordx4 v[244:247], v17, s[8:11], s57 offen offset:0
  s_mul_i32 s28, s27, 6144
  s_add_u32 s28, s28, 94208
  v_add_u32 v15, s28, v17
  s_lshl_b32 s27, s26, 13
  s_add_u32 s27, s27, 57344
  v_add_u32 v30, s27, v17
  ds_read_b128 v[104:107], v20 offset:0
  ds_read_b128 v[108:111], v21 offset:0
  s_waitcnt vmcnt(11)
  s_waitcnt lgkmcnt(4)
  v_mfma_f32_32x32x16_bf16 v[64:79], v[120:123], v[252:255], v[64:79]
  v_mfma_f32_32x32x16_bf16 v[80:95], v[124:127], v[252:255], v[80:95]
  buffer_load_dwordx4 v[248:251], v17, s[8:11], s57 offen offset:1024
  s_mov_b32 s89, 0x3f803f80
  s_min_u32 s27, s7, 23
  s_mul_i32 s28, s27, 43
  s_lshr_b32 s28, s28, 8
  s_mul_i32 s28, s28, 6
  s_sub_u32 s27, s27, s28
  ds_read_b128 v[112:115], v20 offset:2048
  ds_read_b128 v[116:119], v21 offset:2048
  s_waitcnt vmcnt(11)
  s_waitcnt lgkmcnt(4)
  v_mfma_f32_32x32x16_bf16 v[64:79], v[96:99], v[32:35], v[64:79]
  v_mfma_f32_32x32x16_bf16 v[80:95], v[100:103], v[32:35], v[80:95]
  buffer_load_dwordx4 v[252:255], v17, s[8:11], s57 offen offset:2048
  s_and_b32 s28, s6, 1
  s_mul_i32 s28, s28, 6
  s_add_u32 s27, s27, s28
  s_lshl_b32 s28, s27, 8
  v_lshrrev_b32 v3, 4, v1
  v_and_b32 v4, 15, v1
  ds_read_b128 v[120:123], v20 offset:4096
  ds_read_b128 v[124:127], v21 offset:4096
  s_waitcnt vmcnt(11)
  s_waitcnt lgkmcnt(4)
  v_mfma_f32_32x32x16_bf16 v[64:79], v[104:107], v[36:39], v[64:79]
  v_mfma_f32_32x32x16_bf16 v[80:95], v[108:111], v[36:39], v[80:95]
  v_lshrrev_b32 v5, 2, v4
  v_xor_b32 v5, v5, v3
  v_and_b32 v4, 3, v4
  v_lshl_add_u32 v4, v5, 2, v4
  v_lshlrev_b32 v4, 4, v4
  v_mul_u32_u24 v3, 3072, v3
  ds_read_b128 v[96:99], v20 offset:6144
  ds_read_b128 v[100:103], v21 offset:6144
  s_waitcnt vmcnt(9)
  s_waitcnt lgkmcnt(4)
  v_mfma_f32_32x32x16_bf16 v[64:79], v[112:115], v[40:43], v[64:79]
  v_mfma_f32_32x32x16_bf16 v[80:95], v[116:119], v[40:43], v[80:95]
  v_add3_u32 v16, v3, v4, s28
  s_mul_i32 s91, s5, 12288
  s_lshl_b32 s90, s5, 10
  s_add_u32 s90, s90, 114688
  s_mov_b32 s12, s38
  s_and_b32 s13, s39, 0xffff
  ds_read_b128 v[104:107], v20 offset:8192
  ds_read_b128 v[108:111], v21 offset:8192
  s_waitcnt vmcnt(8)
  s_waitcnt lgkmcnt(4)
  v_mfma_f32_32x32x16_bf16 v[64:79], v[120:123], v[44:47], v[64:79]
  v_mfma_f32_32x32x16_bf16 v[80:95], v[124:127], v[44:47], v[80:95]
  s_mov_b32 s14, 1572864
  s_mov_b32 s15, 0x20000
  ds_read_b128 v[112:115], v20 offset:10240
  ds_read_b128 v[116:119], v21 offset:10240
  s_waitcnt vmcnt(7)
  s_waitcnt lgkmcnt(4)
  v_mfma_f32_32x32x16_bf16 v[64:79], v[96:99], v[48:51], v[64:79]
  v_mfma_f32_32x32x16_bf16 v[80:95], v[100:103], v[48:51], v[80:95]
  ds_read_b128 v[120:123], v20 offset:12288
  ds_read_b128 v[124:127], v21 offset:12288
  s_waitcnt vmcnt(6)
  s_waitcnt lgkmcnt(4)
  v_mfma_f32_32x32x16_bf16 v[64:79], v[104:107], v[52:55], v[64:79]
  v_mfma_f32_32x32x16_bf16 v[80:95], v[108:111], v[52:55], v[80:95]
  ds_read_b128 v[96:99], v20 offset:14336
  ds_read_b128 v[100:103], v21 offset:14336
  s_waitcnt vmcnt(5)
  s_waitcnt lgkmcnt(4)
  v_mfma_f32_32x32x16_bf16 v[64:79], v[112:115], v[56:59], v[64:79]
  v_mfma_f32_32x32x16_bf16 v[80:95], v[116:119], v[56:59], v[80:95]
  ds_read_b128 v[104:107], v22 offset:0
  ds_read_b128 v[108:111], v23 offset:0
  s_waitcnt vmcnt(4)
  s_waitcnt lgkmcnt(4)
  v_mfma_f32_32x32x16_bf16 v[64:79], v[120:123], v[60:63], v[64:79]
  v_mfma_f32_32x32x16_bf16 v[80:95], v[124:127], v[60:63], v[80:95]
  ds_read_b128 v[112:115], v22 offset:2048
  ds_read_b128 v[116:119], v23 offset:2048
  s_waitcnt vmcnt(3)
  s_waitcnt lgkmcnt(4)
  v_mfma_f32_32x32x16_bf16 v[64:79], v[96:99], v[240:243], v[64:79]
  v_mfma_f32_32x32x16_bf16 v[80:95], v[100:103], v[240:243], v[80:95]
  ds_read_b128 v[120:123], v22 offset:4096
  ds_read_b128 v[124:127], v23 offset:4096
  s_waitcnt vmcnt(2)
  s_waitcnt lgkmcnt(4)
  v_mfma_f32_32x32x16_bf16 v[64:79], v[104:107], v[244:247], v[64:79]
  v_mfma_f32_32x32x16_bf16 v[80:95], v[108:111], v[244:247], v[80:95]
  s_waitcnt lgkmcnt(0)
  ds_write_b32 v31, v31 offset:64
  s_mov_b32 s33, 0
L_dnf_lp:
  ds_read_b128 v[4:7], v2 offset:64
  s_add_u32 s33, s33, 1
  s_waitcnt lgkmcnt(0)
  v_min_u32 v4, v4, v5
  v_min3_u32 v4, v4, v6, v7
  s_nop 0
  v_readfirstlane_b32 s34, v4
  s_cmp_lg_u32 s34, 0
  s_cbranch_scc1 L_dnf_ld
  s_sleep 1
  s_cmp_lt_u32 s33, 262144
  s_cbranch_scc1 L_dnf_lp
L_dnf_ld:
  s_load_dwordx2 s[40:41], s[0:1], 32768 glc
  s_load_dwordx2 s[42:43], s[0:1], 32896 glc
  s_load_dwordx2 s[48:49], s[0:1], 33024 glc
  s_load_dwordx2 s[52:53], s[0:1], 33152 glc
  s_waitcnt vmcnt(1)
  v_mfma_f32_32x32x16_bf16 v[64:79], v[112:115], v[248:251], v[64:79]
  v_mfma_f32_32x32x16_bf16 v[80:95], v[116:119], v[248:251], v[80:95]
  s_waitcnt vmcnt(0)
  v_mfma_f32_32x32x16_bf16 v[64:79], v[120:123], v[252:255], v[64:79]
  v_mfma_f32_32x32x16_bf16 v[80:95], v[124:127], v[252:255], v[80:95]
  s_mov_b32 s33, 0
  s_branch L_dn1_sph
L_dn1_sp:
  s_load_dwordx2 s[40:41], s[0:1], 32768 glc
  s_load_dwordx2 s[42:43], s[0:1], 32896 glc
  s_load_dwordx2 s[48:49], s[0:1], 33024 glc
  s_load_dwordx2 s[52:53], s[0:1], 33152 glc
L_dn1_sph:
  s_waitcnt lgkmcnt(0)
  s_xor_b64 s[40:41], s[40:41], s[76:77]
  s_xor_b64 s[42:43], s[42:43], s[76:77]
  s_xor_b64 s[48:49], s[48:49], s[76:77]
  s_xor_b64 s[52:53], s[52:53], s[76:77]
  s_or_b64 s[40:41], s[40:41], s[42:43]
  s_or_b64 s[40:41], s[40:41], s[48:49]
  s_or_b64 s[40:41], s[40:41], s[52:53]
  s_cbranch_scc0 L_dn1_spd
  s_add_u32 s33, s33, 1
  s_sleep 1
  s_cmp_lt_u32 s33, 16384
  s_cbranch_scc1 L_dn1_sp
L_dn1_spd:
  s_add_u32 s57, s56, 1048576
  buffer_load_dwordx4 v[32:35], v17, s[8:11], s57 offen offset:0
  buffer_load_dwordx4 v[36:39], v17, s[8:11], s57 offen offset:1024
  buffer_load_dwordx4 v[40:43], v17, s[8:11], s57 offen offset:2048
  buffer_load_dwordx4 v[44:47], v17, s[8:11], s57 offen offset:3072
  s_add_u32 s57, s56, 1052672
  buffer_load_dwordx4 v[48:51], v17, s[8:11], s57 offen offset:0
  buffer_load_dwordx4 v[52:55], v17, s[8:11], s57 offen offset:1024
  buffer_load_dwordx4 v[56:59], v17, s[8:11], s57 offen offset:2048
  s_add_u32 s57, s56, 1064960
  buffer_load_dwordx4 v[60:63], v17, s[8:11], s57 offen offset:0
  buffer_load_dwordx4 v[240:243], v17, s[8:11], s57 offen offset:1024
  buffer_load_dwordx4 v[244:247], v17, s[8:11], s57 offen offset:2048
  buffer_load_dwordx4 v[248:251], v17, s[8:11], s57 offen offset:3072
  s_add_u32 s57, s56, 1069056
  buffer_load_dwordx4 v[252:255], v17, s[8:11], s57 offen offset:0
  v_lshlrev_b32 v96, 16, v8
  v_and_b32 v97, 0xffff0000, v8
  v_lshlrev_b32 v98, 16, v9
  v_and_b32 v99, 0xffff0000, v9
  v_lshlrev_b32 v100, 16, v10
  v_and_b32 v101, 0xffff0000, v10
  v_lshlrev_b32 v102, 16, v11
  v_and_b32 v103, 0xffff0000, v11
  ds_write_b128 v13, v[72:75] offset:0
  ds_write_b128 v13, v[76:79] offset:1024
  ds_write_b128 v14, v[80:83] offset:0
  ds_write_b128 v14, v[84:87] offset:1024
  ds_write_b128 v15, v[88:91] offset:0
  ds_write_b128 v15, v[92:95] offset:1024
  v_pk_add_f32 v[64:65], v[64:65], v[96:97]
  v_pk_add_f32 v[66:67], v[66:67], v[98:99]
  v_pk_add_f32 v[68:69], v[68:69], v[100:101]
  v_pk_add_f32 v[70:71], v[70:71], v[102:103]
L_dn_p2:
  v_mov_b32 v2, 132176
  v_mov_b32 v3, 132192
  s_mov_b32 s33, 0
L_dng_lp:
  ds_read_b128 v[4:7], v3 offset:0
  s_add_u32 s33, s33, 1
  s_waitcnt lgkmcnt(0)
  v_min_u32 v4, v4, v5
  v_min3_u32 v4, v4, v6, v7
  s_nop 0
  v_readfirstlane_b32 s34, v4
  s_cmp_lg_u32 s34, 0
  s_cbranch_scc1 L_dng_ld
  s_sleep 1
  s_cmp_lt_u32 s33, 262144
  s_cbranch_scc1 L_dng_lp
L_dng_ld:
  s_lshl_b32 s27, s4, 5
  s_add_u32 s27, s27, s7
  s_cmp_ge_u32 s27, 24
  s_cbranch_scc1 L_dn_nq
  s_waitcnt vmcnt(11)
  v_mfma_f32_32x32x16_bf16 v[112:127], v[132:135], v[32:35], 0
  v_mfma_f32_32x32x16_bf16 v[96:111], v[128:131], v[32:35], 0
  s_waitcnt vmcnt(10)
  v_mfma_f32_32x32x16_bf16 v[112:127], v[140:143], v[36:39], v[112:127]
  v_mfma_f32_32x32x16_bf16 v[96:111], v[136:139], v[36:39], v[96:111]
  s_add_u32 s57, s56, 1069056
  buffer_load_dwordx4 v[32:35], v17, s[8:11], s57 offen offset:1024
  s_waitcnt vmcnt(10)
  v_mfma_f32_32x32x16_bf16 v[112:127], v[148:151], v[40:43], v[112:127]
  v_mfma_f32_32x32x16_bf16 v[96:111], v[144:147], v[40:43], v[96:111]
  buffer_load_dwordx4 v[36:39], v17, s[8:11], s57 offen offset:2048
  s_waitcnt vmcnt(10)
  v_mfma_f32_32x32x16_bf16 v[112:127], v[156:159], v[44:47], v[112:127]
  v_mfma_f32_32x32x16_bf16 v[96:111], v[152:155], v[44:47], v[96:111]
  s_mov_b32 s33, 0
L_dnh1_lp:
  ds_read_b128 v[4:7], v2 offset:0
  s_add_u32 s33, s33, 1
  s_waitcnt lgkmcnt(0)
  v_min_u32 v4, v4, v5
  v_min3_u32 v4, v4, v6, v7
  s_nop 0
  v_readfirstlane_b32 s34, v4
  s_cmp_lg_u32 s34, 0
  s_cbranch_scc1 L_dnh1_ld
  s_sleep 1
  s_cmp_lt_u32 s33, 262144
  s_cbranch_scc1 L_dnh1_lp
L_dnh1_ld:
  s_add_u32 m0, s90, 0
  s_add_u32 s34, s91, 0
  buffer_load_dwordx4 v16, s[12:15], s34 offen lds
  s_waitcnt vmcnt(10)
  v_mfma_f32_32x32x16_bf16 v[112:127], v[164:167], v[48:51], v[112:127]
  v_mfma_f32_32x32x16_bf16 v[96:111], v[160:163], v[48:51], v[96:111]
  s_add_u32 m0, s90, 8192
  s_add_u32 s34, s91, 98304
  buffer_load_dwordx4 v16, s[12:15], s34 offen lds
  s_waitcnt vmcnt(10)
  v_mfma_f32_32x32x16_bf16 v[112:127], v[172:175], v[52:55], v[112:127]
  v_mfma_f32_32x32x16_bf16 v[96:111], v[168:171], v[52:55], v[96:111]
  s_add_u32 m0, s90, 24576
  s_add_u32 s34, s91, 294912
  buffer_load_dwordx4 v16, s[12:15], s34 offen lds
  s_waitcnt vmcnt(10)
  v_mfma_f32_32x32x16_bf16 v[112:127], v[180:183], v[56:59], v[112:127]
  v_mfma_f32_32x32x16_bf16 v[96:111], v[176:179], v[56:59], v[96:111]
  s_add_u32 m0, s90, 32768
  s_add_u32 s34, s91, 393216
  buffer_load_dwordx4 v16, s[12:15], s34 offen lds
  s_waitcnt vmcnt(10)
  v_mfma_f32_32x32x16_bf16 v[112:127], v[188:191], v[60:63], v[112:127]
  v_mfma_f32_32x32x16_bf16 v[96:111], v[184:187], v[60:63], v[96:111]
  s_add_u32 m0, s90, 40960
  s_add_u32 s34, s91, 491520
  buffer_load_dwordx4 v16, s[12:15], s34 offen lds
  s_waitcnt vmcnt(10)
  v_mfma_f32_32x32x16_bf16 v[112:127], v[196:199], v[240:243], v[112:127]
  v_mfma_f32_32x32x16_bf16 v[96:111], v[192:195], v[240:243], v[96:111]
  s_waitcnt vmcnt(9)
  v_mfma_f32_32x32x16_bf16 v[112:127], v[204:207], v[244:247], v[112:127]
  v_mfma_f32_32x32x16_bf16 v[96:111], v[200:203], v[244:247], v[96:111]
  s_waitcnt vmcnt(8)
  v_mfma_f32_32x32x16_bf16 v[112:127], v[212:215], v[248:251], v[112:127]
  v_mfma_f32_32x32x16_bf16 v[96:111], v[208:211], v[248:251], v[96:111]
  s_waitcnt vmcnt(7)
  v_mfma_f32_32x32x16_bf16 v[112:127], v[220:223], v[252:255], v[112:127]
  v_mfma_f32_32x32x16_bf16 v[96:111], v[216:219], v[252:255], v[96:111]
  s_waitcnt vmcnt(6)
  v_mfma_f32_32x32x16_bf16 v[112:127], v[228:231], v[32:35], v[112:127]
  v_mfma_f32_32x32x16_bf16 v[96:111], v[224:227], v[32:35], v[96:111]
  s_waitcnt vmcnt(5)
  v_mfma_f32_32x32x16_bf16 v[112:127], v[236:239], v[36:39], v[112:127]
  v_mfma_f32_32x32x16_bf16 v[96:111], v[232:235], v[36:39], v[96:111]
  s_branch L_dn_mq
L_dn_nq:
  s_waitcnt vmcnt(11)
  v_mfma_f32_32x32x16_bf16 v[112:127], v[132:135], v[32:35], 0
  v_mfma_f32_32x32x16_bf16 v[96:111], v[128:131], v[32:35], 0
  s_waitcnt vmcnt(10)
  v_mfma_f32_32x32x16_bf16 v[112:127], v[140:143], v[36:39], v[112:127]
  v_mfma_f32_32x32x16_bf16 v[96:111], v[136:139], v[36:39], v[96:111]
  s_add_u32 s57, s56, 1069056
  buffer_load_dwordx4 v[32:35], v17, s[8:11], s57 offen offset:1024
  s_waitcnt vmcnt(10)
  v_mfma_f32_32x32x16_bf16 v[112:127], v[148:151], v[40:43], v[112:127]
  v_mfma_f32_32x32x16_bf16 v[96:111], v[144:147], v[40:43], v[96:111]
  buffer_load_dwordx4 v[36:39], v17, s[8:11], s57 offen offset:2048
  s_waitcnt vmcnt(10)
  v_mfma_f32_32x32x16_bf16 v[112:127], v[156:159], v[44:47], v[112:127]
  v_mfma_f32_32x32x16_bf16 v[96:111], v[152:155], v[44:47], v[96:111]
  s_mov_b32 s33, 0
L_dnh0_lp:
  ds_read_b128 v[4:7], v2 offset:0
  s_add_u32 s33, s33, 1
  s_waitcnt lgkmcnt(0)
  v_min_u32 v4, v4, v5
  v_min3_u32 v4, v4, v6, v7
  s_nop 0
  v_readfirstlane_b32 s34, v4
  s_cmp_lg_u32 s34, 0
  s_cbranch_scc1 L_dnh0_ld
  s_sleep 1
  s_cmp_lt_u32 s33, 262144
  s_cbranch_scc1 L_dnh0_lp
L_dnh0_ld:
  s_waitcnt vmcnt(9)
  v_mfma_f32_32x32x16_bf16 v[112:127], v[164:167], v[48:51], v[112:127]
  v_mfma_f32_32x32x16_bf16 v[96:111], v[160:163], v[48:51], v[96:111]
  s_waitcnt vmcnt(8)
  v_mfma_f32_32x32x16_bf16 v[112:127], v[172:175], v[52:55], v[112:127]
  v_mfma_f32_32x32x16_bf16 v[96:111], v[168:171], v[52:55], v[96:111]
  s_waitcnt vmcnt(7)
  v_mfma_f32_32x32x16_bf16 v[112:127], v[180:183], v[56:59], v[112:127]
  v_mfma_f32_32x32x16_bf16 v[96:111], v[176:179], v[56:59], v[96:111]
  s_waitcnt vmcnt(6)
  v_mfma_f32_32x32x16_bf16 v[112:127], v[188:191], v[60:63], v[112:127]
  v_mfma_f32_32x32x16_bf16 v[96:111], v[184:187], v[60:63], v[96:111]
  s_waitcnt vmcnt(5)
  v_mfma_f32_32x32x16_bf16 v[112:127], v[196:199], v[240:243], v[112:127]
  v_mfma_f32_32x32x16_bf16 v[96:111], v[192:195], v[240:243], v[96:111]
  s_waitcnt vmcnt(4)
  v_mfma_f32_32x32x16_bf16 v[112:127], v[204:207], v[244:247], v[112:127]
  v_mfma_f32_32x32x16_bf16 v[96:111], v[200:203], v[244:247], v[96:111]
  s_waitcnt vmcnt(3)
  v_mfma_f32_32x32x16_bf16 v[112:127], v[212:215], v[248:251], v[112:127]
  v_mfma_f32_32x32x16_bf16 v[96:111], v[208:211], v[248:251], v[96:111]
  s_waitcnt vmcnt(2)
  v_mfma_f32_32x32x16_bf16 v[112:127], v[220:223], v[252:255], v[112:127]
  v_mfma_f32_32x32x16_bf16 v[96:111], v[216:219], v[252:255], v[96:111]
  s_waitcnt vmcnt(1)
  v_mfma_f32_32x32x16_bf16 v[112:127], v[228:231], v[32:35], v[112:127]
  v_mfma_f32_32x32x16_bf16 v[96:111], v[224:227], v[32:35], v[96:111]
  s_waitcnt vmcnt(0)
  v_mfma_f32_32x32x16_bf16 v[112:127], v[236:239], v[36:39], v[112:127]
  v_mfma_f32_32x32x16_bf16 v[96:111], v[232:235], v[36:39], v[96:111]
L_dn_mq:
  v_lshlrev_b32 v40, 16, v8
  v_and_b32 v41, 0xffff0000, v8
  v_lshlrev_b32 v42, 16, v9
  v_and_b32 v43, 0xffff0000, v9
  v_lshlrev_b32 v44, 16, v10
  v_and_b32 v45, 0xffff0000, v10
  v_lshlrev_b32 v46, 16, v11
  v_and_b32 v47, 0xffff0000, v11
  s_nop 7
  ds_write_b128 v25, v[104:107] offset:0
  ds_write_b128 v25, v[108:111] offset:1024
  ds_write_b128 v26, v[112:115] offset:0
  ds_write_b128 v26, v[116:119] offset:1024
  ds_write_b128 v27, v[120:123] offset:0
  ds_write_b128 v27, v[124:127] offset:1024
  s_cmp_ge_u32 s5, 4
  s_cbranch_scc1 L_dn_redB
  ds_write_b128 v24, v[96:99] offset:0
  ds_write_b128 v24, v[100:103] offset:1024
  s_waitcnt lgkmcnt(0)
  s_barrier
  ds_read_b128 v[128:131], v12 offset:0
  ds_read_b128 v[132:135], v12 offset:1024
  ds_read_b128 v[136:139], v12 offset:2048
  ds_read_b128 v[140:143], v12 offset:3072
  ds_read_b128 v[144:147], v12 offset:4096
  ds_read_b128 v[148:151], v12 offset:5120
  s_cmp_ge_u32 s27, 24
  s_cbranch_scc1 L_dn_qlA
  s_add_u32 m0, s90, 16384
  s_add_u32 s34, s91, 196608
  buffer_load_dwordx4 v16, s[12:15], s34 offen lds
L_dn_qlA:
  s_waitcnt lgkmcnt(4)
  v_pk_add_f32 v[64:65], v[64:65], v[128:129]
  v_pk_add_f32 v[66:67], v[66:67], v[130:131]
  v_pk_add_f32 v[68:69], v[68:69], v[132:133]
  v_pk_add_f32 v[70:71], v[70:71], v[134:135]
  s_waitcnt lgkmcnt(2)
  v_pk_add_f32 v[64:65], v[64:65], v[136:137]
  v_pk_add_f32 v[66:67], v[66:67], v[138:139]
  v_pk_add_f32 v[68:69], v[68:69], v[140:141]
  v_pk_add_f32 v[70:71], v[70:71], v[142:143]
  s_waitcnt lgkmcnt(0)
  v_pk_add_f32 v[64:65], v[64:65], v[144:145]
  v_pk_add_f32 v[66:67], v[66:67], v[146:147]
  v_pk_add_f32 v[68:69], v[68:69], v[148:149]
  v_pk_add_f32 v[70:71], v[70:71], v[150:151]
  v_cvt_pk_bf16_f32 v72, v64, v65
  v_cvt_pk_bf16_f32 v73, v66, v67
  v_cvt_pk_bf16_f32 v74, v68, v69
  v_cvt_pk_bf16_f32 v75, v70, v71
  s_cmp_eq_u32 s4, 1
  s_cbranch_scc1 L_dn_finalA
  buffer_store_dwordx4 v[72:75], v17, s[8:11], s84 offen sc1
  v_mov_b32 v2, 0
  v_mov_b32 v3, 0
  v_mov_b32 v4, 0
  v_mov_b32 v5, 0
  v_dot2_f32_bf16 v2, v72, s89, v2
  v_dot2_f32_bf16 v3, v72, v72, v3
  v_dot2_f32_bf16 v4, v73, s89, v4
  v_dot2_f32_bf16 v5, v73, v73, v5
  v_dot2_f32_bf16 v2, v74, s89, v2
  v_dot2_f32_bf16 v3, v74, v74, v3
  v_dot2_f32_bf16 v4, v75, s89, v4
  v_dot2_f32_bf16 v5, v75, v75, v5
  s_nop 2
  v_pk_add_f32 v[2:3], v[2:3], v[4:5]
  s_nop 0
  v_mov_b32 v4, v2
  v_mov_b32 v5, v3
  s_nop 1
  v_permlane32_swap_b32 v2, v4
  v_permlane32_swap_b32 v3, v5
  s_nop 1
  v_pk_add_f32 v[2:3], v[2:3], v[4:5]
  buffer_store_dwordx2 v[2:3], v29, s[8:11], s85 offen sc1
  s_branch L_dn_pub
L_dn_finalA:
  s_nop 1
  v_permlane32_swap_b32 v72, v74
  v_permlane32_swap_b32 v73, v75
  buffer_store_dwordx4 v[72:75], v28, s[20:23], s86 offen
  s_branch L_dn_end
L_dn_redB:
  v_add_f32 v40, v40, v96
  v_add_f32 v41, v41, v97
  v_add_f32 v42, v42, v98
  v_add_f32 v43, v43, v99
  v_add_f32 v44, v44, v100
  v_add_f32 v45, v45, v101
  v_add_f32 v46, v46, v102
  v_add_f32 v47, v47, v103
  s_waitcnt lgkmcnt(0)
  s_barrier
  ds_read_b128 v[128:131], v24 offset:0
  ds_read_b128 v[132:135], v24 offset:1024
  ds_read_b128 v[136:139], v24 offset:2048
  ds_read_b128 v[140:143], v24 offset:3072
  ds_read_b128 v[144:147], v24 offset:4096
  ds_read_b128 v[148:151], v24 offset:5120
  ds_read_b128 v[152:155], v24 offset:6144
  ds_read_b128 v[156:159], v24 offset:7168
  ds_read_b128 v[160:163], v24 offset:8192
  ds_read_b128 v[164:167], v24 offset:9216
  ds_read_b128 v[168:171], v24 offset:10240
  ds_read_b128 v[172:175], v24 offset:11264
  ds_read_b128 v[176:179], v24 offset:12288
  ds_read_b128 v[180:183], v24 offset:13312
  s_cmp_ge_u32 s27, 24
  s_cbranch_scc1 L_dn_qlB
  s_add_u32 m0, s90, 16384
  s_add_u32 s34, s91, 196608
  buffer_load_dwordx4 v16, s[12:15], s34 offen lds
L_dn_qlB:
  s_waitcnt lgkmcnt(12)
  v_pk_add_f32 v[40:41], v[40:41], v[128:129]
  v_pk_add_f32 v[42:43], v[42:43], v[130:131]
  v_pk_add_f32 v[44:45], v[44:45], v[132:133]
  v_pk_add_f32 v[46:47], v[46:47], v[134:135]
  s_waitcnt lgkmcnt(10)
  v_pk_add_f32 v[40:41], v[40:41], v[136:137]
  v_pk_add_f32 v[42:43], v[42:43], v[138:139]
  v_pk_add_f32 v[44:45], v[44:45], v[140:141]
  v_pk_add_f32 v[46:47], v[46:47], v[142:143]
  s_waitcnt lgkmcnt(8)
  v_pk_add_f32 v[40:41], v[40:41], v[144:145]
  v_pk_add_f32 v[42:43], v[42:43], v[146:147]
  v_pk_add_f32 v[44:45], v[44:45], v[148:149]
  v_pk_add_f32 v[46:47], v[46:47], v[150:151]
  s_waitcnt lgkmcnt(6)
  v_pk_add_f32 v[40:41], v[40:41], v[152:153]
  v_pk_add_f32 v[42:43], v[42:43], v[154:155]
  v_pk_add_f32 v[44:45], v[44:45], v[156:157]
  v_pk_add_f32 v[46:47], v[46:47], v[158:159]
  s_waitcnt lgkmcnt(4)
  v_pk_add_f32 v[40:41], v[40:41], v[160:161]
  v_pk_add_f32 v[42:43], v[42:43], v[162:163]
  v_pk_add_f32 v[44:45], v[44:45], v[164:165]
  v_pk_add_f32 v[46:47], v[46:47], v[166:167]
  s_waitcnt lgkmcnt(2)
  v_pk_add_f32 v[40:41], v[40:41], v[168:169]
  v_pk_add_f32 v[42:43], v[42:43], v[170:171]
  v_pk_add_f32 v[44:45], v[44:45], v[172:173]
  v_pk_add_f32 v[46:47], v[46:47], v[174:175]
  s_waitcnt lgkmcnt(0)
  v_pk_add_f32 v[40:41], v[40:41], v[176:177]
  v_pk_add_f32 v[42:43], v[42:43], v[178:179]
  v_pk_add_f32 v[44:45], v[44:45], v[180:181]
  v_pk_add_f32 v[46:47], v[46:47], v[182:183]
  v_cvt_pk_bf16_f32 v32, v40, v41
  v_cvt_pk_bf16_f32 v33, v42, v43
  v_cvt_pk_bf16_f32 v34, v44, v45
  v_cvt_pk_bf16_f32 v35, v46, v47
  s_cmp_eq_u32 s4, 1
  s_cbranch_scc1 L_dn_finalB
  buffer_store_dwordx4 v[32:35], v17, s[8:11], s84 offen sc1
  v_mov_b32 v2, 0
  v_mov_b32 v3, 0
  v_mov_b32 v4, 0
  v_mov_b32 v5, 0
  v_dot2_f32_bf16 v2, v32, s89, v2
  v_dot2_f32_bf16 v3, v32, v32, v3
  v_dot2_f32_bf16 v4, v33, s89, v4
  v_dot2_f32_bf16 v5, v33, v33, v5
  v_dot2_f32_bf16 v2, v34, s89, v2
  v_dot2_f32_bf16 v3, v34, v34, v3
  v_dot2_f32_bf16 v4, v35, s89, v4
  v_dot2_f32_bf16 v5, v35, v35, v5
  s_nop 2
  v_pk_add_f32 v[2:3], v[2:3], v[4:5]
  s_nop 0
  v_mov_b32 v4, v2
  v_mov_b32 v5, v3
  s_nop 1
  v_permlane32_swap_b32 v2, v4
  v_permlane32_swap_b32 v3, v5
  s_nop 1
  v_pk_add_f32 v[2:3], v[2:3], v[4:5]
  buffer_store_dwordx2 v[2:3], v29, s[8:11], s85 offen sc1
  s_branch L_dn_pub
L_dn_finalB:
  s_nop 1
  v_permlane32_swap_b32 v32, v34
  v_permlane32_swap_b32 v33, v35
  buffer_store_dwordx4 v[32:35], v28, s[20:23], s86 offen
L_dn_end:
  s_endpgm
L_dn_pub:
  s_mov_b32 s78, -1
  s_cmp_ge_u32 s7, 24
  s_cbranch_scc1 L_mqkv_skip
  s_mul_i32 s24, s7, 43
  s_lshr_b32 s24, s24, 8
  s_mul_i32 s25, s24, 6
  s_sub_u32 s25, s7, s25
  s_lshr_b32 s26, s6, 1
  s_lshl_b32 s26, s26, 2
  s_add_u32 s24, s24, s26
  s_and_b32 s26, s6, 1
  s_mul_i32 s26, s26, 6
  s_add_u32 s25, s25, s26
  s_lshl_b32 s27, s24, 2
  s_cmp_ge_u32 s5, 4
  s_cbranch_scc1 L_mqkv_B
  s_lshr_b32 s78, s24, 1
  s_lshl_b32 s78, s78, 5
  s_and_b32 s28, s24, 1
  s_mul_i32 s28, s28, 12
  s_add_u32 s78, s78, s28
  s_add_u32 s78, s78, s25
  s_and_b32 s62, s78, 127
  s_and_b32 s78, s62, 63
  s_lshl_b32 s78, s78, 7
  s_lshr_b32 s63, s62, 6
  s_lshl_b32 s63, s63, 14
  s_add_u32 s78, s78, s63
  s_xor_b32 s63, s94, 0x2000
  s_add_u32 s78, s78, s63
  s_add_u32 s78, s78, s95
  s_add_u32 s78, s78, 524288
  s_add_u32 s27, s27, s5
  v_lshlrev_b32 v17, 4, v1
  s_and_b32 s27, s27, 31
  s_lshl_b32 s29, s27, 16
  s_add_u32 s29, s29, s3
  s_add_u32 s29, s29, s94
  s_add_u32 s29, s29, 20971520
  v_and_b32 v3, 15, v1
  v_lshrrev_b32 v4, 2, v3
  v_and_b32 v5, 3, v3
  v_bfe_u32 v6, v1, 4, 1
  v_lshrrev_b32 v7, 5, v1
  v_lshl_add_u32 v8, v7, 2, v4
  v_mul_u32_u24 v8, 256, v8
  v_lshlrev_b32 v9, 5, v6
  v_lshl_add_u32 v9, v5, 3, v9
  v_add_u32 v8, v8, v9
  v_xor_b32 v9, 0, v4
  v_lshl_add_u32 v18, v9, 6, v8
  v_add_u32 v18, 114688, v18
  v_xor_b32 v9, 1, v4
  v_lshl_add_u32 v19, v9, 6, v8
  v_add_u32 v19, 114688, v19
  v_xor_b32 v9, 2, v4
  v_lshl_add_u32 v20, v9, 6, v8
  v_add_u32 v20, 114688, v20
  v_xor_b32 v9, 3, v4
  v_lshl_add_u32 v21, v9, 6, v8
  v_add_u32 v21, 114688, v21
  s_lshl_b32 s62, s27, 6
  s_and_b32 s30, s62, 63
  s_lshl_b32 s30, s30, 7
  s_lshr_b32 s63, s62, 6
  s_lshl_b32 s63, s63, 14
  s_add_u32 s30, s30, s63
  s_xor_b32 s63, s94, 0x2000
  s_add_u32 s30, s30, s63
  s_add_u32 s30, s30, s3
  s_add_u32 s30, s30, 19136512
  v_and_b32 v11, 31, v1
  v_lshlrev_b32 v12, 3, v11
  v_lshl_add_u32 v12, v7, 12, v12
  v_lshlrev_b32 v10, 4, v11
  s_mov_b32 s90, -1
  s_mov_b32 s91, 0
  s_mul_i32 s35, s24, 12
  s_add_u32 s35, s35, s25
  s_lshl_b32 s35, s35, 11
  s_add_u32 s35, s35, 19988480
  s_lshr_b32 s84, s25, 2
  s_lshl_b32 s84, s84, 22
  s_and_b32 s85, s25, 3
  s_lshl_b32 s85, s85, 14
  s_add_u32 s84, s84, s85
  s_lshl_b32 s85, s27, 16
  s_add_u32 s84, s84, s85
  s_add_u32 s84, s84, s3
  s_add_u32 s84, s84, s94
  s_add_u32 s84, s84, 33554432
  s_add_u32 s85, s84, 4096
  v_bfe_u32 v13, v1, 4, 1
  v_lshlrev_b32 v13, 10, v13
  v_lshl_add_u32 v13, v7, 8, v13
  v_and_b32 v4, 15, v1
  v_lshl_add_u32 v13, v4, 4, v13
  s_mov_b32 s92, 0x3eb8aa3b
  s_cmp_lt_u32 s25, 4
  s_cselect_b32 s92, s92, 1.0
  s_lshl_b32 s93, s5, 7
  s_add_u32 s93, s93, 131072
  s_lshr_b32 s28, s24, 1
  s_lshl_b32 s28, s28, 5
  s_and_b32 s62, s28, 127
  s_and_b32 s33, s62, 63
  s_lshl_b32 s33, s33, 7
  s_lshr_b32 s63, s62, 6
  s_lshl_b32 s63, s63, 14
  s_add_u32 s33, s33, s63
  s_xor_b32 s63, s94, 0x2000
  s_add_u32 s33, s33, s63
  s_add_u32 s33, s33, s95
  s_add_u32 s33, s33, 131072
  v_lshl_add_u32 v2, v1, 7, s33
  v_mov_b32 v4, s76
  v_mov_b32 v5, s77
  s_cmp_lg_u32 s5, 0
  s_mov_b64 exec, 1
  s_waitcnt vmcnt(0) lgkmcnt(0)
  s_barrier
  s_cbranch_scc1 L_pub_33
  buffer_store_dwordx2 v[4:5], off, s[8:11], s83 sc1
L_pub_33:
  s_mov_b64 exec, -1
  s_cmp_lg_u32 s5, 1
  s_cbranch_scc1 L_mqkv_wait
  s_mov_b32 exec_hi, 0
  s_mov_b32 s33, 0
  s_sleep 8
L_mqkv_poll:
  buffer_load_dwordx2 v[4:5], v2, s[8:11], 0 offen sc1
  s_waitcnt vmcnt(0)
  v_cmp_ne_u64 vcc, s[76:77], v[4:5]
  s_add_u32 s33, s33, 1
  s_cbranch_vccz L_mqkv_polled
  s_sleep 1
  s_cmp_lt_u32 s33, 16384
  s_cbranch_scc1 L_mqkv_poll
L_mqkv_polled:
  s_mov_b64 exec, -1
L_mqkv_wait:
  s_barrier
  s_cmp_ge_u32 s25, 8
  s_cbranch_scc1 L_mqkv_v
  s_add_u32 s34, s29, 0
  buffer_load_dwordx4 v[128:131], v17, s[8:11], s34 offen offset:0
  buffer_load_dwordx4 v[132:135], v17, s[8:11], s34 offen offset:1024
  buffer_load_dwordx4 v[136:139], v17, s[8:11], s34 offen offset:2048
  buffer_load_dwordx4 v[140:143], v17, s[8:11], s34 offen offset:3072
  s_add_u32 s34, s29, 4096
  buffer_load_dwordx4 v[144:147], v17, s[8:11], s34 offen offset:0
  buffer_load_dwordx4 v[148:151], v17, s[8:11], s34 offen offset:1024
  ds_read_b64_tr_b16 v[32:33], v18 offset:0
  ds_read_b64_tr_b16 v[34:35], v18 offset:2048
  ds_read_b64_tr_b16 v[36:37], v19 offset:0
  ds_read_b64_tr_b16 v[38:39], v19 offset:2048
  ds_read_b64_tr_b16 v[40:41], v20 offset:0
  ds_read_b64_tr_b16 v[42:43], v20 offset:2048
  ds_read_b64_tr_b16 v[44:45], v21 offset:0
  ds_read_b64_tr_b16 v[46:47], v21 offset:2048
  s_waitcnt vmcnt(5)
  s_waitcnt lgkmcnt(6)
  v_mfma_f32_32x32x16_bf16 v[64:79], v[32:35], v[128:131], 0
  ds_read_b64_tr_b16 v[48:49], v18 offset:4096
  ds_read_b64_tr_b16 v[50:51], v18 offset:6144
  s_waitcnt lgkmcnt(6)
  v_mfma_f32_32x32x16_bf16 v[80:95], v[36:39], v[128:131], 0
  ds_read_b64_tr_b16 v[52:53], v19 offset:4096
  ds_read_b64_tr_b16 v[54:55], v19 offset:6144
  buffer_load_dwordx4 v[152:155], v17, s[8:11], s34 offen offset:2048
  s_waitcnt lgkmcnt(6)
  v_mfma_f32_32x32x16_bf16 v[96:111], v[40:43], v[128:131], 0
  ds_read_b64_tr_b16 v[56:57], v20 offset:4096
  ds_read_b64_tr_b16 v[58:59], v20 offset:6144
  s_waitcnt lgkmcnt(6)
  v_mfma_f32_32x32x16_bf16 v[112:127], v[44:47], v[128:131], 0
  ds_read_b64_tr_b16 v[60:61], v21 offset:4096
  ds_read_b64_tr_b16 v[62:63], v21 offset:6144
  buffer_load_dwordx4 v[156:159], v17, s[8:11], s34 offen offset:3072
  s_waitcnt lgkmcnt(6)
  s_waitcnt vmcnt(6)
  v_mfma_f32_32x32x16_bf16 v[64:79], v[48:51], v[132:135], v[64:79]
  ds_read_b64_tr_b16 v[32:33], v18 offset:8192
  ds_read_b64_tr_b16 v[34:35], v18 offset:10240
  s_waitcnt lgkmcnt(6)
  v_mfma_f32_32x32x16_bf16 v[80:95], v[52:55], v[132:135], v[80:95]
  ds_read_b64_tr_b16 v[36:37], v19 offset:8192
  ds_read_b64_tr_b16 v[38:39], v19 offset:10240
  s_add_u32 s34, s29, 16384
  buffer_load_dwordx4 v[160:163], v17, s[8:11], s34 offen offset:0
  s_waitcnt lgkmcnt(6)
  v_mfma_f32_32x32x16_bf16 v[96:111], v[56:59], v[132:135], v[96:111]
  ds_read_b64_tr_b16 v[40:41], v20 offset:8192
  ds_read_b64_tr_b16 v[42:43], v20 offset:10240
  s_waitcnt lgkmcnt(6)
  v_mfma_f32_32x32x16_bf16 v[112:127], v[60:63], v[132:135], v[112:127]
  ds_read_b64_tr_b16 v[44:45], v21 offset:8192
  ds_read_b64_tr_b16 v[46:47], v21 offset:10240
  buffer_load_dwordx4 v[164:167], v17, s[8:11], s34 offen offset:1024
  s_waitcnt lgkmcnt(6)
  s_waitcnt vmcnt(7)
  v_mfma_f32_32x32x16_bf16 v[64:79], v[32:35], v[136:139], v[64:79]
  ds_read_b64_tr_b16 v[48:49], v18 offset:12288
  ds_read_b64_tr_b16 v[50:51], v18 offset:14336
  s_waitcnt lgkmcnt(6)
  v_mfma_f32_32x32x16_bf16 v[80:95], v[36:39], v[136:139], v[80:95]
  ds_read_b64_tr_b16 v[52:53], v19 offset:12288
  ds_read_b64_tr_b16 v[54:55], v19 offset:14336
  buffer_load_dwordx4 v[168:171], v17, s[8:11], s34 offen offset:2048
  s_waitcnt lgkmcnt(6)
  v_mfma_f32_32x32x16_bf16 v[96:111], v[40:43], v[136:139], v[96:111]
  ds_read_b64_tr_b16 v[56:57], v20 offset:12288
  ds_read_b64_tr_b16 v[58:59], v20 offset:14336
  buffer_load_dwordx4 v[172:175], v17, s[8:11], s34 offen offset:3072
  s_waitcnt lgkmcnt(6)
  v_mfma_f32_32x32x16_bf16 v[112:127], v[44:47], v[136:139], v[112:127]
  ds_read_b64_tr_b16 v[60:61], v21 offset:12288
  ds_read_b64_tr_b16 v[62:63], v21 offset:14336
  buffer_load_dwordx2 v[128:129], v12, s[8:11], s30 offen offset:0
  s_waitcnt lgkmcnt(6)
  s_waitcnt vmcnt(9)
  v_mfma_f32_32x32x16_bf16 v[64:79], v[48:51], v[140:143], v[64:79]
  ds_read_b64_tr_b16 v[32:33], v18 offset:16384
  ds_read_b64_tr_b16 v[34:35], v18 offset:18432
  s_waitcnt lgkmcnt(6)
  v_mfma_f32_32x32x16_bf16 v[80:95], v[52:55], v[140:143], v[80:95]
  ds_read_b64_tr_b16 v[36:37], v19 offset:16384
  ds_read_b64_tr_b16 v[38:39], v19 offset:18432
  s_add_u32 s34, s29, 20480
  buffer_load_dwordx4 v[176:179], v17, s[8:11], s34 offen offset:0
  s_waitcnt lgkmcnt(6)
  v_mfma_f32_32x32x16_bf16 v[96:111], v[56:59], v[140:143], v[96:111]
  ds_read_b64_tr_b16 v[40:41], v20 offset:16384
  ds_read_b64_tr_b16 v[42:43], v20 offset:18432
  buffer_load_dwordx4 v[180:183], v17, s[8:11], s34 offen offset:1024
  s_waitcnt lgkmcnt(6)
  v_mfma_f32_32x32x16_bf16 v[112:127], v[60:63], v[140:143], v[112:127]
  ds_read_b64_tr_b16 v[44:45], v21 offset:16384
  ds_read_b64_tr_b16 v[46:47], v21 offset:18432
  buffer_load_dwordx2 v[130:131], v12, s[8:11], s30 offen offset:256
  s_waitcnt lgkmcnt(6)
  s_waitcnt vmcnt(11)
  v_mfma_f32_32x32x16_bf16 v[64:79], v[32:35], v[144:147], v[64:79]
  ds_read_b64_tr_b16 v[48:49], v18 offset:20480
  ds_read_b64_tr_b16 v[50:51], v18 offset:22528
  s_waitcnt lgkmcnt(6)
  v_mfma_f32_32x32x16_bf16 v[80:95], v[36:39], v[144:147], v[80:95]
  ds_read_b64_tr_b16 v[52:53], v19 offset:20480
  ds_read_b64_tr_b16 v[54:55], v19 offset:22528
  buffer_load_dwordx4 v[184:187], v17, s[8:11], s34 offen offset:2048
  s_waitcnt lgkmcnt(6)
  v_mfma_f32_32x32x16_bf16 v[96:111], v[40:43], v[144:147], v[96:111]
  ds_read_b64_tr_b16 v[56:57], v20 offset:20480
  ds_read_b64_tr_b16 v[58:59], v20 offset:22528
  s_waitcnt lgkmcnt(6)
  v_mfma_f32_32x32x16_bf16 v[112:127], v[44:47], v[144:147], v[112:127]
  ds_read_b64_tr_b16 v[60:61], v21 offset:20480
  ds_read_b64_tr_b16 v[62:63], v21 offset:22528
  buffer_load_dwordx2 v[132:133], v12, s[8:11], s30 offen offset:512
  s_waitcnt lgkmcnt(6)
  s_waitcnt vmcnt(12)
  v_mfma_f32_32x32x16_bf16 v[64:79], v[48:51], v[148:151], v[64:79]
  ds_read_b64_tr_b16 v[32:33], v18 offset:24576
  ds_read_b64_tr_b16 v[34:35], v18 offset:26624
  s_waitcnt lgkmcnt(6)
  v_mfma_f32_32x32x16_bf16 v[80:95], v[52:55], v[148:151], v[80:95]
  ds_read_b64_tr_b16 v[36:37], v19 offset:24576
  ds_read_b64_tr_b16 v[38:39], v19 offset:26624
  buffer_load_dwordx4 v[188:191], v17, s[8:11], s34 offen offset:3072
  s_waitcnt lgkmcnt(6)
  v_mfma_f32_32x32x16_bf16 v[96:111], v[56:59], v[148:151], v[96:111]
  ds_read_b64_tr_b16 v[40:41], v20 offset:24576
  ds_read_b64_tr_b16 v[42:43], v20 offset:26624
  s_waitcnt lgkmcnt(6)
  v_mfma_f32_32x32x16_bf16 v[112:127], v[60:63], v[148:151], v[112:127]
  ds_read_b64_tr_b16 v[44:45], v21 offset:24576
  ds_read_b64_tr_b16 v[46:47], v21 offset:26624
  buffer_load_dwordx2 v[134:135], v12, s[8:11], s30 offen offset:768
  s_waitcnt lgkmcnt(6)
  s_waitcnt vmcnt(13)
  v_mfma_f32_32x32x16_bf16 v[64:79], v[32:35], v[152:155], v[64:79]
  ds_read_b64_tr_b16 v[48:49], v18 offset:28672
  ds_read_b64_tr_b16 v[50:51], v18 offset:30720
  s_waitcnt lgkmcnt(6)
  v_mfma_f32_32x32x16_bf16 v[80:95], v[36:39], v[152:155], v[80:95]
  ds_read_b64_tr_b16 v[52:53], v19 offset:28672
  ds_read_b64_tr_b16 v[54:55], v19 offset:30720
  s_add_u32 s34, s29, 32768
  buffer_load_dwordx4 v[192:195], v17, s[8:11], s34 offen offset:0
  s_waitcnt lgkmcnt(6)
  v_mfma_f32_32x32x16_bf16 v[96:111], v[40:43], v[152:155], v[96:111]
  ds_read_b64_tr_b16 v[56:57], v20 offset:28672
  ds_read_b64_tr_b16 v[58:59], v20 offset:30720
  s_waitcnt lgkmcnt(6)
  v_mfma_f32_32x32x16_bf16 v[112:127], v[44:47], v[152:155], v[112:127]
  ds_read_b64_tr_b16 v[60:61], v21 offset:28672
  ds_read_b64_tr_b16 v[62:63], v21 offset:30720
  buffer_load_dwordx2 v[136:137], v12, s[8:11], s30 offen offset:1024
  s_waitcnt lgkmcnt(6)
  s_waitcnt vmcnt(14)
  v_mfma_f32_32x32x16_bf16 v[64:79], v[48:51], v[156:159], v[64:79]
  ds_read_b64_tr_b16 v[32:33], v18 offset:32768
  ds_read_b64_tr_b16 v[34:35], v18 offset:34816
  s_waitcnt lgkmcnt(6)
  v_mfma_f32_32x32x16_bf16 v[80:95], v[52:55], v[156:159], v[80:95]
  ds_read_b64_tr_b16 v[36:37], v19 offset:32768
  ds_read_b64_tr_b16 v[38:39], v19 offset:34816
  buffer_load_dwordx4 v[196:199], v17, s[8:11], s34 offen offset:1024
  s_waitcnt lgkmcnt(6)
  v_mfma_f32_32x32x16_bf16 v[96:111], v[56:59], v[156:159], v[96:111]
  ds_read_b64_tr_b16 v[40:41], v20 offset:32768
  ds_read_b64_tr_b16 v[42:43], v20 offset:34816
  s_waitcnt lgkmcnt(6)
  v_mfma_f32_32x32x16_bf16 v[112:127], v[60:63], v[156:159], v[112:127]
  ds_read_b64_tr_b16 v[44:45], v21 offset:32768
  ds_read_b64_tr_b16 v[46:47], v21 offset:34816
  buffer_load_dwordx2 v[138:139], v12, s[8:11], s30 offen offset:1280
  s_waitcnt lgkmcnt(6)
  s_waitcnt vmcnt(15)
  v_mfma_f32_32x32x16_bf16 v[64:79], v[32:35], v[160:163], v[64:79]
  ds_read_b64_tr_b16 v[48:49], v18 offset:36864
  ds_read_b64_tr_b16 v[50:51], v18 offset:38912
  s_waitcnt lgkmcnt(6)
  v_mfma_f32_32x32x16_bf16 v[80:95], v[36:39], v[160:163], v[80:95]
  ds_read_b64_tr_b16 v[52:53], v19 offset:36864
  ds_read_b64_tr_b16 v[54:55], v19 offset:38912
  buffer_load_dwordx4 v[200:203], v17, s[8:11], s34 offen offset:2048
  s_waitcnt lgkmcnt(6)
  v_mfma_f32_32x32x16_bf16 v[96:111], v[40:43], v[160:163], v[96:111]
  ds_read_b64_tr_b16 v[56:57], v20 offset:36864
  ds_read_b64_tr_b16 v[58:59], v20 offset:38912
  s_waitcnt lgkmcnt(6)
  v_mfma_f32_32x32x16_bf16 v[112:127], v[44:47], v[160:163], v[112:127]
  ds_read_b64_tr_b16 v[60:61], v21 offset:36864
  ds_read_b64_tr_b16 v[62:63], v21 offset:38912
  buffer_load_dwordx2 v[140:141], v12, s[8:11], s30 offen offset:1536
  s_waitcnt lgkmcnt(6)
  s_waitcnt vmcnt(16)
  v_mfma_f32_32x32x16_bf16 v[64:79], v[48:51], v[164:167], v[64:79]
  ds_read_b64_tr_b16 v[32:33], v18 offset:40960
  ds_read_b64_tr_b16 v[34:35], v18 offset:43008
  s_waitcnt lgkmcnt(6)
  v_mfma_f32_32x32x16_bf16 v[80:95], v[52:55], v[164:167], v[80:95]
  ds_read_b64_tr_b16 v[36:37], v19 offset:40960
  ds_read_b64_tr_b16 v[38:39], v19 offset:43008
  buffer_load_dwordx4 v[204:207], v17, s[8:11], s34 offen offset:3072
  s_waitcnt lgkmcnt(6)
  v_mfma_f32_32x32x16_bf16 v[96:111], v[56:59], v[164:167], v[96:111]
  ds_read_b64_tr_b16 v[40:41], v20 offset:40960
  ds_read_b64_tr_b16 v[42:43], v20 offset:43008
  s_waitcnt lgkmcnt(6)
  v_mfma_f32_32x32x16_bf16 v[112:127], v[60:63], v[164:167], v[112:127]
  ds_read_b64_tr_b16 v[44:45], v21 offset:40960
  ds_read_b64_tr_b16 v[46:47], v21 offset:43008
  buffer_load_dwordx2 v[142:143], v12, s[8:11], s30 offen offset:1792
  s_waitcnt lgkmcnt(6)
  s_waitcnt vmcnt(17)
  v_mfma_f32_32x32x16_bf16 v[64:79], v[32:35], v[168:171], v[64:79]
  ds_read_b64_tr_b16 v[48:49], v18 offset:45056
  ds_read_b64_tr_b16 v[50:51], v18 offset:47104
  s_waitcnt lgkmcnt(6)
  v_mfma_f32_32x32x16_bf16 v[80:95], v[36:39], v[168:171], v[80:95]
  ds_read_b64_tr_b16 v[52:53], v19 offset:45056
  ds_read_b64_tr_b16 v[54:55], v19 offset:47104
  s_add_u32 s34, s29, 36864
  buffer_load_dwordx4 v[208:211], v17, s[8:11], s34 offen offset:0
  s_waitcnt lgkmcnt(6)
  v_mfma_f32_32x32x16_bf16 v[96:111], v[40:43], v[168:171], v[96:111]
  ds_read_b64_tr_b16 v[56:57], v20 offset:45056
  ds_read_b64_tr_b16 v[58:59], v20 offset:47104
  s_waitcnt lgkmcnt(6)
  v_mfma_f32_32x32x16_bf16 v[112:127], v[44:47], v[168:171], v[112:127]
  ds_read_b64_tr_b16 v[60:61], v21 offset:45056
  ds_read_b64_tr_b16 v[62:63], v21 offset:47104
  buffer_load_dwordx2 v[144:145], v12, s[8:11], s30 offen offset:2048
  v_subrev_u32 v18, 114688, v18
  v_subrev_u32 v19, 114688, v19
  v_subrev_u32 v20, 114688, v20
  v_subrev_u32 v21, 114688, v21
  s_barrier
  s_waitcnt lgkmcnt(6)
  s_waitcnt vmcnt(18)
  v_mfma_f32_32x32x16_bf16 v[64:79], v[48:51], v[172:175], v[64:79]
  ds_read_b64_tr_b16 v[32:33], v18 offset:0
  ds_read_b64_tr_b16 v[34:35], v18 offset:2048
  s_waitcnt lgkmcnt(6)
  v_mfma_f32_32x32x16_bf16 v[80:95], v[52:55], v[172:175], v[80:95]
  ds_read_b64_tr_b16 v[36:37], v19 offset:0
  ds_read_b64_tr_b16 v[38:39], v19 offset:2048
  buffer_load_dwordx4 v[212:215], v17, s[8:11], s34 offen offset:1024
  s_waitcnt lgkmcnt(6)
  v_mfma_f32_32x32x16_bf16 v[96:111], v[56:59], v[172:175], v[96:111]
  ds_read_b64_tr_b16 v[40:41], v20 offset:0
  ds_read_b64_tr_b16 v[42:43], v20 offset:2048
  s_waitcnt lgkmcnt(6)
  v_mfma_f32_32x32x16_bf16 v[112:127], v[60:63], v[172:175], v[112:127]
  ds_read_b64_tr_b16 v[44:45], v21 offset:0
  ds_read_b64_tr_b16 v[46:47], v21 offset:2048
  buffer_load_dwordx2 v[146:147], v12, s[8:11], s30 offen offset:2304
  s_waitcnt lgkmcnt(6)
  s_waitcnt vmcnt(18)
  v_mfma_f32_32x32x16_bf16 v[64:79], v[32:35], v[176:179], v[64:79]
  ds_read_b64_tr_b16 v[48:49], v18 offset:4096
  ds_read_b64_tr_b16 v[50:51], v18 offset:6144
  s_waitcnt lgkmcnt(6)
  v_mfma_f32_32x32x16_bf16 v[80:95], v[36:39], v[176:179], v[80:95]
  ds_read_b64_tr_b16 v[52:53], v19 offset:4096
  ds_read_b64_tr_b16 v[54:55], v19 offset:6144
  buffer_load_dwordx4 v[216:219], v17, s[8:11], s34 offen offset:2048
  s_waitcnt lgkmcnt(6)
  v_mfma_f32_32x32x16_bf16 v[96:111], v[40:43], v[176:179], v[96:111]
  ds_read_b64_tr_b16 v[56:57], v20 offset:4096
  ds_read_b64_tr_b16 v[58:59], v20 offset:6144
  s_waitcnt lgkmcnt(6)
  v_mfma_f32_32x32x16_bf16 v[112:127], v[44:47], v[176:179], v[112:127]
  ds_read_b64_tr_b16 v[60:61], v21 offset:4096
  ds_read_b64_tr_b16 v[62:63], v21 offset:6144
  buffer_load_dwordx2 v[148:149], v12, s[8:11], s30 offen offset:2560
  s_waitcnt lgkmcnt(6)
  s_waitcnt vmcnt(19)
  v_mfma_f32_32x32x16_bf16 v[64:79], v[48:51], v[180:183], v[64:79]
  ds_read_b64_tr_b16 v[32:33], v18 offset:8192
  ds_read_b64_tr_b16 v[34:35], v18 offset:10240
  s_waitcnt lgkmcnt(6)
  v_mfma_f32_32x32x16_bf16 v[80:95], v[52:55], v[180:183], v[80:95]
  ds_read_b64_tr_b16 v[36:37], v19 offset:8192
  ds_read_b64_tr_b16 v[38:39], v19 offset:10240
  buffer_load_dwordx4 v[220:223], v17, s[8:11], s34 offen offset:3072
  s_waitcnt lgkmcnt(6)
  v_mfma_f32_32x32x16_bf16 v[96:111], v[56:59], v[180:183], v[96:111]
  ds_read_b64_tr_b16 v[40:41], v20 offset:8192
  ds_read_b64_tr_b16 v[42:43], v20 offset:10240
  s_waitcnt lgkmcnt(6)
  v_mfma_f32_32x32x16_bf16 v[112:127], v[60:63], v[180:183], v[112:127]
  ds_read_b64_tr_b16 v[44:45], v21 offset:8192
  ds_read_b64_tr_b16 v[46:47], v21 offset:10240
  buffer_load_dwordx2 v[150:151], v12, s[8:11], s30 offen offset:2816
  s_waitcnt lgkmcnt(6)
  s_waitcnt vmcnt(19)
  v_mfma_f32_32x32x16_bf16 v[64:79], v[32:35], v[184:187], v[64:79]
  ds_read_b64_tr_b16 v[48:49], v18 offset:12288
  ds_read_b64_tr_b16 v[50:51], v18 offset:14336
  s_waitcnt lgkmcnt(6)
  v_mfma_f32_32x32x16_bf16 v[80:95], v[36:39], v[184:187], v[80:95]
  ds_read_b64_tr_b16 v[52:53], v19 offset:12288
  ds_read_b64_tr_b16 v[54:55], v19 offset:14336
  s_add_u32 s34, s29, 49152
  buffer_load_dwordx4 v[224:227], v17, s[8:11], s34 offen offset:0
  s_waitcnt lgkmcnt(6)
  v_mfma_f32_32x32x16_bf16 v[96:111], v[40:43], v[184:187], v[96:111]
  ds_read_b64_tr_b16 v[56:57], v20 offset:12288
  ds_read_b64_tr_b16 v[58:59], v20 offset:14336
  s_waitcnt lgkmcnt(6)
  v_mfma_f32_32x32x16_bf16 v[112:127], v[44:47], v[184:187], v[112:127]
  ds_read_b64_tr_b16 v[60:61], v21 offset:12288
  ds_read_b64_tr_b16 v[62:63], v21 offset:14336
  buffer_load_dwordx2 v[152:153], v12, s[8:11], s30 offen offset:3072
  s_waitcnt lgkmcnt(6)
  s_waitcnt vmcnt(19)
  v_mfma_f32_32x32x16_bf16 v[64:79], v[48:51], v[188:191], v[64:79]
  ds_read_b64_tr_b16 v[32:33], v18 offset:16384
  ds_read_b64_tr_b16 v[34:35], v18 offset:18432
  s_waitcnt lgkmcnt(6)
  v_mfma_f32_32x32x16_bf16 v[80:95], v[52:55], v[188:191], v[80:95]
  ds_read_b64_tr_b16 v[36:37], v19 offset:16384
  ds_read_b64_tr_b16 v[38:39], v19 offset:18432
  buffer_load_dwordx4 v[228:231], v17, s[8:11], s34 offen offset:1024
  s_waitcnt lgkmcnt(6)
  v_mfma_f32_32x32x16_bf16 v[96:111], v[56:59], v[188:191], v[96:111]
  ds_read_b64_tr_b16 v[40:41], v20 offset:16384
  ds_read_b64_tr_b16 v[42:43], v20 offset:18432
  s_waitcnt lgkmcnt(6)
  v_mfma_f32_32x32x16_bf16 v[112:127], v[60:63], v[188:191], v[112:127]
  ds_read_b64_tr_b16 v[44:45], v21 offset:16384
  ds_read_b64_tr_b16 v[46:47], v21 offset:18432
  buffer_load_dwordx2 v[154:155], v12, s[8:11], s30 offen offset:3328
  s_waitcnt lgkmcnt(6)
  s_waitcnt vmcnt(19)
  v_mfma_f32_32x32x16_bf16 v[64:79], v[32:35], v[192:195], v[64:79]
  ds_read_b64_tr_b16 v[48:49], v18 offset:20480
  ds_read_b64_tr_b16 v[50:51], v18 offset:22528
  s_waitcnt lgkmcnt(6)
  v_mfma_f32_32x32x16_bf16 v[80:95], v[36:39], v[192:195], v[80:95]
  ds_read_b64_tr_b16 v[52:53], v19 offset:20480
  ds_read_b64_tr_b16 v[54:55], v19 offset:22528
  buffer_load_dwordx4 v[232:235], v17, s[8:11], s34 offen offset:2048
  s_waitcnt lgkmcnt(6)
  v_mfma_f32_32x32x16_bf16 v[96:111], v[40:43], v[192:195], v[96:111]
  ds_read_b64_tr_b16 v[56:57], v20 offset:20480
  ds_read_b64_tr_b16 v[58:59], v20 offset:22528
  s_waitcnt lgkmcnt(6)
  v_mfma_f32_32x32x16_bf16 v[112:127], v[44:47], v[192:195], v[112:127]
  ds_read_b64_tr_b16 v[60:61], v21 offset:20480
  ds_read_b64_tr_b16 v[62:63], v21 offset:22528
  buffer_load_dwordx2 v[156:157], v12, s[8:11], s30 offen offset:3584
  s_waitcnt lgkmcnt(6)
  s_waitcnt vmcnt(19)
  v_mfma_f32_32x32x16_bf16 v[64:79], v[48:51], v[196:199], v[64:79]
  ds_read_b64_tr_b16 v[32:33], v18 offset:24576
  ds_read_b64_tr_b16 v[34:35], v18 offset:26624
  s_waitcnt lgkmcnt(6)
  v_mfma_f32_32x32x16_bf16 v[80:95], v[52:55], v[196:199], v[80:95]
  ds_read_b64_tr_b16 v[36:37], v19 offset:24576
  ds_read_b64_tr_b16 v[38:39], v19 offset:26624
  buffer_load_dwordx4 v[236:239], v17, s[8:11], s34 offen offset:3072
  s_waitcnt lgkmcnt(6)
  v_mfma_f32_32x32x16_bf16 v[96:111], v[56:59], v[196:199], v[96:111]
  ds_read_b64_tr_b16 v[40:41], v20 offset:24576
  ds_read_b64_tr_b16 v[42:43], v20 offset:26624
  s_waitcnt lgkmcnt(6)
  v_mfma_f32_32x32x16_bf16 v[112:127], v[60:63], v[196:199], v[112:127]
  ds_read_b64_tr_b16 v[44:45], v21 offset:24576
  ds_read_b64_tr_b16 v[46:47], v21 offset:26624
  buffer_load_dwordx2 v[158:159], v12, s[8:11], s30 offen offset:3840
  s_waitcnt lgkmcnt(6)
  s_waitcnt vmcnt(19)
  v_mfma_f32_32x32x16_bf16 v[64:79], v[32:35], v[200:203], v[64:79]
  ds_read_b64_tr_b16 v[48:49], v18 offset:28672
  ds_read_b64_tr_b16 v[50:51], v18 offset:30720
  s_waitcnt lgkmcnt(6)
  v_mfma_f32_32x32x16_bf16 v[80:95], v[36:39], v[200:203], v[80:95]
  ds_read_b64_tr_b16 v[52:53], v19 offset:28672
  ds_read_b64_tr_b16 v[54:55], v19 offset:30720
  s_add_u32 s34, s29, 53248
  buffer_load_dwordx4 v[240:243], v17, s[8:11], s34 offen offset:0
  s_waitcnt lgkmcnt(6)
  v_mfma_f32_32x32x16_bf16 v[96:111], v[40:43], v[200:203], v[96:111]
  ds_read_b64_tr_b16 v[56:57], v20 offset:28672
  ds_read_b64_tr_b16 v[58:59], v20 offset:30720
  s_waitcnt lgkmcnt(6)
  v_mfma_f32_32x32x16_bf16 v[112:127], v[44:47], v[200:203], v[112:127]
  ds_read_b64_tr_b16 v[60:61], v21 offset:28672
  ds_read_b64_tr_b16 v[62:63], v21 offset:30720
  buffer_load_dwordx4 v[160:163], v10, s[8:11], s35 offen offset:0
  s_waitcnt lgkmcnt(6)
  s_waitcnt vmcnt(19)
  v_mfma_f32_32x32x16_bf16 v[64:79], v[48:51], v[204:207], v[64:79]
  ds_read_b64_tr_b16 v[32:33], v18 offset:32768
  ds_read_b64_tr_b16 v[34:35], v18 offset:34816
  s_waitcnt lgkmcnt(6)
  v_mfma_f32_32x32x16_bf16 v[80:95], v[52:55], v[204:207], v[80:95]
  ds_read_b64_tr_b16 v[36:37], v19 offset:32768
  ds_read_b64_tr_b16 v[38:39], v19 offset:34816
  buffer_load_dwordx4 v[244:247], v17, s[8:11], s34 offen offset:1024
  s_waitcnt lgkmcnt(6)
  v_mfma_f32_32x32x16_bf16 v[96:111], v[56:59], v[204:207], v[96:111]
  ds_read_b64_tr_b16 v[40:41], v20 offset:32768
  ds_read_b64_tr_b16 v[42:43], v20 offset:34816
  s_waitcnt lgkmcnt(6)
  v_mfma_f32_32x32x16_bf16 v[112:127], v[60:63], v[204:207], v[112:127]
  ds_read_b64_tr_b16 v[44:45], v21 offset:32768
  ds_read_b64_tr_b16 v[46:47], v21 offset:34816
  buffer_load_dwordx4 v[164:167], v10, s[8:11], s35 offen offset:512
  s_waitcnt lgkmcnt(6)
  s_waitcnt vmcnt(19)
  v_mfma_f32_32x32x16_bf16 v[64:79], v[32:35], v[208:211], v[64:79]
  ds_read_b64_tr_b16 v[48:49], v18 offset:36864
  ds_read_b64_tr_b16 v[50:51], v18 offset:38912
  s_waitcnt lgkmcnt(6)
  v_mfma_f32_32x32x16_bf16 v[80:95], v[36:39], v[208:211], v[80:95]
  ds_read_b64_tr_b16 v[52:53], v19 offset:36864
  ds_read_b64_tr_b16 v[54:55], v19 offset:38912
  buffer_load_dwordx4 v[248:251], v17, s[8:11], s34 offen offset:2048
  s_waitcnt lgkmcnt(6)
  v_mfma_f32_32x32x16_bf16 v[96:111], v[40:43], v[208:211], v[96:111]
  ds_read_b64_tr_b16 v[56:57], v20 offset:36864
  ds_read_b64_tr_b16 v[58:59], v20 offset:38912
  s_waitcnt lgkmcnt(6)
  v_mfma_f32_32x32x16_bf16 v[112:127], v[44:47], v[208:211], v[112:127]
  ds_read_b64_tr_b16 v[60:61], v21 offset:36864
  ds_read_b64_tr_b16 v[62:63], v21 offset:38912
  buffer_load_dwordx4 v[168:171], v10, s[8:11], s35 offen offset:1024
  s_waitcnt lgkmcnt(6)
  s_waitcnt vmcnt(19)
  v_mfma_f32_32x32x16_bf16 v[64:79], v[48:51], v[212:215], v[64:79]
  ds_read_b64_tr_b16 v[32:33], v18 offset:40960
  ds_read_b64_tr_b16 v[34:35], v18 offset:43008
  s_waitcnt lgkmcnt(6)
  v_mfma_f32_32x32x16_bf16 v[80:95], v[52:55], v[212:215], v[80:95]
  ds_read_b64_tr_b16 v[36:37], v19 offset:40960
  ds_read_b64_tr_b16 v[38:39], v19 offset:43008
  buffer_load_dwordx4 v[252:255], v17, s[8:11], s34 offen offset:3072
  s_waitcnt lgkmcnt(6)
  v_mfma_f32_32x32x16_bf16 v[96:111], v[56:59], v[212:215], v[96:111]
  ds_read_b64_tr_b16 v[40:41], v20 offset:40960
  ds_read_b64_tr_b16 v[42:43], v20 offset:43008
  s_waitcnt lgkmcnt(6)
  v_mfma_f32_32x32x16_bf16 v[112:127], v[60:63], v[212:215], v[112:127]
  ds_read_b64_tr_b16 v[44:45], v21 offset:40960
  ds_read_b64_tr_b16 v[46:47], v21 offset:43008
  buffer_load_dwordx4 v[172:175], v10, s[8:11], s35 offen offset:1536
  s_waitcnt lgkmcnt(6)
  s_waitcnt vmcnt(19)
  v_mfma_f32_32x32x16_bf16 v[64:79], v[32:35], v[216:219], v[64:79]
  ds_read_b64_tr_b16 v[48:49], v18 offset:45056
  ds_read_b64_tr_b16 v[50:51], v18 offset:47104
  s_waitcnt vmcnt(8)
  v_add_f32 v2, v128, v130
  v_add_f32 v4, v132, v134
  s_waitcnt lgkmcnt(6)
  v_mfma_f32_32x32x16_bf16 v[80:95], v[36:39], v[216:219], v[80:95]
  ds_read_b64_tr_b16 v[52:53], v19 offset:45056
  ds_read_b64_tr_b16 v[54:55], v19 offset:47104
  v_add_f32 v3, v129, v131
  v_add_f32 v5, v133, v135
  v_add_f32 v2, v2, v136
  s_waitcnt lgkmcnt(6)
  v_mfma_f32_32x32x16_bf16 v[96:111], v[40:43], v[216:219], v[96:111]
  ds_read_b64_tr_b16 v[56:57], v20 offset:45056
  ds_read_b64_tr_b16 v[58:59], v20 offset:47104
  v_add_f32 v3, v3, v137
  v_add_f32 v4, v4, v138
  v_add_f32 v5, v5, v139
  s_waitcnt lgkmcnt(6)
  v_mfma_f32_32x32x16_bf16 v[112:127], v[44:47], v[216:219], v[112:127]
  ds_read_b64_tr_b16 v[60:61], v21 offset:45056
  ds_read_b64_tr_b16 v[62:63], v21 offset:47104
  v_add_f32 v2, v2, v140
  v_add_f32 v3, v3, v141
  v_add_f32 v4, v4, v142
  v_add_f32 v5, v5, v143
  s_waitcnt lgkmcnt(6)
  v_mfma_f32_32x32x16_bf16 v[64:79], v[48:51], v[220:223], v[64:79]
  ds_read_b64_tr_b16 v[32:33], v18 offset:49152
  ds_read_b64_tr_b16 v[34:35], v18 offset:51200
  v_add_f32 v2, v2, v144
  v_add_f32 v3, v3, v145
  v_add_f32 v4, v4, v146
  s_waitcnt lgkmcnt(6)
  v_mfma_f32_32x32x16_bf16 v[80:95], v[52:55], v[220:223], v[80:95]
  ds_read_b64_tr_b16 v[36:37], v19 offset:49152
  ds_read_b64_tr_b16 v[38:39], v19 offset:51200
  v_add_f32 v5, v5, v147
  v_add_f32 v2, v2, v148
  v_add_f32 v3, v3, v149
  s_waitcnt lgkmcnt(6)
  v_mfma_f32_32x32x16_bf16 v[96:111], v[56:59], v[220:223], v[96:111]
  ds_read_b64_tr_b16 v[40:41], v20 offset:49152
  ds_read_b64_tr_b16 v[42:43], v20 offset:51200
  v_add_f32 v4, v4, v150
  v_add_f32 v5, v5, v151
  v_add_f32 v2, v2, v152
  s_waitcnt lgkmcnt(6)
  v_mfma_f32_32x32x16_bf16 v[112:127], v[60:63], v[220:223], v[112:127]
  ds_read_b64_tr_b16 v[44:45], v21 offset:49152
  ds_read_b64_tr_b16 v[46:47], v21 offset:51200
  v_add_f32 v3, v3, v153
  v_add_f32 v4, v4, v154
  v_add_f32 v5, v5, v155
  s_waitcnt lgkmcnt(6)
  v_mfma_f32_32x32x16_bf16 v[64:79], v[32:35], v[224:227], v[64:79]
  ds_read_b64_tr_b16 v[48:49], v18 offset:53248
  ds_read_b64_tr_b16 v[50:51], v18 offset:55296
  v_add_f32 v2, v2, v156
  v_add_f32 v3, v3, v157
  v_add_f32 v4, v4, v158
  s_waitcnt lgkmcnt(6)
  v_mfma_f32_32x32x16_bf16 v[80:95], v[36:39], v[224:227], v[80:95]
  ds_read_b64_tr_b16 v[52:53], v19 offset:53248
  ds_read_b64_tr_b16 v[54:55], v19 offset:55296
  v_add_f32 v5, v5, v159
  v_add_f32 v2, v2, v4
  v_add_f32 v3, v3, v5
  s_waitcnt lgkmcnt(6)
  v_mfma_f32_32x32x16_bf16 v[96:111], v[40:43], v[224:227], v[96:111]
  ds_read_b64_tr_b16 v[56:57], v20 offset:53248
  ds_read_b64_tr_b16 v[58:59], v20 offset:55296
  v_mov_b32 v4, v2
  v_mov_b32 v5, v3
  s_nop 1
  s_waitcnt lgkmcnt(6)
  v_mfma_f32_32x32x16_bf16 v[112:127], v[44:47], v[224:227], v[112:127]
  ds_read_b64_tr_b16 v[60:61], v21 offset:53248
  ds_read_b64_tr_b16 v[62:63], v21 offset:55296
  v_permlane32_swap_b32 v2, v4
  v_permlane32_swap_b32 v3, v5
  s_nop 1
  s_waitcnt lgkmcnt(6)
  v_mfma_f32_32x32x16_bf16 v[64:79], v[48:51], v[228:231], v[64:79]
  ds_read_b64_tr_b16 v[32:33], v18 offset:57344
  ds_read_b64_tr_b16 v[34:35], v18 offset:59392
  v_add_f32 v2, v2, v4
  v_add_f32 v3, v3, v5
  v_mul_f32 v2, 0xbb000000, v2
  s_waitcnt lgkmcnt(6)
  v_mfma_f32_32x32x16_bf16 v[80:95], v[52:55], v[228:231], v[80:95]
  ds_read_b64_tr_b16 v[36:37], v19 offset:57344
  ds_read_b64_tr_b16 v[38:39], v19 offset:59392
  v_mul_f32 v3, 0x3b000000, v3
  v_fma_f32 v3, -v2, v2, v3
  v_max_f32 v3, 0, v3
  s_waitcnt lgkmcnt(6)
  v_mfma_f32_32x32x16_bf16 v[96:111], v[56:59], v[228:231], v[96:111]
  ds_read_b64_tr_b16 v[40:41], v20 offset:57344
  ds_read_b64_tr_b16 v[42:43], v20 offset:59392
  v_add_f32 v26, 0x3727c5ac, v3
  v_rsq_f32 v6, v26
  v_cvt_pk_bf16_f32 v4, v2, v2
  s_waitcnt lgkmcnt(6)
  v_mfma_f32_32x32x16_bf16 v[112:127], v[60:63], v[228:231], v[112:127]
  ds_read_b64_tr_b16 v[44:45], v21 offset:57344
  ds_read_b64_tr_b16 v[46:47], v21 offset:59392
  v_and_b32 v4, 0xffff0000, v4
  v_sub_f32 v4, v2, v4
  v_cvt_pk_bf16_f32 v4, v2, v4
  s_waitcnt lgkmcnt(6)
  v_mfma_f32_32x32x16_bf16 v[64:79], v[32:35], v[232:235], v[64:79]
  ds_read_b64_tr_b16 v[48:49], v18 offset:61440
  ds_read_b64_tr_b16 v[50:51], v18 offset:63488
  v_cndmask_b32_e64 v28, 0, v4, s[90:91]
  s_waitcnt lgkmcnt(6)
  v_mfma_f32_32x32x16_bf16 v[80:95], v[36:39], v[232:235], v[80:95]
  ds_read_b64_tr_b16 v[52:53], v19 offset:61440
  ds_read_b64_tr_b16 v[54:55], v19 offset:63488
  v_cndmask_b32_e64 v29, 0, v4, s[90:91]
  s_waitcnt lgkmcnt(6)
  v_mfma_f32_32x32x16_bf16 v[96:111], v[40:43], v[232:235], v[96:111]
  ds_read_b64_tr_b16 v[56:57], v20 offset:61440
  ds_read_b64_tr_b16 v[58:59], v20 offset:63488
  v_mov_b32 v30, 0
  s_waitcnt lgkmcnt(6)
  v_mfma_f32_32x32x16_bf16 v[112:127], v[44:47], v[232:235], v[112:127]
  ds_read_b64_tr_b16 v[60:61], v21 offset:61440
  ds_read_b64_tr_b16 v[62:63], v21 offset:63488
  v_mov_b32 v31, 0
  v_mul_f32 v22, s92, v6
  v_add_u32 v18, 65536, v18
  v_add_u32 v19, 65536, v19
  v_add_u32 v20, 65536, v20
  v_add_u32 v21, 65536, v21
  s_waitcnt lgkmcnt(6)
  v_mfma_f32_32x32x16_bf16 v[64:79], v[48:51], v[236:239], v[64:79]
  ds_read_b64_tr_b16 v[32:33], v18 offset:0
  ds_read_b64_tr_b16 v[34:35], v18 offset:2048
  s_waitcnt lgkmcnt(6)
  v_mfma_f32_32x32x16_bf16 v[80:95], v[52:55], v[236:239], v[80:95]
  ds_read_b64_tr_b16 v[36:37], v18 offset:4096
  ds_read_b64_tr_b16 v[38:39], v18 offset:6144
  s_waitcnt lgkmcnt(6)
  v_mfma_f32_32x32x16_bf16 v[96:111], v[56:59], v[236:239], v[96:111]
  ds_read_b64_tr_b16 v[40:41], v18 offset:8192
  ds_read_b64_tr_b16 v[42:43], v18 offset:10240
  s_waitcnt lgkmcnt(6)
  v_mfma_f32_32x32x16_bf16 v[112:127], v[60:63], v[236:239], v[112:127]
  ds_read_b64_tr_b16 v[44:45], v18 offset:12288
  ds_read_b64_tr_b16 v[46:47], v18 offset:14336
  s_waitcnt vmcnt(0)
  v_mfma_f32_32x32x16_bf16 v[64:79], v[160:163], v[28:31], v[64:79]
  v_mfma_f32_32x32x16_bf16 v[80:95], v[164:167], v[28:31], v[80:95]
  v_mfma_f32_32x32x16_bf16 v[96:111], v[168:171], v[28:31], v[96:111]
  v_mfma_f32_32x32x16_bf16 v[112:127], v[172:175], v[28:31], v[112:127]
  s_waitcnt lgkmcnt(6)
  v_mfma_f32_32x32x16_bf16 v[64:79], v[32:35], v[240:243], v[64:79]
  ds_read_b64_tr_b16 v[48:49], v19 offset:0
  ds_read_b64_tr_b16 v[50:51], v19 offset:2048
  s_waitcnt lgkmcnt(6)
  v_mfma_f32_32x32x16_bf16 v[64:79], v[36:39], v[244:247], v[64:79]
  ds_read_b64_tr_b16 v[52:53], v19 offset:4096
  ds_read_b64_tr_b16 v[54:55], v19 offset:6144
  s_waitcnt lgkmcnt(6)
  v_mfma_f32_32x32x16_bf16 v[64:79], v[40:43], v[248:251], v[64:79]
  ds_read_b64_tr_b16 v[56:57], v19 offset:8192
  ds_read_b64_tr_b16 v[58:59], v19 offset:10240
  s_waitcnt lgkmcnt(6)
  v_mfma_f32_32x32x16_bf16 v[64:79], v[44:47], v[252:255], v[64:79]
  ds_read_b64_tr_b16 v[60:61], v19 offset:12288
  ds_read_b64_tr_b16 v[62:63], v19 offset:14336
  s_waitcnt lgkmcnt(6)
  v_mfma_f32_32x32x16_bf16 v[80:95], v[48:51], v[240:243], v[80:95]
  ds_read_b64_tr_b16 v[32:33], v20 offset:0
  ds_read_b64_tr_b16 v[34:35], v20 offset:2048
  s_nop 7
  v_mul_f32 v64, v64, v22
  v_mul_f32 v65, v65, v22
  v_mul_f32 v66, v66, v22
  v_mul_f32 v67, v67, v22
  v_mul_f32 v68, v68, v22
  v_mul_f32 v69, v69, v22
  s_waitcnt lgkmcnt(6)
  v_mfma_f32_32x32x16_bf16 v[80:95], v[52:55], v[244:247], v[80:95]
  ds_read_b64_tr_b16 v[36:37], v20 offset:4096
  ds_read_b64_tr_b16 v[38:39], v20 offset:6144
  v_mul_f32 v70, v70, v22
  v_mul_f32 v71, v71, v22
  v_cvt_pk_bf16_f32 v192, v64, v65
  v_cvt_pk_bf16_f32 v193, v66, v67
  v_cvt_pk_bf16_f32 v194, v68, v69
  v_cvt_pk_bf16_f32 v195, v70, v71
  s_waitcnt lgkmcnt(6)
  v_mfma_f32_32x32x16_bf16 v[80:95], v[56:59], v[248:251], v[80:95]
  ds_read_b64_tr_b16 v[40:41], v20 offset:8192
  ds_read_b64_tr_b16 v[42:43], v20 offset:10240
  buffer_store_dwordx4 v[192:195], v17, s[8:11], s84 offen offset:0 sc1
  v_mul_f32 v72, v72, v22
  v_mul_f32 v73, v73, v22
  v_mul_f32 v74, v74, v22
  v_mul_f32 v75, v75, v22
  v_mul_f32 v76, v76, v22
  s_waitcnt lgkmcnt(6)
  v_mfma_f32_32x32x16_bf16 v[80:95], v[60:63], v[252:255], v[80:95]
  ds_read_b64_tr_b16 v[44:45], v20 offset:12288
  ds_read_b64_tr_b16 v[46:47], v20 offset:14336
  v_mul_f32 v77, v77, v22
  v_mul_f32 v78, v78, v22
  v_mul_f32 v79, v79, v22
  v_cvt_pk_bf16_f32 v196, v72, v73
  v_cvt_pk_bf16_f32 v197, v74, v75
  v_cvt_pk_bf16_f32 v198, v76, v77
  s_waitcnt lgkmcnt(6)
  v_mfma_f32_32x32x16_bf16 v[96:111], v[32:35], v[240:243], v[96:111]
  ds_read_b64_tr_b16 v[48:49], v21 offset:0
  ds_read_b64_tr_b16 v[50:51], v21 offset:2048
  v_cvt_pk_bf16_f32 v199, v78, v79
  buffer_store_dwordx4 v[196:199], v17, s[8:11], s84 offen offset:1024 sc1
  v_mul_f32 v80, v80, v22
  v_mul_f32 v81, v81, v22
  v_mul_f32 v82, v82, v22
  v_mul_f32 v83, v83, v22
  s_waitcnt lgkmcnt(6)
  v_mfma_f32_32x32x16_bf16 v[96:111], v[36:39], v[244:247], v[96:111]
  ds_read_b64_tr_b16 v[52:53], v21 offset:4096
  ds_read_b64_tr_b16 v[54:55], v21 offset:6144
  v_mul_f32 v84, v84, v22
  v_mul_f32 v85, v85, v22
  v_mul_f32 v86, v86, v22
  v_mul_f32 v87, v87, v22
  v_cvt_pk_bf16_f32 v200, v80, v81
  v_cvt_pk_bf16_f32 v201, v82, v83
  s_waitcnt lgkmcnt(6)
  v_mfma_f32_32x32x16_bf16 v[96:111], v[40:43], v[248:251], v[96:111]
  ds_read_b64_tr_b16 v[56:57], v21 offset:8192
  ds_read_b64_tr_b16 v[58:59], v21 offset:10240
  v_cvt_pk_bf16_f32 v202, v84, v85
  v_cvt_pk_bf16_f32 v203, v86, v87
  buffer_store_dwordx4 v[200:203], v17, s[8:11], s84 offen offset:2048 sc1
  v_mul_f32 v88, v88, v22
  v_mul_f32 v89, v89, v22
  v_mul_f32 v90, v90, v22
  s_waitcnt lgkmcnt(6)
  v_mfma_f32_32x32x16_bf16 v[96:111], v[44:47], v[252:255], v[96:111]
  ds_read_b64_tr_b16 v[60:61], v21 offset:12288
  ds_read_b64_tr_b16 v[62:63], v21 offset:14336
  v_mul_f32 v91, v91, v22
  v_mul_f32 v92, v92, v22
  v_mul_f32 v93, v93, v22
  v_mul_f32 v94, v94, v22
  v_mul_f32 v95, v95, v22
  v_cvt_pk_bf16_f32 v204, v88, v89
  s_waitcnt lgkmcnt(6)
  v_mfma_f32_32x32x16_bf16 v[112:127], v[48:51], v[240:243], v[112:127]
  v_cvt_pk_bf16_f32 v205, v90, v91
  v_cvt_pk_bf16_f32 v206, v92, v93
  v_cvt_pk_bf16_f32 v207, v94, v95
  buffer_store_dwordx4 v[204:207], v17, s[8:11], s84 offen offset:3072 sc1
  v_mul_f32 v96, v96, v22
  v_mul_f32 v97, v97, v22
  s_waitcnt lgkmcnt(4)
  v_mfma_f32_32x32x16_bf16 v[112:127], v[52:55], v[244:247], v[112:127]
  v_mul_f32 v98, v98, v22
  v_mul_f32 v99, v99, v22
  v_mul_f32 v100, v100, v22
  v_mul_f32 v101, v101, v22
  v_mul_f32 v102, v102, v22
  v_mul_f32 v103, v103, v22
  s_waitcnt lgkmcnt(2)
  v_mfma_f32_32x32x16_bf16 v[112:127], v[56:59], v[248:251], v[112:127]
  v_cvt_pk_bf16_f32 v208, v96, v97
  v_cvt_pk_bf16_f32 v209, v98, v99
  v_cvt_pk_bf16_f32 v210, v100, v101
  v_cvt_pk_bf16_f32 v211, v102, v103
  buffer_store_dwordx4 v[208:211], v17, s[8:11], s85 offen offset:0 sc1
  v_mul_f32 v104, v104, v22
  s_waitcnt lgkmcnt(0)
  v_mfma_f32_32x32x16_bf16 v[112:127], v[60:63], v[252:255], v[112:127]
  v_mul_f32 v105, v105, v22
  v_mul_f32 v106, v106, v22
  v_mul_f32 v107, v107, v22
  v_mul_f32 v108, v108, v22
  v_mul_f32 v109, v109, v22
  v_mul_f32 v110, v110, v22
  s_waitcnt lgkmcnt(0)
  v_mul_f32 v111, v111, v22
  v_cvt_pk_bf16_f32 v212, v104, v105
  v_cvt_pk_bf16_f32 v213, v106, v107
  v_cvt_pk_bf16_f32 v214, v108, v109
  v_cvt_pk_bf16_f32 v215, v110, v111
  buffer_store_dwordx4 v[212:215], v17, s[8:11], s85 offen offset:1024 sc1
  s_nop 3
  v_pk_mul_f32 v[112:113], v[112:113], v[22:23] op_sel_hi:[1,0]
  v_pk_mul_f32 v[114:115], v[114:115], v[22:23] op_sel_hi:[1,0]
  v_pk_mul_f32 v[116:117], v[116:117], v[22:23] op_sel_hi:[1,0]
  v_pk_mul_f32 v[118:119], v[118:119], v[22:23] op_sel_hi:[1,0]
  v_cvt_pk_bf16_f32 v216, v112, v113
  v_cvt_pk_bf16_f32 v217, v114, v115
  v_cvt_pk_bf16_f32 v218, v116, v117
  v_cvt_pk_bf16_f32 v219, v118, v119
  buffer_store_dwordx4 v[216:219], v17, s[8:11], s85 offen offset:2048 sc1
  v_pk_mul_f32 v[120:121], v[120:121], v[22:23] op_sel_hi:[1,0]
  v_pk_mul_f32 v[122:123], v[122:123], v[22:23] op_sel_hi:[1,0]
  v_pk_mul_f32 v[124:125], v[124:125], v[22:23] op_sel_hi:[1,0]
  v_pk_mul_f32 v[126:127], v[126:127], v[22:23] op_sel_hi:[1,0]
  v_cvt_pk_bf16_f32 v220, v120, v121
  v_cvt_pk_bf16_f32 v221, v122, v123
  v_cvt_pk_bf16_f32 v222, v124, v125
  v_cvt_pk_bf16_f32 v223, v126, v127
  buffer_store_dwordx4 v[220:223], v17, s[8:11], s85 offen offset:3072 sc1
  s_branch L_mqkv_pub
L_mqkv_v:
  s_add_u32 s34, s29, 0
  buffer_load_dwordx4 v[128:131], v17, s[8:11], s34 offen offset:0
  buffer_load_dwordx4 v[132:135], v17, s[8:11], s34 offen offset:1024
  buffer_load_dwordx4 v[136:139], v17, s[8:11], s34 offen offset:2048
  buffer_load_dwordx4 v[140:143], v17, s[8:11], s34 offen offset:3072
  s_add_u32 s34, s29, 4096
  buffer_load_dwordx4 v[144:147], v17, s[8:11], s34 offen offset:0
  buffer_load_dwordx4 v[148:151], v17, s[8:11], s34 offen offset:1024
  ds_read_b64_tr_b16 v[32:33], v18 offset:0
  ds_read_b64_tr_b16 v[34:35], v18 offset:2048
  ds_read_b64_tr_b16 v[36:37], v19 offset:0
  ds_read_b64_tr_b16 v[38:39], v19 offset:2048
  ds_read_b64_tr_b16 v[40:41], v20 offset:0
  ds_read_b64_tr_b16 v[42:43], v20 offset:2048
  ds_read_b64_tr_b16 v[44:45], v21 offset:0
  ds_read_b64_tr_b16 v[46:47], v21 offset:2048
  s_waitcnt vmcnt(5)
  s_waitcnt lgkmcnt(6)
  v_mfma_f32_32x32x16_bf16 v[64:79], v[128:131], v[32:35], 0
  ds_read_b64_tr_b16 v[48:49], v18 offset:4096
  ds_read_b64_tr_b16 v[50:51], v18 offset:6144
  s_waitcnt lgkmcnt(6)
  v_mfma_f32_32x32x16_bf16 v[80:95], v[128:131], v[36:39], 0
  ds_read_b64_tr_b16 v[52:53], v19 offset:4096
  ds_read_b64_tr_b16 v[54:55], v19 offset:6144
  buffer_load_dwordx4 v[152:155], v17, s[8:11], s34 offen offset:2048
  s_waitcnt lgkmcnt(6)
  v_mfma_f32_32x32x16_bf16 v[96:111], v[128:131], v[40:43], 0
  ds_read_b64_tr_b16 v[56:57], v20 offset:4096
  ds_read_b64_tr_b16 v[58:59], v20 offset:6144
  s_waitcnt lgkmcnt(6)
  v_mfma_f32_32x32x16_bf16 v[112:127], v[128:131], v[44:47], 0
  ds_read_b64_tr_b16 v[60:61], v21 offset:4096
  ds_read_b64_tr_b16 v[62:63], v21 offset:6144
  buffer_load_dwordx4 v[156:159], v17, s[8:11], s34 offen offset:3072
  s_waitcnt lgkmcnt(6)
  s_waitcnt vmcnt(6)
  v_mfma_f32_32x32x16_bf16 v[64:79], v[132:135], v[48:51], v[64:79]
  ds_read_b64_tr_b16 v[32:33], v18 offset:8192
  ds_read_b64_tr_b16 v[34:35], v18 offset:10240
  s_waitcnt lgkmcnt(6)
  v_mfma_f32_32x32x16_bf16 v[80:95], v[132:135], v[52:55], v[80:95]
  ds_read_b64_tr_b16 v[36:37], v19 offset:8192
  ds_read_b64_tr_b16 v[38:39], v19 offset:10240
  s_add_u32 s34, s29, 16384
  buffer_load_dwordx4 v[160:163], v17, s[8:11], s34 offen offset:0
  s_waitcnt lgkmcnt(6)
  v_mfma_f32_32x32x16_bf16 v[96:111], v[132:135], v[56:59], v[96:111]
  ds_read_b64_tr_b16 v[40:41], v20 offset:8192
  ds_read_b64_tr_b16 v[42:43], v20 offset:10240
  s_waitcnt lgkmcnt(6)
  v_mfma_f32_32x32x16_bf16 v[112:127], v[132:135], v[60:63], v[112:127]
  ds_read_b64_tr_b16 v[44:45], v21 offset:8192
  ds_read_b64_tr_b16 v[46:47], v21 offset:10240
  buffer_load_dwordx4 v[164:167], v17, s[8:11], s34 offen offset:1024
  s_waitcnt lgkmcnt(6)
  s_waitcnt vmcnt(7)
  v_mfma_f32_32x32x16_bf16 v[64:79], v[136:139], v[32:35], v[64:79]
  ds_read_b64_tr_b16 v[48:49], v18 offset:12288
  ds_read_b64_tr_b16 v[50:51], v18 offset:14336
  s_waitcnt lgkmcnt(6)
  v_mfma_f32_32x32x16_bf16 v[80:95], v[136:139], v[36:39], v[80:95]
  ds_read_b64_tr_b16 v[52:53], v19 offset:12288
  ds_read_b64_tr_b16 v[54:55], v19 offset:14336
  buffer_load_dwordx4 v[168:171], v17, s[8:11], s34 offen offset:2048
  s_waitcnt lgkmcnt(6)
  v_mfma_f32_32x32x16_bf16 v[96:111], v[136:139], v[40:43], v[96:111]
  ds_read_b64_tr_b16 v[56:57], v20 offset:12288
  ds_read_b64_tr_b16 v[58:59], v20 offset:14336
  buffer_load_dwordx4 v[172:175], v17, s[8:11], s34 offen offset:3072
  s_waitcnt lgkmcnt(6)
  v_mfma_f32_32x32x16_bf16 v[112:127], v[136:139], v[44:47], v[112:127]
  ds_read_b64_tr_b16 v[60:61], v21 offset:12288
  ds_read_b64_tr_b16 v[62:63], v21 offset:14336
  buffer_load_dwordx2 v[128:129], v12, s[8:11], s30 offen offset:0
  s_waitcnt lgkmcnt(6)
  s_waitcnt vmcnt(9)
  v_mfma_f32_32x32x16_bf16 v[64:79], v[140:143], v[48:51], v[64:79]
  ds_read_b64_tr_b16 v[32:33], v18 offset:16384
  ds_read_b64_tr_b16 v[34:35], v18 offset:18432
  s_waitcnt lgkmcnt(6)
  v_mfma_f32_32x32x16_bf16 v[80:95], v[140:143], v[52:55], v[80:95]
  ds_read_b64_tr_b16 v[36:37], v19 offset:16384
  ds_read_b64_tr_b16 v[38:39], v19 offset:18432
  s_add_u32 s34, s29, 20480
  buffer_load_dwordx4 v[176:179], v17, s[8:11], s34 offen offset:0
  s_waitcnt lgkmcnt(6)
  v_mfma_f32_32x32x16_bf16 v[96:111], v[140:143], v[56:59], v[96:111]
  ds_read_b64_tr_b16 v[40:41], v20 offset:16384
  ds_read_b64_tr_b16 v[42:43], v20 offset:18432
  buffer_load_dwordx4 v[180:183], v17, s[8:11], s34 offen offset:1024
  s_waitcnt lgkmcnt(6)
  v_mfma_f32_32x32x16_bf16 v[112:127], v[140:143], v[60:63], v[112:127]
  ds_read_b64_tr_b16 v[44:45], v21 offset:16384
  ds_read_b64_tr_b16 v[46:47], v21 offset:18432
  buffer_load_dwordx2 v[130:131], v12, s[8:11], s30 offen offset:256
  s_waitcnt lgkmcnt(6)
  s_waitcnt vmcnt(11)
  v_mfma_f32_32x32x16_bf16 v[64:79], v[144:147], v[32:35], v[64:79]
  ds_read_b64_tr_b16 v[48:49], v18 offset:20480
  ds_read_b64_tr_b16 v[50:51], v18 offset:22528
  s_waitcnt lgkmcnt(6)
  v_mfma_f32_32x32x16_bf16 v[80:95], v[144:147], v[36:39], v[80:95]
  ds_read_b64_tr_b16 v[52:53], v19 offset:20480
  ds_read_b64_tr_b16 v[54:55], v19 offset:22528
  buffer_load_dwordx4 v[184:187], v17, s[8:11], s34 offen offset:2048
  s_waitcnt lgkmcnt(6)
  v_mfma_f32_32x32x16_bf16 v[96:111], v[144:147], v[40:43], v[96:111]
  ds_read_b64_tr_b16 v[56:57], v20 offset:20480
  ds_read_b64_tr_b16 v[58:59], v20 offset:22528
  s_waitcnt lgkmcnt(6)
  v_mfma_f32_32x32x16_bf16 v[112:127], v[144:147], v[44:47], v[112:127]
  ds_read_b64_tr_b16 v[60:61], v21 offset:20480
  ds_read_b64_tr_b16 v[62:63], v21 offset:22528
  buffer_load_dwordx2 v[132:133], v12, s[8:11], s30 offen offset:512
  s_waitcnt lgkmcnt(6)
  s_waitcnt vmcnt(12)
  v_mfma_f32_32x32x16_bf16 v[64:79], v[148:151], v[48:51], v[64:79]
  ds_read_b64_tr_b16 v[32:33], v18 offset:24576
  ds_read_b64_tr_b16 v[34:35], v18 offset:26624
  s_waitcnt lgkmcnt(6)
  v_mfma_f32_32x32x16_bf16 v[80:95], v[148:151], v[52:55], v[80:95]
  ds_read_b64_tr_b16 v[36:37], v19 offset:24576
  ds_read_b64_tr_b16 v[38:39], v19 offset:26624
  buffer_load_dwordx4 v[188:191], v17, s[8:11], s34 offen offset:3072
  s_waitcnt lgkmcnt(6)
  v_mfma_f32_32x32x16_bf16 v[96:111], v[148:151], v[56:59], v[96:111]
  ds_read_b64_tr_b16 v[40:41], v20 offset:24576
  ds_read_b64_tr_b16 v[42:43], v20 offset:26624
  s_waitcnt lgkmcnt(6)
  v_mfma_f32_32x32x16_bf16 v[112:127], v[148:151], v[60:63], v[112:127]
  ds_read_b64_tr_b16 v[44:45], v21 offset:24576
  ds_read_b64_tr_b16 v[46:47], v21 offset:26624
  buffer_load_dwordx2 v[134:135], v12, s[8:11], s30 offen offset:768
  s_waitcnt lgkmcnt(6)
  s_waitcnt vmcnt(13)
  v_mfma_f32_32x32x16_bf16 v[64:79], v[152:155], v[32:35], v[64:79]
  ds_read_b64_tr_b16 v[48:49], v18 offset:28672
  ds_read_b64_tr_b16 v[50:51], v18 offset:30720
  s_waitcnt lgkmcnt(6)
  v_mfma_f32_32x32x16_bf16 v[80:95], v[152:155], v[36:39], v[80:95]
  ds_read_b64_tr_b16 v[52:53], v19 offset:28672
  ds_read_b64_tr_b16 v[54:55], v19 offset:30720
  s_add_u32 s34, s29, 32768
  buffer_load_dwordx4 v[192:195], v17, s[8:11], s34 offen offset:0
  s_waitcnt lgkmcnt(6)
  v_mfma_f32_32x32x16_bf16 v[96:111], v[152:155], v[40:43], v[96:111]
  ds_read_b64_tr_b16 v[56:57], v20 offset:28672
  ds_read_b64_tr_b16 v[58:59], v20 offset:30720
  s_waitcnt lgkmcnt(6)
  v_mfma_f32_32x32x16_bf16 v[112:127], v[152:155], v[44:47], v[112:127]
  ds_read_b64_tr_b16 v[60:61], v21 offset:28672
  ds_read_b64_tr_b16 v[62:63], v21 offset:30720
  buffer_load_dwordx2 v[136:137], v12, s[8:11], s30 offen offset:1024
  s_waitcnt lgkmcnt(6)
  s_waitcnt vmcnt(14)
  v_mfma_f32_32x32x16_bf16 v[64:79], v[156:159], v[48:51], v[64:79]
  ds_read_b64_tr_b16 v[32:33], v18 offset:32768
  ds_read_b64_tr_b16 v[34:35], v18 offset:34816
  s_waitcnt lgkmcnt(6)
  v_mfma_f32_32x32x16_bf16 v[80:95], v[156:159], v[52:55], v[80:95]
  ds_read_b64_tr_b16 v[36:37], v19 offset:32768
  ds_read_b64_tr_b16 v[38:39], v19 offset:34816
  buffer_load_dwordx4 v[196:199], v17, s[8:11], s34 offen offset:1024
  s_waitcnt lgkmcnt(6)
  v_mfma_f32_32x32x16_bf16 v[96:111], v[156:159], v[56:59], v[96:111]
  ds_read_b64_tr_b16 v[40:41], v20 offset:32768
  ds_read_b64_tr_b16 v[42:43], v20 offset:34816
  s_waitcnt lgkmcnt(6)
  v_mfma_f32_32x32x16_bf16 v[112:127], v[156:159], v[60:63], v[112:127]
  ds_read_b64_tr_b16 v[44:45], v21 offset:32768
  ds_read_b64_tr_b16 v[46:47], v21 offset:34816
  buffer_load_dwordx2 v[138:139], v12, s[8:11], s30 offen offset:1280
  s_waitcnt lgkmcnt(6)
  s_waitcnt vmcnt(15)
  v_mfma_f32_32x32x16_bf16 v[64:79], v[160:163], v[32:35], v[64:79]
  ds_read_b64_tr_b16 v[48:49], v18 offset:36864
  ds_read_b64_tr_b16 v[50:51], v18 offset:38912
  s_waitcnt lgkmcnt(6)
  v_mfma_f32_32x32x16_bf16 v[80:95], v[160:163], v[36:39], v[80:95]
  ds_read_b64_tr_b16 v[52:53], v19 offset:36864
  ds_read_b64_tr_b16 v[54:55], v19 offset:38912
  buffer_load_dwordx4 v[200:203], v17, s[8:11], s34 offen offset:2048
  s_waitcnt lgkmcnt(6)
  v_mfma_f32_32x32x16_bf16 v[96:111], v[160:163], v[40:43], v[96:111]
  ds_read_b64_tr_b16 v[56:57], v20 offset:36864
  ds_read_b64_tr_b16 v[58:59], v20 offset:38912
  s_waitcnt lgkmcnt(6)
  v_mfma_f32_32x32x16_bf16 v[112:127], v[160:163], v[44:47], v[112:127]
  ds_read_b64_tr_b16 v[60:61], v21 offset:36864
  ds_read_b64_tr_b16 v[62:63], v21 offset:38912
  buffer_load_dwordx2 v[140:141], v12, s[8:11], s30 offen offset:1536
  s_waitcnt lgkmcnt(6)
  s_waitcnt vmcnt(16)
  v_mfma_f32_32x32x16_bf16 v[64:79], v[164:167], v[48:51], v[64:79]
  ds_read_b64_tr_b16 v[32:33], v18 offset:40960
  ds_read_b64_tr_b16 v[34:35], v18 offset:43008
  s_waitcnt lgkmcnt(6)
  v_mfma_f32_32x32x16_bf16 v[80:95], v[164:167], v[52:55], v[80:95]
  ds_read_b64_tr_b16 v[36:37], v19 offset:40960
  ds_read_b64_tr_b16 v[38:39], v19 offset:43008
  buffer_load_dwordx4 v[204:207], v17, s[8:11], s34 offen offset:3072
  s_waitcnt lgkmcnt(6)
  v_mfma_f32_32x32x16_bf16 v[96:111], v[164:167], v[56:59], v[96:111]
  ds_read_b64_tr_b16 v[40:41], v20 offset:40960
  ds_read_b64_tr_b16 v[42:43], v20 offset:43008
  s_waitcnt lgkmcnt(6)
  v_mfma_f32_32x32x16_bf16 v[112:127], v[164:167], v[60:63], v[112:127]
  ds_read_b64_tr_b16 v[44:45], v21 offset:40960
  ds_read_b64_tr_b16 v[46:47], v21 offset:43008
  buffer_load_dwordx2 v[142:143], v12, s[8:11], s30 offen offset:1792
  s_waitcnt lgkmcnt(6)
  s_waitcnt vmcnt(17)
  v_mfma_f32_32x32x16_bf16 v[64:79], v[168:171], v[32:35], v[64:79]
  ds_read_b64_tr_b16 v[48:49], v18 offset:45056
  ds_read_b64_tr_b16 v[50:51], v18 offset:47104
  s_waitcnt lgkmcnt(6)
  v_mfma_f32_32x32x16_bf16 v[80:95], v[168:171], v[36:39], v[80:95]
  ds_read_b64_tr_b16 v[52:53], v19 offset:45056
  ds_read_b64_tr_b16 v[54:55], v19 offset:47104
  s_add_u32 s34, s29, 36864
  buffer_load_dwordx4 v[208:211], v17, s[8:11], s34 offen offset:0
  s_waitcnt lgkmcnt(6)
  v_mfma_f32_32x32x16_bf16 v[96:111], v[168:171], v[40:43], v[96:111]
  ds_read_b64_tr_b16 v[56:57], v20 offset:45056
  ds_read_b64_tr_b16 v[58:59], v20 offset:47104
  s_waitcnt lgkmcnt(6)
  v_mfma_f32_32x32x16_bf16 v[112:127], v[168:171], v[44:47], v[112:127]
  ds_read_b64_tr_b16 v[60:61], v21 offset:45056
  ds_read_b64_tr_b16 v[62:63], v21 offset:47104
  buffer_load_dwordx2 v[144:145], v12, s[8:11], s30 offen offset:2048
  v_subrev_u32 v18, 114688, v18
  v_subrev_u32 v19, 114688, v19
  v_subrev_u32 v20, 114688, v20
  v_subrev_u32 v21, 114688, v21
  s_barrier
  s_waitcnt lgkmcnt(6)
  s_waitcnt vmcnt(18)
  v_mfma_f32_32x32x16_bf16 v[64:79], v[172:175], v[48:51], v[64:79]
  ds_read_b64_tr_b16 v[32:33], v18 offset:0
  ds_read_b64_tr_b16 v[34:35], v18 offset:2048
  s_waitcnt lgkmcnt(6)
  v_mfma_f32_32x32x16_bf16 v[80:95], v[172:175], v[52:55], v[80:95]
  ds_read_b64_tr_b16 v[36:37], v19 offset:0
  ds_read_b64_tr_b16 v[38:39], v19 offset:2048
  buffer_load_dwordx4 v[212:215], v17, s[8:11], s34 offen offset:1024
  s_waitcnt lgkmcnt(6)
  v_mfma_f32_32x32x16_bf16 v[96:111], v[172:175], v[56:59], v[96:111]
  ds_read_b64_tr_b16 v[40:41], v20 offset:0
  ds_read_b64_tr_b16 v[42:43], v20 offset:2048
  s_waitcnt lgkmcnt(6)
  v_mfma_f32_32x32x16_bf16 v[112:127], v[172:175], v[60:63], v[112:127]
  ds_read_b64_tr_b16 v[44:45], v21 offset:0
  ds_read_b64_tr_b16 v[46:47], v21 offset:2048
  buffer_load_dwordx2 v[146:147], v12, s[8:11], s30 offen offset:2304
  s_waitcnt lgkmcnt(6)
  s_waitcnt vmcnt(18)
  v_mfma_f32_32x32x16_bf16 v[64:79], v[176:179], v[32:35], v[64:79]
  ds_read_b64_tr_b16 v[48:49], v18 offset:4096
  ds_read_b64_tr_b16 v[50:51], v18 offset:6144
  s_waitcnt lgkmcnt(6)
  v_mfma_f32_32x32x16_bf16 v[80:95], v[176:179], v[36:39], v[80:95]
  ds_read_b64_tr_b16 v[52:53], v19 offset:4096
  ds_read_b64_tr_b16 v[54:55], v19 offset:6144
  buffer_load_dwordx4 v[216:219], v17, s[8:11], s34 offen offset:2048
  s_waitcnt lgkmcnt(6)
  v_mfma_f32_32x32x16_bf16 v[96:111], v[176:179], v[40:43], v[96:111]
  ds_read_b64_tr_b16 v[56:57], v20 offset:4096
  ds_read_b64_tr_b16 v[58:59], v20 offset:6144
  s_waitcnt lgkmcnt(6)
  v_mfma_f32_32x32x16_bf16 v[112:127], v[176:179], v[44:47], v[112:127]
  ds_read_b64_tr_b16 v[60:61], v21 offset:4096
  ds_read_b64_tr_b16 v[62:63], v21 offset:6144
  buffer_load_dwordx2 v[148:149], v12, s[8:11], s30 offen offset:2560
  s_waitcnt lgkmcnt(6)
  s_waitcnt vmcnt(19)
  v_mfma_f32_32x32x16_bf16 v[64:79], v[180:183], v[48:51], v[64:79]
  ds_read_b64_tr_b16 v[32:33], v18 offset:8192
  ds_read_b64_tr_b16 v[34:35], v18 offset:10240
  s_waitcnt lgkmcnt(6)
  v_mfma_f32_32x32x16_bf16 v[80:95], v[180:183], v[52:55], v[80:95]
  ds_read_b64_tr_b16 v[36:37], v19 offset:8192
  ds_read_b64_tr_b16 v[38:39], v19 offset:10240
  buffer_load_dwordx4 v[220:223], v17, s[8:11], s34 offen offset:3072
  s_waitcnt lgkmcnt(6)
  v_mfma_f32_32x32x16_bf16 v[96:111], v[180:183], v[56:59], v[96:111]
  ds_read_b64_tr_b16 v[40:41], v20 offset:8192
  ds_read_b64_tr_b16 v[42:43], v20 offset:10240
  s_waitcnt lgkmcnt(6)
  v_mfma_f32_32x32x16_bf16 v[112:127], v[180:183], v[60:63], v[112:127]
  ds_read_b64_tr_b16 v[44:45], v21 offset:8192
  ds_read_b64_tr_b16 v[46:47], v21 offset:10240
  buffer_load_dwordx2 v[150:151], v12, s[8:11], s30 offen offset:2816
  s_waitcnt lgkmcnt(6)
  s_waitcnt vmcnt(19)
  v_mfma_f32_32x32x16_bf16 v[64:79], v[184:187], v[32:35], v[64:79]
  ds_read_b64_tr_b16 v[48:49], v18 offset:12288
  ds_read_b64_tr_b16 v[50:51], v18 offset:14336
  s_waitcnt lgkmcnt(6)
  v_mfma_f32_32x32x16_bf16 v[80:95], v[184:187], v[36:39], v[80:95]
  ds_read_b64_tr_b16 v[52:53], v19 offset:12288
  ds_read_b64_tr_b16 v[54:55], v19 offset:14336
  s_add_u32 s34, s29, 49152
  buffer_load_dwordx4 v[224:227], v17, s[8:11], s34 offen offset:0
  s_waitcnt lgkmcnt(6)
  v_mfma_f32_32x32x16_bf16 v[96:111], v[184:187], v[40:43], v[96:111]
  ds_read_b64_tr_b16 v[56:57], v20 offset:12288
  ds_read_b64_tr_b16 v[58:59], v20 offset:14336
  s_waitcnt lgkmcnt(6)
  v_mfma_f32_32x32x16_bf16 v[112:127], v[184:187], v[44:47], v[112:127]
  ds_read_b64_tr_b16 v[60:61], v21 offset:12288
  ds_read_b64_tr_b16 v[62:63], v21 offset:14336
  buffer_load_dwordx2 v[152:153], v12, s[8:11], s30 offen offset:3072
  s_waitcnt lgkmcnt(6)
  s_waitcnt vmcnt(19)
  v_mfma_f32_32x32x16_bf16 v[64:79], v[188:191], v[48:51], v[64:79]
  ds_read_b64_tr_b16 v[32:33], v18 offset:16384
  ds_read_b64_tr_b16 v[34:35], v18 offset:18432
  s_waitcnt lgkmcnt(6)
  v_mfma_f32_32x32x16_bf16 v[80:95], v[188:191], v[52:55], v[80:95]
  ds_read_b64_tr_b16 v[36:37], v19 offset:16384
  ds_read_b64_tr_b16 v[38:39], v19 offset:18432
  buffer_load_dwordx4 v[228:231], v17, s[8:11], s34 offen offset:1024
  s_waitcnt lgkmcnt(6)
  v_mfma_f32_32x32x16_bf16 v[96:111], v[188:191], v[56:59], v[96:111]
  ds_read_b64_tr_b16 v[40:41], v20 offset:16384
  ds_read_b64_tr_b16 v[42:43], v20 offset:18432
  s_waitcnt lgkmcnt(6)
  v_mfma_f32_32x32x16_bf16 v[112:127], v[188:191], v[60:63], v[112:127]
  ds_read_b64_tr_b16 v[44:45], v21 offset:16384
  ds_read_b64_tr_b16 v[46:47], v21 offset:18432
  buffer_load_dwordx2 v[154:155], v12, s[8:11], s30 offen offset:3328
  s_waitcnt lgkmcnt(6)
  s_waitcnt vmcnt(19)
  v_mfma_f32_32x32x16_bf16 v[64:79], v[192:195], v[32:35], v[64:79]
  ds_read_b64_tr_b16 v[48:49], v18 offset:20480
  ds_read_b64_tr_b16 v[50:51], v18 offset:22528
  s_waitcnt lgkmcnt(6)
  v_mfma_f32_32x32x16_bf16 v[80:95], v[192:195], v[36:39], v[80:95]
  ds_read_b64_tr_b16 v[52:53], v19 offset:20480
  ds_read_b64_tr_b16 v[54:55], v19 offset:22528
  buffer_load_dwordx4 v[232:235], v17, s[8:11], s34 offen offset:2048
  s_waitcnt lgkmcnt(6)
  v_mfma_f32_32x32x16_bf16 v[96:111], v[192:195], v[40:43], v[96:111]
  ds_read_b64_tr_b16 v[56:57], v20 offset:20480
  ds_read_b64_tr_b16 v[58:59], v20 offset:22528
  s_waitcnt lgkmcnt(6)
  v_mfma_f32_32x32x16_bf16 v[112:127], v[192:195], v[44:47], v[112:127]
  ds_read_b64_tr_b16 v[60:61], v21 offset:20480
  ds_read_b64_tr_b16 v[62:63], v21 offset:22528
  buffer_load_dwordx2 v[156:157], v12, s[8:11], s30 offen offset:3584
  s_waitcnt lgkmcnt(6)
  s_waitcnt vmcnt(19)
  v_mfma_f32_32x32x16_bf16 v[64:79], v[196:199], v[48:51], v[64:79]
  ds_read_b64_tr_b16 v[32:33], v18 offset:24576
  ds_read_b64_tr_b16 v[34:35], v18 offset:26624
  s_waitcnt lgkmcnt(6)
  v_mfma_f32_32x32x16_bf16 v[80:95], v[196:199], v[52:55], v[80:95]
  ds_read_b64_tr_b16 v[36:37], v19 offset:24576
  ds_read_b64_tr_b16 v[38:39], v19 offset:26624
  buffer_load_dwordx4 v[236:239], v17, s[8:11], s34 offen offset:3072
  s_waitcnt lgkmcnt(6)
  v_mfma_f32_32x32x16_bf16 v[96:111], v[196:199], v[56:59], v[96:111]
  ds_read_b64_tr_b16 v[40:41], v20 offset:24576
  ds_read_b64_tr_b16 v[42:43], v20 offset:26624
  s_waitcnt lgkmcnt(6)
  v_mfma_f32_32x32x16_bf16 v[112:127], v[196:199], v[60:63], v[112:127]
  ds_read_b64_tr_b16 v[44:45], v21 offset:24576
  ds_read_b64_tr_b16 v[46:47], v21 offset:26624
  buffer_load_dwordx2 v[158:159], v12, s[8:11], s30 offen offset:3840
  s_waitcnt lgkmcnt(6)
  s_waitcnt vmcnt(19)
  v_mfma_f32_32x32x16_bf16 v[64:79], v[200:203], v[32:35], v[64:79]
  ds_read_b64_tr_b16 v[48:49], v18 offset:28672
  ds_read_b64_tr_b16 v[50:51], v18 offset:30720
  s_waitcnt lgkmcnt(6)
  v_mfma_f32_32x32x16_bf16 v[80:95], v[200:203], v[36:39], v[80:95]
  ds_read_b64_tr_b16 v[52:53], v19 offset:28672
  ds_read_b64_tr_b16 v[54:55], v19 offset:30720
  s_add_u32 s34, s29, 53248
  buffer_load_dwordx4 v[240:243], v17, s[8:11], s34 offen offset:0
  s_waitcnt lgkmcnt(6)
  v_mfma_f32_32x32x16_bf16 v[96:111], v[200:203], v[40:43], v[96:111]
  ds_read_b64_tr_b16 v[56:57], v20 offset:28672
  ds_read_b64_tr_b16 v[58:59], v20 offset:30720
  s_waitcnt lgkmcnt(6)
  v_mfma_f32_32x32x16_bf16 v[112:127], v[200:203], v[44:47], v[112:127]
  ds_read_b64_tr_b16 v[60:61], v21 offset:28672
  ds_read_b64_tr_b16 v[62:63], v21 offset:30720
  buffer_load_dwordx4 v[160:163], v10, s[8:11], s35 offen offset:0
  s_waitcnt lgkmcnt(6)
  s_waitcnt vmcnt(19)
  v_mfma_f32_32x32x16_bf16 v[64:79], v[204:207], v[48:51], v[64:79]
  ds_read_b64_tr_b16 v[32:33], v18 offset:32768
  ds_read_b64_tr_b16 v[34:35], v18 offset:34816
  s_waitcnt lgkmcnt(6)
  v_mfma_f32_32x32x16_bf16 v[80:95], v[204:207], v[52:55], v[80:95]
  ds_read_b64_tr_b16 v[36:37], v19 offset:32768
  ds_read_b64_tr_b16 v[38:39], v19 offset:34816
  buffer_load_dwordx4 v[244:247], v17, s[8:11], s34 offen offset:1024
  s_waitcnt lgkmcnt(6)
  v_mfma_f32_32x32x16_bf16 v[96:111], v[204:207], v[56:59], v[96:111]
  ds_read_b64_tr_b16 v[40:41], v20 offset:32768
  ds_read_b64_tr_b16 v[42:43], v20 offset:34816
  s_waitcnt lgkmcnt(6)
  v_mfma_f32_32x32x16_bf16 v[112:127], v[204:207], v[60:63], v[112:127]
  ds_read_b64_tr_b16 v[44:45], v21 offset:32768
  ds_read_b64_tr_b16 v[46:47], v21 offset:34816
  buffer_load_dwordx4 v[164:167], v10, s[8:11], s35 offen offset:512
  s_waitcnt lgkmcnt(6)
  s_waitcnt vmcnt(19)
  v_mfma_f32_32x32x16_bf16 v[64:79], v[208:211], v[32:35], v[64:79]
  ds_read_b64_tr_b16 v[48:49], v18 offset:36864
  ds_read_b64_tr_b16 v[50:51], v18 offset:38912
  s_waitcnt lgkmcnt(6)
  v_mfma_f32_32x32x16_bf16 v[80:95], v[208:211], v[36:39], v[80:95]
  ds_read_b64_tr_b16 v[52:53], v19 offset:36864
  ds_read_b64_tr_b16 v[54:55], v19 offset:38912
  buffer_load_dwordx4 v[248:251], v17, s[8:11], s34 offen offset:2048
  s_waitcnt lgkmcnt(6)
  v_mfma_f32_32x32x16_bf16 v[96:111], v[208:211], v[40:43], v[96:111]
  ds_read_b64_tr_b16 v[56:57], v20 offset:36864
  ds_read_b64_tr_b16 v[58:59], v20 offset:38912
  s_waitcnt lgkmcnt(6)
  v_mfma_f32_32x32x16_bf16 v[112:127], v[208:211], v[44:47], v[112:127]
  ds_read_b64_tr_b16 v[60:61], v21 offset:36864
  ds_read_b64_tr_b16 v[62:63], v21 offset:38912
  buffer_load_dwordx4 v[168:171], v10, s[8:11], s35 offen offset:1024
  s_waitcnt lgkmcnt(6)
  s_waitcnt vmcnt(19)
  v_mfma_f32_32x32x16_bf16 v[64:79], v[212:215], v[48:51], v[64:79]
  ds_read_b64_tr_b16 v[32:33], v18 offset:40960
  ds_read_b64_tr_b16 v[34:35], v18 offset:43008
  s_waitcnt lgkmcnt(6)
  v_mfma_f32_32x32x16_bf16 v[80:95], v[212:215], v[52:55], v[80:95]
  ds_read_b64_tr_b16 v[36:37], v19 offset:40960
  ds_read_b64_tr_b16 v[38:39], v19 offset:43008
  buffer_load_dwordx4 v[252:255], v17, s[8:11], s34 offen offset:3072
  s_waitcnt lgkmcnt(6)
  v_mfma_f32_32x32x16_bf16 v[96:111], v[212:215], v[56:59], v[96:111]
  ds_read_b64_tr_b16 v[40:41], v20 offset:40960
  ds_read_b64_tr_b16 v[42:43], v20 offset:43008
  s_waitcnt lgkmcnt(6)
  v_mfma_f32_32x32x16_bf16 v[112:127], v[212:215], v[60:63], v[112:127]
  ds_read_b64_tr_b16 v[44:45], v21 offset:40960
  ds_read_b64_tr_b16 v[46:47], v21 offset:43008
  buffer_load_dwordx4 v[172:175], v10, s[8:11], s35 offen offset:1536
  s_waitcnt lgkmcnt(6)
  s_waitcnt vmcnt(19)
  v_mfma_f32_32x32x16_bf16 v[64:79], v[216:219], v[32:35], v[64:79]
  ds_read_b64_tr_b16 v[48:49], v18 offset:45056
  ds_read_b64_tr_b16 v[50:51], v18 offset:47104
  s_waitcnt vmcnt(8)
  v_add_f32 v2, v128, v130
  v_add_f32 v4, v132, v134
  s_waitcnt lgkmcnt(6)
  v_mfma_f32_32x32x16_bf16 v[80:95], v[216:219], v[36:39], v[80:95]
  ds_read_b64_tr_b16 v[52:53], v19 offset:45056
  ds_read_b64_tr_b16 v[54:55], v19 offset:47104
  v_add_f32 v3, v129, v131
  v_add_f32 v5, v133, v135
  v_add_f32 v2, v2, v136
  s_waitcnt lgkmcnt(6)
  v_mfma_f32_32x32x16_bf16 v[96:111], v[216:219], v[40:43], v[96:111]
  ds_read_b64_tr_b16 v[56:57], v20 offset:45056
  ds_read_b64_tr_b16 v[58:59], v20 offset:47104
  v_add_f32 v3, v3, v137
  v_add_f32 v4, v4, v138
  v_add_f32 v5, v5, v139
  s_waitcnt lgkmcnt(6)
  v_mfma_f32_32x32x16_bf16 v[112:127], v[216:219], v[44:47], v[112:127]
  ds_read_b64_tr_b16 v[60:61], v21 offset:45056
  ds_read_b64_tr_b16 v[62:63], v21 offset:47104
  v_add_f32 v2, v2, v140
  v_add_f32 v3, v3, v141
  v_add_f32 v4, v4, v142
  v_add_f32 v5, v5, v143
  s_waitcnt lgkmcnt(6)
  v_mfma_f32_32x32x16_bf16 v[64:79], v[220:223], v[48:51], v[64:79]
  ds_read_b64_tr_b16 v[32:33], v18 offset:49152
  ds_read_b64_tr_b16 v[34:35], v18 offset:51200
  v_add_f32 v2, v2, v144
  v_add_f32 v3, v3, v145
  v_add_f32 v4, v4, v146
  s_waitcnt lgkmcnt(6)
  v_mfma_f32_32x32x16_bf16 v[80:95], v[220:223], v[52:55], v[80:95]
  ds_read_b64_tr_b16 v[36:37], v19 offset:49152
  ds_read_b64_tr_b16 v[38:39], v19 offset:51200
  v_add_f32 v5, v5, v147
  v_add_f32 v2, v2, v148
  v_add_f32 v3, v3, v149
  s_waitcnt lgkmcnt(6)
  v_mfma_f32_32x32x16_bf16 v[96:111], v[220:223], v[56:59], v[96:111]
  ds_read_b64_tr_b16 v[40:41], v20 offset:49152
  ds_read_b64_tr_b16 v[42:43], v20 offset:51200
  v_add_f32 v4, v4, v150
  v_add_f32 v5, v5, v151
  v_add_f32 v2, v2, v152
  s_waitcnt lgkmcnt(6)
  v_mfma_f32_32x32x16_bf16 v[112:127], v[220:223], v[60:63], v[112:127]
  ds_read_b64_tr_b16 v[44:45], v21 offset:49152
  ds_read_b64_tr_b16 v[46:47], v21 offset:51200
  v_add_f32 v3, v3, v153
  v_add_f32 v4, v4, v154
  v_add_f32 v5, v5, v155
  s_waitcnt lgkmcnt(6)
  v_mfma_f32_32x32x16_bf16 v[64:79], v[224:227], v[32:35], v[64:79]
  ds_read_b64_tr_b16 v[48:49], v18 offset:53248
  ds_read_b64_tr_b16 v[50:51], v18 offset:55296
  v_add_f32 v2, v2, v156
  v_add_f32 v3, v3, v157
  v_add_f32 v4, v4, v158
  s_waitcnt lgkmcnt(6)
  v_mfma_f32_32x32x16_bf16 v[80:95], v[224:227], v[36:39], v[80:95]
  ds_read_b64_tr_b16 v[52:53], v19 offset:53248
  ds_read_b64_tr_b16 v[54:55], v19 offset:55296
  v_add_f32 v5, v5, v159
  v_add_f32 v2, v2, v4
  v_add_f32 v3, v3, v5
  s_waitcnt lgkmcnt(6)
  v_mfma_f32_32x32x16_bf16 v[96:111], v[224:227], v[40:43], v[96:111]
  ds_read_b64_tr_b16 v[56:57], v20 offset:53248
  ds_read_b64_tr_b16 v[58:59], v20 offset:55296
  v_mov_b32 v4, v2
  v_mov_b32 v5, v3
  s_nop 1
  s_waitcnt lgkmcnt(6)
  v_mfma_f32_32x32x16_bf16 v[112:127], v[224:227], v[44:47], v[112:127]
  ds_read_b64_tr_b16 v[60:61], v21 offset:53248
  ds_read_b64_tr_b16 v[62:63], v21 offset:55296
  v_permlane32_swap_b32 v2, v4
  v_permlane32_swap_b32 v3, v5
  s_nop 1
  s_waitcnt lgkmcnt(6)
  v_mfma_f32_32x32x16_bf16 v[64:79], v[228:231], v[48:51], v[64:79]
  ds_read_b64_tr_b16 v[32:33], v18 offset:57344
  ds_read_b64_tr_b16 v[34:35], v18 offset:59392
  v_add_f32 v2, v2, v4
  v_add_f32 v3, v3, v5
  v_mul_f32 v2, 0xbb000000, v2
  s_waitcnt lgkmcnt(6)
  v_mfma_f32_32x32x16_bf16 v[80:95], v[228:231], v[52:55], v[80:95]
  ds_read_b64_tr_b16 v[36:37], v19 offset:57344
  ds_read_b64_tr_b16 v[38:39], v19 offset:59392
  v_mul_f32 v3, 0x3b000000, v3
  v_fma_f32 v3, -v2, v2, v3
  v_max_f32 v3, 0, v3
  s_waitcnt lgkmcnt(6)
  v_mfma_f32_32x32x16_bf16 v[96:111], v[228:231], v[56:59], v[96:111]
  ds_read_b64_tr_b16 v[40:41], v20 offset:57344
  ds_read_b64_tr_b16 v[42:43], v20 offset:59392
  v_add_f32 v26, 0x3727c5ac, v3
  v_rsq_f32 v6, v26
  v_cvt_pk_bf16_f32 v4, v2, v2
  s_waitcnt lgkmcnt(6)
  v_mfma_f32_32x32x16_bf16 v[112:127], v[228:231], v[60:63], v[112:127]
  ds_read_b64_tr_b16 v[44:45], v21 offset:57344
  ds_read_b64_tr_b16 v[46:47], v21 offset:59392
  v_and_b32 v4, 0xffff0000, v4
  v_sub_f32 v4, v2, v4
  v_cvt_pk_bf16_f32 v4, v2, v4
  s_waitcnt lgkmcnt(6)
  v_mfma_f32_32x32x16_bf16 v[64:79], v[232:235], v[32:35], v[64:79]
  ds_read_b64_tr_b16 v[48:49], v18 offset:61440
  ds_read_b64_tr_b16 v[50:51], v18 offset:63488
  v_cndmask_b32_e64 v28, 0, v4, s[90:91]
  v_cndmask_b32_e64 v29, 0, v4, s[90:91]
  s_waitcnt lgkmcnt(6)
  v_mfma_f32_32x32x16_bf16 v[80:95], v[232:235], v[36:39], v[80:95]
  ds_read_b64_tr_b16 v[52:53], v19 offset:61440
  ds_read_b64_tr_b16 v[54:55], v19 offset:63488
  v_mov_b32 v30, 0
  v_mov_b32 v31, 0
  v_lshl_add_u32 v4, v11, 2, s93
  s_waitcnt lgkmcnt(6)
  v_mfma_f32_32x32x16_bf16 v[96:111], v[232:235], v[40:43], v[96:111]
  ds_read_b64_tr_b16 v[56:57], v20 offset:61440
  ds_read_b64_tr_b16 v[58:59], v20 offset:63488
  ds_write_b32 v4, v6
  v_lshl_add_u32 v4, v7, 4, s93
  ds_read_b128 v[176:179], v4 offset:0
  s_waitcnt lgkmcnt(8)
  v_mfma_f32_32x32x16_bf16 v[112:127], v[232:235], v[44:47], v[112:127]
  ds_read_b64_tr_b16 v[60:61], v21 offset:61440
  ds_read_b64_tr_b16 v[62:63], v21 offset:63488
  ds_read_b128 v[180:183], v4 offset:32
  ds_read_b128 v[184:187], v4 offset:64
  ds_read_b128 v[188:191], v4 offset:96
  v_add_u32 v18, 65536, v18
  v_add_u32 v19, 65536, v19
  v_add_u32 v20, 65536, v20
  v_add_u32 v21, 65536, v21
  s_waitcnt lgkmcnt(11)
  v_mfma_f32_32x32x16_bf16 v[64:79], v[236:239], v[48:51], v[64:79]
  ds_read_b64_tr_b16 v[32:33], v18 offset:0
  ds_read_b64_tr_b16 v[34:35], v18 offset:2048
  s_waitcnt lgkmcnt(11)
  v_mfma_f32_32x32x16_bf16 v[80:95], v[236:239], v[52:55], v[80:95]
  ds_read_b64_tr_b16 v[36:37], v18 offset:4096
  ds_read_b64_tr_b16 v[38:39], v18 offset:6144
  s_waitcnt lgkmcnt(11)
  v_mfma_f32_32x32x16_bf16 v[96:111], v[236:239], v[56:59], v[96:111]
  ds_read_b64_tr_b16 v[40:41], v18 offset:8192
  ds_read_b64_tr_b16 v[42:43], v18 offset:10240
  s_waitcnt lgkmcnt(9)
  v_mfma_f32_32x32x16_bf16 v[112:127], v[236:239], v[60:63], v[112:127]
  ds_read_b64_tr_b16 v[44:45], v18 offset:12288
  ds_read_b64_tr_b16 v[46:47], v18 offset:14336
  s_waitcnt vmcnt(0)
  v_mfma_f32_32x32x16_bf16 v[64:79], v[28:31], v[160:163], v[64:79]
  v_mfma_f32_32x32x16_bf16 v[80:95], v[28:31], v[164:167], v[80:95]
  v_mfma_f32_32x32x16_bf16 v[96:111], v[28:31], v[168:171], v[96:111]
  v_mfma_f32_32x32x16_bf16 v[112:127], v[28:31], v[172:175], v[112:127]
  s_waitcnt lgkmcnt(6)
  v_mfma_f32_32x32x16_bf16 v[64:79], v[240:243], v[32:35], v[64:79]
  ds_read_b64_tr_b16 v[48:49], v19 offset:0
  ds_read_b64_tr_b16 v[50:51], v19 offset:2048
  s_waitcnt lgkmcnt(6)
  v_mfma_f32_32x32x16_bf16 v[64:79], v[244:247], v[36:39], v[64:79]
  ds_read_b64_tr_b16 v[52:53], v19 offset:4096
  ds_read_b64_tr_b16 v[54:55], v19 offset:6144
  s_waitcnt lgkmcnt(6)
  v_mfma_f32_32x32x16_bf16 v[64:79], v[248:251], v[40:43], v[64:79]
  ds_read_b64_tr_b16 v[56:57], v19 offset:8192
  ds_read_b64_tr_b16 v[58:59], v19 offset:10240
  s_waitcnt lgkmcnt(6)
  v_mfma_f32_32x32x16_bf16 v[64:79], v[252:255], v[44:47], v[64:79]
  ds_read_b64_tr_b16 v[60:61], v19 offset:12288
  ds_read_b64_tr_b16 v[62:63], v19 offset:14336
  s_waitcnt lgkmcnt(6)
  v_mfma_f32_32x32x16_bf16 v[80:95], v[240:243], v[48:51], v[80:95]
  ds_read_b64_tr_b16 v[32:33], v20 offset:0
  ds_read_b64_tr_b16 v[34:35], v20 offset:2048
  s_nop 7
  v_mul_f32 v64, v64, v176
  v_mul_f32 v65, v65, v177
  v_mul_f32 v66, v66, v178
  v_mul_f32 v67, v67, v179
  v_mul_f32 v68, v68, v180
  v_mul_f32 v69, v69, v181
  s_waitcnt lgkmcnt(6)
  v_mfma_f32_32x32x16_bf16 v[80:95], v[244:247], v[52:55], v[80:95]
  ds_read_b64_tr_b16 v[36:37], v20 offset:4096
  ds_read_b64_tr_b16 v[38:39], v20 offset:6144
  v_mul_f32 v70, v70, v182
  v_mul_f32 v71, v71, v183
  v_cvt_pk_bf16_f32 v192, v64, v65
  v_cvt_pk_bf16_f32 v193, v66, v67
  v_cvt_pk_bf16_f32 v194, v68, v69
  v_cvt_pk_bf16_f32 v195, v70, v71
  s_waitcnt lgkmcnt(6)
  v_mfma_f32_32x32x16_bf16 v[80:95], v[248:251], v[56:59], v[80:95]
  ds_read_b64_tr_b16 v[40:41], v20 offset:8192
  ds_read_b64_tr_b16 v[42:43], v20 offset:10240
  buffer_store_dwordx4 v[192:195], v13, s[8:11], s84 offen offset:0 sc1
  v_mul_f32 v72, v72, v184
  v_mul_f32 v73, v73, v185
  v_mul_f32 v74, v74, v186
  v_mul_f32 v75, v75, v187
  v_mul_f32 v76, v76, v188
  s_waitcnt lgkmcnt(6)
  v_mfma_f32_32x32x16_bf16 v[80:95], v[252:255], v[60:63], v[80:95]
  ds_read_b64_tr_b16 v[44:45], v20 offset:12288
  ds_read_b64_tr_b16 v[46:47], v20 offset:14336
  v_mul_f32 v77, v77, v189
  v_mul_f32 v78, v78, v190
  v_mul_f32 v79, v79, v191
  v_cvt_pk_bf16_f32 v196, v72, v73
  v_cvt_pk_bf16_f32 v197, v74, v75
  v_cvt_pk_bf16_f32 v198, v76, v77
  s_waitcnt lgkmcnt(6)
  v_mfma_f32_32x32x16_bf16 v[96:111], v[240:243], v[32:35], v[96:111]
  ds_read_b64_tr_b16 v[48:49], v21 offset:0
  ds_read_b64_tr_b16 v[50:51], v21 offset:2048
  v_cvt_pk_bf16_f32 v199, v78, v79
  buffer_store_dwordx4 v[196:199], v13, s[8:11], s84 offen offset:512 sc1
  v_mul_f32 v80, v80, v176
  v_mul_f32 v81, v81, v177
  v_mul_f32 v82, v82, v178
  v_mul_f32 v83, v83, v179
  s_waitcnt lgkmcnt(6)
  v_mfma_f32_32x32x16_bf16 v[96:111], v[244:247], v[36:39], v[96:111]
  ds_read_b64_tr_b16 v[52:53], v21 offset:4096
  ds_read_b64_tr_b16 v[54:55], v21 offset:6144
  v_mul_f32 v84, v84, v180
  v_mul_f32 v85, v85, v181
  v_mul_f32 v86, v86, v182
  v_mul_f32 v87, v87, v183
  v_cvt_pk_bf16_f32 v200, v80, v81
  v_cvt_pk_bf16_f32 v201, v82, v83
  s_waitcnt lgkmcnt(6)
  v_mfma_f32_32x32x16_bf16 v[96:111], v[248:251], v[40:43], v[96:111]
  ds_read_b64_tr_b16 v[56:57], v21 offset:8192
  ds_read_b64_tr_b16 v[58:59], v21 offset:10240
  v_cvt_pk_bf16_f32 v202, v84, v85
  v_cvt_pk_bf16_f32 v203, v86, v87
  buffer_store_dwordx4 v[200:203], v13, s[8:11], s84 offen offset:2048 sc1
  v_mul_f32 v88, v88, v184
  v_mul_f32 v89, v89, v185
  v_mul_f32 v90, v90, v186
  s_waitcnt lgkmcnt(6)
  v_mfma_f32_32x32x16_bf16 v[96:111], v[252:255], v[44:47], v[96:111]
  ds_read_b64_tr_b16 v[60:61], v21 offset:12288
  ds_read_b64_tr_b16 v[62:63], v21 offset:14336
  v_mul_f32 v91, v91, v187
  v_mul_f32 v92, v92, v188
  v_mul_f32 v93, v93, v189
  v_mul_f32 v94, v94, v190
  v_mul_f32 v95, v95, v191
  v_cvt_pk_bf16_f32 v204, v88, v89
  s_waitcnt lgkmcnt(6)
  v_mfma_f32_32x32x16_bf16 v[112:127], v[240:243], v[48:51], v[112:127]
  v_cvt_pk_bf16_f32 v205, v90, v91
  v_cvt_pk_bf16_f32 v206, v92, v93
  v_cvt_pk_bf16_f32 v207, v94, v95
  buffer_store_dwordx4 v[204:207], v13, s[8:11], s84 offen offset:2560 sc1
  v_mul_f32 v96, v96, v176
  v_mul_f32 v97, v97, v177
  s_waitcnt lgkmcnt(4)
  v_mfma_f32_32x32x16_bf16 v[112:127], v[244:247], v[52:55], v[112:127]
  v_mul_f32 v98, v98, v178
  v_mul_f32 v99, v99, v179
  v_mul_f32 v100, v100, v180
  v_mul_f32 v101, v101, v181
  v_mul_f32 v102, v102, v182
  v_mul_f32 v103, v103, v183
  s_waitcnt lgkmcnt(2)
  v_mfma_f32_32x32x16_bf16 v[112:127], v[248:251], v[56:59], v[112:127]
  v_cvt_pk_bf16_f32 v208, v96, v97
  v_cvt_pk_bf16_f32 v209, v98, v99
  v_cvt_pk_bf16_f32 v210, v100, v101
  v_cvt_pk_bf16_f32 v211, v102, v103
  buffer_store_dwordx4 v[208:211], v13, s[8:11], s85 offen offset:0 sc1
  v_mul_f32 v104, v104, v184
  s_waitcnt lgkmcnt(0)
  v_mfma_f32_32x32x16_bf16 v[112:127], v[252:255], v[60:63], v[112:127]
  v_mul_f32 v105, v105, v185
  v_mul_f32 v106, v106, v186
  v_mul_f32 v107, v107, v187
  v_mul_f32 v108, v108, v188
  v_mul_f32 v109, v109, v189
  v_mul_f32 v110, v110, v190
  s_waitcnt lgkmcnt(0)
  v_mul_f32 v111, v111, v191
  v_cvt_pk_bf16_f32 v212, v104, v105
  v_cvt_pk_bf16_f32 v213, v106, v107
  v_cvt_pk_bf16_f32 v214, v108, v109
  v_cvt_pk_bf16_f32 v215, v110, v111
  buffer_store_dwordx4 v[212:215], v13, s[8:11], s85 offen offset:512 sc1
  s_nop 3
  v_pk_mul_f32 v[112:113], v[112:113], v[176:177]
  v_pk_mul_f32 v[114:115], v[114:115], v[178:179]
  v_pk_mul_f32 v[116:117], v[116:117], v[180:181]
  v_pk_mul_f32 v[118:119], v[118:119], v[182:183]
  v_cvt_pk_bf16_f32 v216, v112, v113
  v_cvt_pk_bf16_f32 v217, v114, v115
  v_cvt_pk_bf16_f32 v218, v116, v117
  v_cvt_pk_bf16_f32 v219, v118, v119
  buffer_store_dwordx4 v[216:219], v13, s[8:11], s85 offen offset:2048 sc1
  v_pk_mul_f32 v[120:121], v[120:121], v[184:185]
  v_pk_mul_f32 v[122:123], v[122:123], v[186:187]
  v_pk_mul_f32 v[124:125], v[124:125], v[188:189]
  v_pk_mul_f32 v[126:127], v[126:127], v[190:191]
  v_cvt_pk_bf16_f32 v220, v120, v121
  v_cvt_pk_bf16_f32 v221, v122, v123
  v_cvt_pk_bf16_f32 v222, v124, v125
  v_cvt_pk_bf16_f32 v223, v126, v127
  buffer_store_dwordx4 v[220:223], v13, s[8:11], s85 offen offset:2560 sc1
  s_branch L_mqkv_pub
L_mqkv_B:
  s_and_b32 s26, s5, 3
  v_lshrrev_b32 v3, 4, v1
  v_and_b32 v4, 15, v1
  v_lshrrev_b32 v5, 2, v4
  v_xor_b32 v5, v5, v3
  v_and_b32 v4, 3, v4
  v_lshl_add_u32 v4, v5, 2, v4
  v_lshlrev_b32 v4, 4, v4
  v_mul_u32_u24 v3, 3072, v3
  s_lshl_b32 s28, s25, 8
  v_add3_u32 v16, v3, v4, s28
  s_mul_i32 s32, s26, 12288
  s_lshl_b32 s31, s26, 10
  s_mov_b32 s12, s38
  s_and_b32 s13, s39, 0xffff
  s_mov_b32 s14, 1572864
  s_mov_b32 s15, 0x20000
  s_waitcnt vmcnt(0) lgkmcnt(0)
  s_barrier
  s_add_u32 m0, s31, 0
  s_add_u32 s33, s32, 589824
  buffer_load_dwordx4 v16, s[12:15], s33 offen lds
  s_add_u32 m0, s31, 4096
  s_add_u32 s33, s32, 638976
  buffer_load_dwordx4 v16, s[12:15], s33 offen lds
  s_add_u32 m0, s31, 8192
  s_add_u32 s33, s32, 688128
  buffer_load_dwordx4 v16, s[12:15], s33 offen lds
  s_add_u32 m0, s31, 12288
  s_add_u32 s33, s32, 737280
  buffer_load_dwordx4 v16, s[12:15], s33 offen lds
  s_add_u32 m0, s31, 16384
  s_add_u32 s33, s32, 786432
  buffer_load_dwordx4 v16, s[12:15], s33 offen lds
  s_add_u32 m0, s31, 20480
  s_add_u32 s33, s32, 835584
  buffer_load_dwordx4 v16, s[12:15], s33 offen lds
  s_add_u32 m0, s31, 24576
  s_add_u32 s33, s32, 884736
  buffer_load_dwordx4 v16, s[12:15], s33 offen lds
  s_add_u32 m0, s31, 28672
  s_add_u32 s33, s32, 933888
  buffer_load_dwordx4 v16, s[12:15], s33 offen lds
  s_add_u32 m0, s31, 32768
  s_add_u32 s33, s32, 983040
  buffer_load_dwordx4 v16, s[12:15], s33 offen lds
  s_add_u32 m0, s31, 36864
  s_add_u32 s33, s32, 1032192
  buffer_load_dwordx4 v16, s[12:15], s33 offen lds
  s_add_u32 m0, s31, 40960
  s_add_u32 s33, s32, 1081344
  buffer_load_dwordx4 v16, s[12:15], s33 offen lds
  s_add_u32 m0, s31, 45056
  s_add_u32 s33, s32, 1130496
  buffer_load_dwordx4 v16, s[12:15], s33 offen lds
  s_add_u32 m0, s31, 49152
  s_add_u32 s33, s32, 1179648
  buffer_load_dwordx4 v16, s[12:15], s33 offen lds
  s_add_u32 m0, s31, 53248
  s_add_u32 s33, s32, 1228800
  buffer_load_dwordx4 v16, s[12:15], s33 offen lds
  s_add_u32 m0, s31, 57344
  s_add_u32 s33, s32, 1277952
  buffer_load_dwordx4 v16, s[12:15], s33 offen lds
  s_add_u32 m0, s31, 61440
  s_add_u32 s33, s32, 1327104
  buffer_load_dwordx4 v16, s[12:15], s33 offen lds
  s_add_u32 m0, s31, 65536
  s_add_u32 s33, s32, 1376256
  buffer_load_dwordx4 v16, s[12:15], s33 offen lds
  s_add_u32 m0, s31, 69632
  s_add_u32 s33, s32, 1425408
  buffer_load_dwordx4 v16, s[12:15], s33 offen lds
  s_add_u32 m0, s31, 73728
  s_add_u32 s33, s32, 1474560
  buffer_load_dwordx4 v16, s[12:15], s33 offen lds
  s_add_u32 m0, s31, 77824
  s_add_u32 s33, s32, 1523712
  buffer_load_dwordx4 v16, s[12:15], s33 offen lds
  s_barrier
  s_waitcnt vmcnt(0)
  s_barrier
L_mqkv_pub:
  s_branch L_mqkv_skip3
L_mqkv_skip:
  v_mov_b32 v4, s76
  v_mov_b32 v5, s77
  s_cmp_lg_u32 s5, 0
  s_mov_b64 exec, 1
  s_waitcnt vmcnt(0) lgkmcnt(0)
  s_barrier
  s_cbranch_scc1 L_pub_34
  buffer_store_dwordx2 v[4:5], off, s[8:11], s83 sc1
L_pub_34:
  s_mov_b64 exec, -1
L_mqkv_skip3:
  s_add_u32 s3, s3, 33554432
  s_add_u32 s95, s95, 524288
  s_mov_b32 s4, 1
  s_branch L_mega_layer
L_mega_end:
  s_endpgm
B_mega_codeend:
L_text_end:
.section .rodata,"a"
.p2align 6
.amdhsa_kernel mega_kernel
  .amdhsa_next_free_vgpr 256
  .amdhsa_next_free_sgpr 102
  .amdhsa_accum_offset 256
  .amdhsa_group_segment_fixed_size 0
  .amdhsa_kernarg_size 80
  .amdhsa_user_sgpr_count 2
  .amdhsa_user_sgpr_kernarg_segment_ptr 1
  .amdhsa_system_sgpr_workgroup_id_x 1
.end_amdhsa_kernel
```
